```python
import torch

def _softmax(x, axis=-1):
    return torch.softmax(x, dim=axis)
def _gelu(x):
    return torch.nn.functional.gelu(x, approximate="tanh")
def _silu(x):
    return torch.nn.functional.silu(x)
def _sigmoid(x):
    return torch.sigmoid(x)
def _layernorm(x, axis=-1, eps=1e-5):
    m = x.mean(dim=axis, keepdim=True)
    v = x.var(dim=axis, keepdim=True, unbiased=False)
    return (x - m) / torch.sqrt(v + eps)
def _scatter_add(tgt, idx, src, axis=0):
    return tgt.clone().index_add_(axis, idx, src)
def _segment_sum(src, seg, n):
    out = torch.zeros((n,) + src.shape[1:], dtype=src.dtype)
    return out.index_add_(0, seg, src)
def _pad(x, pw):
    flat = tuple(v for pair in reversed(pw) for v in pair)
    return torch.nn.functional.pad(x, flat)

kernel_name = 'gated_mix__linear_kernel_hedgehog__moe_arch_mod__prompt'

def setup_inputs():

    _w = (lambda a: (lambda t: t.to(torch.bfloat16) if t.is_floating_point() else t)(torch.as_tensor(a)))
    def _A_setup():
        B, S, D, H = 1, 2048, 640, 32
        Dh = D // H
        return {
            "x": _w((lambda *s: torch.randn(*s, dtype=torch.bfloat16) * 0.05)(B, S, D)),
            "wqkv": _w((lambda *s: torch.randn(*s, dtype=torch.bfloat16) * 1.6)(D, 3 * D)),
            "w_phi": _w((lambda *s: torch.randn(*s, dtype=torch.bfloat16) * 1.6)(H, Dh, Dh) * (Dh ** -0.5)),
            "wo": _w((lambda *s: torch.randn(*s, dtype=torch.bfloat16) * 0.1)(D, D)),
        }
    _A_in = _A_setup()

    def _B_setup():
        B, S, D, F, C = 1, 2048, 640, 1536, 2
        return {
            "x": _w((lambda *s: torch.randn(*s, dtype=torch.bfloat16) * 0.05)(B, S, D)),
            "w_r": _w((lambda *s: torch.randn(*s, dtype=torch.bfloat16) * 1.6)(D)),
            "w_gate": _w((lambda *s: torch.randn(*s, dtype=torch.bfloat16) * 0.2)(D, F)),
            "w_up": _w((lambda *s: torch.randn(*s, dtype=torch.bfloat16) * 0.2)(D, F)),
            "w_down": _w((lambda *s: torch.randn(*s, dtype=torch.bfloat16) * 0.2)(F, D)),
        }
    _B_in = _B_setup()

    return {
        "A_x": _A_in["x"],
        "A_wqkv": _A_in["wqkv"],
        "A_w_phi": _A_in["w_phi"],
        "A_wo": _A_in["wo"],
        "B_x": _B_in["x"],
        "B_w_r": _B_in["w_r"],
        "B_w_gate": _B_in["w_gate"],
        "B_w_up": _B_in["w_up"],
        "B_w_down": _B_in["w_down"],
        "gate_w": _w((lambda *s: torch.randn(*s, dtype=torch.bfloat16) * 0.05)(640) * 16.0),
    }

def reference(A_x, A_wqkv, A_w_phi, A_wo, B_x, B_w_r, B_w_gate, B_w_up, B_w_down, gate_w):
    def _A_ref(x, wqkv, w_phi, wo):
        B, S, D = x.shape
        H = 32; Dh = D // H
        qkv = (lambda x, *d: x.permute(*d))((x @ wqkv).reshape(B, S, 3, H, Dh), 2, 0, 3, 1, 4)
        q, k, v = qkv[0], qkv[1], qkv[2]
        pq = torch.einsum("bhsd,hdf->bhsf", q, w_phi)
        pk = torch.einsum("bhsd,hdf->bhsf", k, w_phi)
        phi_q = torch.concatenate([_softmax(pq, axis=-1), _softmax(-pq, axis=-1)], axis=-1)
        phi_k = torch.concatenate([_softmax(pk, axis=-1), _softmax(-pk, axis=-1)], axis=-1)
        kv = torch.einsum("bhsf,bhsd->bhfd", phi_k, v)
        z  = torch.einsum("bhsf->bhf", phi_k)
        num = torch.einsum("bhqf,bhfd->bhqd", phi_q, kv)
        den = torch.einsum("bhqf,bhf->bhq", phi_q, z)[..., None] + 1e-6
        o = num / den
        return (lambda x, *d: x.permute(*d))(o, 0, 2, 1, 3).reshape(B, S, D) @ wo

    def _B_ref(x, w_r, w_gate, w_up, w_down):
        B, S, D = x.shape
        C = 2
        r = x @ w_r
        idx = torch.argsort(-r, axis=-1)[:, :C]
        idx_e = (lambda x, n, axis: torch.repeat_interleave(x, n, dim=axis))(idx.reshape(B, C, 1), D, axis=2)
        x_sel = (lambda x, i, axis: torch.take_along_dim(x, i, dim=axis))(x, idx_e, axis=1)
        g = _silu(x_sel @ w_gate)
        u = x_sel @ w_up
        y = (g * u) @ w_down
        r_sel = _sigmoid((lambda x, i, axis: torch.take_along_dim(x, i, dim=axis))(r, idx, axis=1))
        y = y * r_sel.reshape(B, C, 1)
        b_off = (torch.arange(B) * S).reshape(B, 1)
        flat_idx = (idx + b_off).reshape(B * C)
        zero = (x * 0.0).reshape(B * S, D)
        upd = _scatter_add(zero, flat_idx, y.reshape(B * C, D), axis=0)
        return x + upd.reshape(B, S, D)

    x = A_x
    g = _sigmoid((x * gate_w).sum(-1, keepdims=True))
    a = _A_ref(x, A_wqkv, A_w_phi, A_wo)
    b = _B_ref(x, B_w_r, B_w_gate, B_w_up, B_w_down)
    return g * a + (1 - g) * b
```

```asm
; @launch grid=(256,1,1) block=(512,1,1) lds=163840
.amdgcn_target "amdgcn-amd-amdhsa--gfx950"
.text
.globl gated_mix__linear_kernel_hedgehog__moe_arch_mod__prompt_kernel
.p2align 8
.type gated_mix__linear_kernel_hedgehog__moe_arch_mod__prompt_kernel,@function
gated_mix__linear_kernel_hedgehog__moe_arch_mod__prompt_kernel:
    s_load_dwordx2 s[4:5], s[0:1], 0
    s_load_dwordx2 s[8:9], s[0:1], 8
    s_load_dwordx2 s[16:17], s[0:1], 96
    s_getpc_b64 s[56:57]
L_pc:
    s_cmp_ge_u32 s2, 256
    s_cbranch_scc1 L_end
    v_lshrrev_b32 v12, 6, v0
    s_lshr_b32 s59, s2, 3
    s_and_b32 s58, s2, 7
    v_readfirstlane_b32 s50, v12
    s_mul_i32 s60, s59, 1024
    v_lshl_add_u32 v12, v0, 4, s60
    s_cmp_lt_u32 s50, 1
    s_cbranch_scc0 L_nopf
    global_load_dwordx4 v[252:255], v12, s[56:57]
L_nopf:
    s_add_u32 s12, s56, L_tab - L_pc
    s_addc_u32 s13, s57, 0
    v_and_b32 v1, 63, v0
    v_mov_b32 v244, 0
    v_lshlrev_b32 v243, 2, v1
    v_add_u32 v245, 159360, v243
    ds_write_b32 v245, v244
    s_lshr_b32 s48, s58, 1
    s_lshl_b32 s48, s48, 2
    s_lshr_b32 s60, s59, 3
    s_add_u32 s48, s48, s60
    s_and_b32 s49, s58, 1
    s_lshl_b32 s49, s49, 3
    s_and_b32 s60, s59, 7
    s_add_u32 s49, s49, s60
    s_add_u32 s53, s49, s48
    s_mul_i32 s60, s53, 52
    s_lshr_b32 s60, s60, 8
    s_mul_i32 s60, s60, 5
    s_sub_u32 s53, s53, s60
    s_mov_b32 s6, 2621440
    s_mov_b32 s7, 0x20000
    s_mov_b32 s10, 2457600
    s_mov_b32 s11, 0x20000
    s_mul_i32 s61, s49, 80
    s_add_u32 s62, s61, 1280
    s_and_b32 s51, s50, 3
    s_lshr_b32 s52, s50, 2
    s_cmp_lt_u32 s50, 4
    s_cbranch_scc1 L_A
    v_lshrrev_b32 v14, 3, v1
    v_and_b32 v15, 7, v1
    v_lshrrev_b32 v16, 1, v14
    v_xor_b32 v16, v15, v16
    s_lshl_b32 s66, s48, 7
    s_lshl_b32 s67, s51, 5
    s_add_u32 s66, s66, s67
    v_add_u32 v14, s66, v14
    v_mul_u32_u24 v14, 1280, v14
    v_lshl_add_u32 v4, v16, 4, v14
    v_xor_b32 v5, 64, v4
    v_add_u32 v5, 10240, v5
    v_add_u32 v6, 20480, v4
    v_add_u32 v7, 20480, v5
    s_lshl_b32 s68, s51, 12
    s_add_u32 s68, s68, 20480
    s_lshl_b32 s66, s53, 8
    v_lshlrev_b32 v11, 4, v1
    s_waitcnt lgkmcnt(0)
    s_barrier
    s_load_dword s3, s[16:17], 0
    s_load_dwordx2 s[24:25], s[0:1], 48
    s_load_dwordx2 s[28:29], s[0:1], 56
    s_load_dwordx2 s[32:33], s[0:1], 64
    s_load_dwordx2 s[20:21], s[0:1], 80
    s_branch L_B_1
L_A:
    v_lshlrev_b32 v240, 4, v1
    s_and_b32 s56, s49, 1
    s_lshl_b32 s56, s56, 4
    s_add_u32 s56, s56, s48
    s_lshl_b32 s60, s56, 10
    s_add_u32 s60, s60, 13312
    v_lshlrev_b32 v241, 2, v0
    v_add_u32 v241, 4096, v241
    v_add_u32 v242, s60, v241
    global_load_dwordx4 v[212:215], v240, s[12:13] offset:3072
    global_load_dwordx4 v[2:5], v240, s[12:13] offset:0
    global_load_dwordx4 v[6:9], v240, s[12:13] offset:1024
    global_load_dwordx4 v[10:13], v240, s[12:13] offset:2048
    global_load_dword v228, v241, s[12:13]
    global_load_dword v229, v242, s[12:13]
    v_mov_b32 v250, 2146435072
    s_mul_i32 s60, s48, 40
    s_load_dwordx4 s[40:43], s[0:1], 16
    s_load_dwordx2 s[44:45], s[0:1], 40
    s_load_dwordx2 s[36:37], s[0:1], 72
    v_mul_u32_u24 v240, 6554, v0
    v_lshrrev_b32 v240, 16, v240
    v_mul_u32_u24 v241, 10, v240
    v_sub_u32 v241, v0, v241
    v_add_u32 v240, s60, v240
    v_and_b32 v242, 8, v240
    v_lshrrev_b32 v242, 1, v242
    v_xor_b32 v240, v240, v242
    v_cmp_le_u32 vcc, 5, v241
    v_mul_u32_u24 v240, 3840, v240
    v_lshl_add_u32 v240, v241, 4, v240
    v_add_u32 v242, 1200, v240
    v_cndmask_b32 v224, v240, v242, vcc
    v_add_u32 v243, 256, v0
    v_mul_u32_u24 v240, 6554, v243
    v_lshrrev_b32 v240, 16, v240
    v_mul_u32_u24 v241, 10, v240
    v_sub_u32 v241, v243, v241
    v_add_u32 v240, s60, v240
    v_and_b32 v242, 8, v240
    v_lshrrev_b32 v242, 1, v242
    v_xor_b32 v240, v240, v242
    v_cmp_le_u32 vcc, 5, v241
    v_mul_u32_u24 v240, 3840, v240
    v_lshl_add_u32 v240, v241, 4, v240
    v_add_u32 v242, 1200, v240
    v_cndmask_b32 v225, v240, v242, vcc
    v_cmp_gt_u32 vcc, 144, v0
    v_lshlrev_b32 v226, 4, v0
    s_mov_b32 s39, 0x20000
    v_cndmask_b32 v225, v250, v225, vcc
    v_cndmask_b32 v227, v250, v226, vcc
    s_waitcnt lgkmcnt(0)
    buffer_load_dwordx4 v[184:187], v224, s[8:11], s62 offen
    buffer_load_dwordx4 v[188:191], v225, s[8:11], s62 offen
    s_barrier
    s_load_dword s3, s[16:17], 0
    s_load_dwordx2 s[20:21], s[0:1], 80
    s_cmp_lt_u32 s50, 2
    s_cbranch_scc0 L_3
    s_mov_b32 s36, s40
    s_mov_b32 s37, s41
    s_mov_b32 s38, 25600
    s_mul_i32 s60, s49, 1600
    buffer_load_dwordx4 v[200:203], v226, s[36:39], s60 offen
    s_branch L_4
L_3:
    s_cmp_eq_u32 s50, 2
    s_cselect_b32 s36, s44, s36
    s_cselect_b32 s37, s45, s37
    s_cselect_b32 s60, 0, 1280
    s_mov_b32 s38, 1280
    s_add_u32 m0, s60, 153600
    v_lshlrev_b32 v240, 4, v1
    buffer_load_dwordx4 v240, s[36:39], 0 offen lds
    s_mov_b64 exec, 0xffff
    buffer_load_dwordx4 v240, s[36:39], 0 offen offset:1024 lds
    s_mov_b64 exec, -1
L_4:
    s_lshl_b32 s54, s58, 2
    s_lshr_b32 s60, s59, 3
    s_add_u32 s54, s54, s60
    s_and_b32 s55, s59, 7
    s_mov_b32 s18, 268435456
    s_mov_b32 s19, 0x20000
    s_mov_b32 s22, 2621440
    s_mov_b32 s23, 0x20000
    s_mov_b32 s69, 0
    s_mov_b32 s98, 0
    s_mov_b32 s99, 0
    s_mul_i32 s65, s49, 266240
    s_add_u32 s65, s65, 3342336
    s_mul_i32 s64, s48, 16640
    s_add_u32 s64, s64, s65
    s_mul_i32 s46, s49, 102400
    s_add_u32 s46, s46, 65536
    s_lshr_b32 s57, s49, 1
    s_mul_i32 s68, s57, 160
    s_mov_b32 s24, s42
    s_mov_b32 s25, s43
    s_mov_b32 s26, 819200
    s_mov_b32 s27, 0x20000
    s_mul_i32 s70, s57, 102400
    s_mul_i32 s60, s56, 3200
    s_add_u32 s70, s70, s60
    s_add_u32 s70, s70, 2523136
    s_mul_i32 s63, s49, 51200
    s_mul_i32 s60, s48, 3200
    s_add_u32 s63, s63, s60
    s_add_u32 s63, s63, 1703936
    s_mul_i32 s60, s48, 6400
    s_add_u32 s71, s46, s60
    s_add_u32 s67, s71, 4096
    s_mul_i32 s60, s48, 153600
    s_add_u32 s61, s61, s60
    s_lshl_b32 s66, s53, 8
    s_mov_b32 s40, 1069066811
    s_mov_b32 s41, 3216550459
    v_cmp_gt_u32 vcc, 200, v0
    s_nop 1
    v_cndmask_b32 v230, v250, v226, vcc
    v_mov_b32 v223, 159424
    s_lshl_b32 s60, s51, 2
    v_add_u32 v251, s60, v223
    s_lshl_b32 s47, s49, 4
    s_add_u32 s47, s47, s48
    s_lshl_b32 s47, s47, 2
    s_add_u32 s45, s47, s50
    s_lshl_b32 s45, s45, 2
    s_add_u32 s45, s45, 16384
    s_waitcnt vmcnt(3)
    s_waitcnt vmcnt(1)
    buffer_store_dwordx4 v[184:187], v226, s[16:19], s71 offen sc1
    buffer_store_dwordx4 v[188:191], v227, s[16:19], s67 offen sc1
    v_add_u32 v240, s57, v229
    v_and_b32 v241, 8, v229
    v_and_b32 v240, 7, v240
    v_cmp_eq_u32 vcc, 0, v241
    v_mul_u32_u24 v240, 51200, v240
    v_and_b32 v229, -16, v229
    v_cndmask_b32 v240, 0, v240, vcc
    v_add_u32 v229, v229, v240
    buffer_load_dwordx4 v[192:195], v228, s[8:11], s61 offen
    buffer_load_dwordx4 v[196:199], v229, s[24:27], s68 offen
    v_mov_b32 v220, v213
    v_mov_b32 v222, v215
    s_lshl_b32 s60, s51, 8
    v_add_u32 v221, s60, v214
    s_lshl_b32 s60, s51, 12
    v_add_u32 v212, s60, v212
    v_xor_b32 v213, 64, v212
    v_add_u32 v214, 0x10000, v212
    v_add_u32 v215, 0x10000, v213
    s_mul_i32 s60, s51, 3328
    v_add_u32 v8, s60, v8
    s_mul_i32 s60, s51, 5376
    v_add_u32 v9, s60, v9
    v_mov_b32 v253, 1
    v_mov_b32 v254, v251
    s_waitcnt lgkmcnt(0)
    s_mul_i32 s3, s3, 0x9E3779B1
    s_add_u32 s3, s3, 0x7F4A7C15
    v_mov_b32 v245, s3
    s_waitcnt vmcnt(4)
    s_cmp_lt_u32 s50, 2
    s_cbranch_scc0 L_5
    v_xor_b32 v216, 0x80008000, v200
    v_xor_b32 v217, 0x80008000, v201
    v_xor_b32 v218, 0x80008000, v202
    v_xor_b32 v219, 0x80008000, v203
    v_add_u32 v247, 156160, v226
    v_cmp_gt_u32 vcc, 100, v0
    s_nop 0
    s_mov_b64 exec, vcc
    ds_write_b128 v247, v[200:203]
    ds_write_b128 v247, v[216:219] offset:1600
    s_mov_b64 exec, -1
    s_waitcnt lgkmcnt(0)
L_5:
    v_add_u32 v247, 162688, v13
    ds_write_b128 v247, v[10:13]
    s_mov_b64 exec, 1
    ds_add_u32 v223, v253 offset:16
    s_mov_b64 exec, -1
    s_waitcnt vmcnt(2)
    s_mov_b64 exec, 1
    buffer_atomic_swap v245, off, s[16:19], s45 sc1
    s_mov_b64 exec, -1
L_6:
    ds_read_b32 v255, v223 offset:16
    s_waitcnt lgkmcnt(0)
    v_cmp_gt_u32 vcc, 4, v255
    s_cbranch_vccz L_6_d
    s_add_u32 s99, s99, 1
    s_cmp_gt_u32 s99, 0x1000000
    s_cbranch_scc1 L_6_d
    s_sleep 1
    s_branch L_6
L_6_d:
    ds_read_b64_tr_b16 v[14:15], v222 offset:0
    ds_read_b64_tr_b16 v[16:17], v222 offset:8
    ds_read_b64_tr_b16 v[18:19], v222 offset:16
    ds_read_b64_tr_b16 v[20:21], v222 offset:24
    ds_read_b64_tr_b16 v[22:23], v222 offset:32
L_7:
    ds_read_b32 v255, v254 offset:32
    s_waitcnt lgkmcnt(0)
    v_cmp_gt_u32 vcc, 1, v255
    s_cbranch_vccz L_7_d
    s_add_u32 s99, s99, 1
    s_cmp_gt_u32 s99, 0x1000000
    s_cbranch_scc1 L_7_d
    s_sleep 1
    s_branch L_7
L_7_d:
    v_add_u32 v249, s66, v220
    s_add_u32 s66, s66, 256
    s_cmp_eq_u32 s66, 1280
    s_cselect_b32 s66, 0, s66
    ds_read_b128 v[24:27], v214 offset:32768
    ds_read_b128 v[28:31], v215 offset:32768
    ds_read_b128 v[32:35], v214 offset:34816
    ds_read_b128 v[36:39], v215 offset:34816
    ds_read_b128 v[232:235], v249 offset:0
    ds_read_b128 v[236:239], v249 offset:64
    ds_read_b128 v[240:243], v249 offset:128
    ds_read_b128 v[244:247], v249 offset:192
    ds_read_b128 v[40:43], v214 offset:49152
    ds_read_b128 v[44:47], v215 offset:49152
    ds_read_b128 v[48:51], v214 offset:51200
    ds_read_b128 v[52:55], v215 offset:51200
    s_waitcnt lgkmcnt(6)
    v_mfma_f32_16x16x32_bf16 v[184:187], v[232:235], v[24:27], 0
    v_mfma_f32_16x16x32_bf16 v[188:191], v[232:235], v[32:35], 0
    v_mfma_f32_16x16x32_bf16 v[184:187], v[236:239], v[28:31], v[184:187]
    v_mfma_f32_16x16x32_bf16 v[188:191], v[236:239], v[36:39], v[188:191]
    s_waitcnt lgkmcnt(0)
    s_mov_b64 exec, 1
    ds_add_u32 v254, v253 offset:48
    s_mov_b64 exec, -1
    v_mfma_f32_16x16x32_bf16 v[184:187], v[240:243], v[40:43], v[184:187]
    v_mfma_f32_16x16x32_bf16 v[188:191], v[240:243], v[48:51], v[188:191]
    v_mfma_f32_16x16x32_bf16 v[184:187], v[244:247], v[44:47], v[184:187]
    v_mfma_f32_16x16x32_bf16 v[188:191], v[244:247], v[52:55], v[188:191]
    s_waitcnt vmcnt(2)
    buffer_store_dwordx4 v[192:195], v230, s[16:19], s63 offen sc1
L_8:
    ds_read_b32 v255, v254 offset:32
    s_waitcnt lgkmcnt(0)
    v_cmp_gt_u32 vcc, 2, v255
    s_cbranch_vccz L_8_d
    s_add_u32 s99, s99, 1
    s_cmp_gt_u32 s99, 0x1000000
    s_cbranch_scc1 L_8_d
    s_sleep 1
    s_branch L_8
L_8_d:
    v_add_u32 v249, s66, v220
    s_add_u32 s66, s66, 256
    s_cmp_eq_u32 s66, 1280
    s_cselect_b32 s66, 0, s66
    ds_read_b128 v[56:59], v212 offset:0
    ds_read_b128 v[60:63], v213 offset:0
    ds_read_b128 v[64:67], v212 offset:2048
    ds_read_b128 v[68:71], v213 offset:2048
    ds_read_b128 v[232:235], v249 offset:0
    ds_read_b128 v[236:239], v249 offset:64
    ds_read_b128 v[240:243], v249 offset:128
    ds_read_b128 v[244:247], v249 offset:192
    ds_read_b128 v[72:75], v212 offset:16384
    ds_read_b128 v[76:79], v213 offset:16384
    ds_read_b128 v[80:83], v212 offset:18432
    ds_read_b128 v[84:87], v213 offset:18432
    s_waitcnt lgkmcnt(6)
    v_mfma_f32_16x16x32_bf16 v[184:187], v[232:235], v[56:59], v[184:187]
    v_mfma_f32_16x16x32_bf16 v[188:191], v[232:235], v[64:67], v[188:191]
    v_mfma_f32_16x16x32_bf16 v[184:187], v[236:239], v[60:63], v[184:187]
    v_mfma_f32_16x16x32_bf16 v[188:191], v[236:239], v[68:71], v[188:191]
    s_waitcnt lgkmcnt(0)
    v_mfma_f32_16x16x32_bf16 v[184:187], v[240:243], v[72:75], v[184:187]
    v_mfma_f32_16x16x32_bf16 v[188:191], v[240:243], v[80:83], v[188:191]
    v_mfma_f32_16x16x32_bf16 v[184:187], v[244:247], v[76:79], v[184:187]
    v_mfma_f32_16x16x32_bf16 v[188:191], v[244:247], v[84:87], v[188:191]
    s_waitcnt vmcnt(2)
    buffer_store_dwordx4 v[196:199], v230, s[16:19], s70 offen sc1
L_9:
    ds_read_b32 v255, v254 offset:32
    s_waitcnt lgkmcnt(0)
    v_cmp_gt_u32 vcc, 3, v255
    s_cbranch_vccz L_9_d
    s_add_u32 s99, s99, 1
    s_cmp_gt_u32 s99, 0x1000000
    s_cbranch_scc1 L_9_d
    s_sleep 1
    s_branch L_9
L_9_d:
    v_add_u32 v249, s66, v220
    s_add_u32 s66, s66, 256
    s_cmp_eq_u32 s66, 1280
    s_cselect_b32 s66, 0, s66
    ds_read_b128 v[88:91], v212 offset:32768
    ds_read_b128 v[92:95], v213 offset:32768
    ds_read_b128 v[96:99], v212 offset:34816
    ds_read_b128 v[100:103], v213 offset:34816
    ds_read_b128 v[232:235], v249 offset:0
    ds_read_b128 v[236:239], v249 offset:64
    ds_read_b128 v[240:243], v249 offset:128
    ds_read_b128 v[244:247], v249 offset:192
    ds_read_b128 v[104:107], v212 offset:49152
    ds_read_b128 v[108:111], v213 offset:49152
    ds_read_b128 v[112:115], v212 offset:51200
    ds_read_b128 v[116:119], v213 offset:51200
    s_waitcnt lgkmcnt(6)
    v_mfma_f32_16x16x32_bf16 v[184:187], v[232:235], v[88:91], v[184:187]
    v_mfma_f32_16x16x32_bf16 v[188:191], v[232:235], v[96:99], v[188:191]
    v_mfma_f32_16x16x32_bf16 v[184:187], v[236:239], v[92:95], v[184:187]
    v_mfma_f32_16x16x32_bf16 v[188:191], v[236:239], v[100:103], v[188:191]
    s_waitcnt lgkmcnt(0)
    v_mfma_f32_16x16x32_bf16 v[184:187], v[240:243], v[104:107], v[184:187]
    v_mfma_f32_16x16x32_bf16 v[188:191], v[240:243], v[112:115], v[188:191]
    v_mfma_f32_16x16x32_bf16 v[184:187], v[244:247], v[108:111], v[184:187]
    v_mfma_f32_16x16x32_bf16 v[188:191], v[244:247], v[116:119], v[188:191]
L_10:
    ds_read_b32 v255, v254 offset:32
    s_waitcnt lgkmcnt(0)
    v_cmp_gt_u32 vcc, 4, v255
    s_cbranch_vccz L_10_d
    s_add_u32 s99, s99, 1
    s_cmp_gt_u32 s99, 0x1000000
    s_cbranch_scc1 L_10_d
    s_sleep 1
    s_branch L_10
L_10_d:
    v_add_u32 v249, s66, v220
    s_add_u32 s66, s66, 256
    s_cmp_eq_u32 s66, 1280
    s_cselect_b32 s66, 0, s66
    ds_read_b128 v[120:123], v214 offset:0
    ds_read_b128 v[124:127], v215 offset:0
    ds_read_b128 v[128:131], v214 offset:2048
    ds_read_b128 v[132:135], v215 offset:2048
    ds_read_b128 v[232:235], v249 offset:0
    ds_read_b128 v[236:239], v249 offset:64
    ds_read_b128 v[240:243], v249 offset:128
    ds_read_b128 v[244:247], v249 offset:192
    ds_read_b128 v[136:139], v214 offset:16384
    ds_read_b128 v[140:143], v215 offset:16384
    ds_read_b128 v[144:147], v214 offset:18432
    ds_read_b128 v[148:151], v215 offset:18432
    s_waitcnt lgkmcnt(6)
    v_mfma_f32_16x16x32_bf16 v[184:187], v[232:235], v[120:123], v[184:187]
    v_mfma_f32_16x16x32_bf16 v[188:191], v[232:235], v[128:131], v[188:191]
    v_mfma_f32_16x16x32_bf16 v[184:187], v[236:239], v[124:127], v[184:187]
    v_mfma_f32_16x16x32_bf16 v[188:191], v[236:239], v[132:135], v[188:191]
    s_waitcnt lgkmcnt(0)
    s_mov_b64 exec, 1
    ds_add_u32 v223, v253 offset:20
    s_mov_b64 exec, -1
    v_mfma_f32_16x16x32_bf16 v[184:187], v[240:243], v[136:139], v[184:187]
    v_mfma_f32_16x16x32_bf16 v[188:191], v[240:243], v[144:147], v[188:191]
    v_mfma_f32_16x16x32_bf16 v[184:187], v[244:247], v[140:143], v[184:187]
    v_mfma_f32_16x16x32_bf16 v[188:191], v[244:247], v[148:151], v[188:191]
    s_waitcnt vmcnt(0)
    s_lshl_b32 s60, s49, 7
    s_lshl_b32 s59, s48, 2
    s_add_u32 s60, s60, s59
    s_add_u32 s60, s60, 8192
    s_mov_b64 exec, 1
    ds_add_rtn_u32 v255, v223, v253 offset:132
    v_mov_b32 v248, s3
    s_waitcnt lgkmcnt(0)
    v_cmp_eq_u32 vcc, 3, v255
    s_cbranch_vccz L_11
    buffer_atomic_swap v248, off, s[16:19], s60 sc1
L_11:
    s_mov_b64 exec, -1
L_12:
    ds_read_b32 v255, v254 offset:32
    s_waitcnt lgkmcnt(0)
    v_cmp_gt_u32 vcc, 5, v255
    s_cbranch_vccz L_12_d
    s_add_u32 s99, s99, 1
    s_cmp_gt_u32 s99, 0x1000000
    s_cbranch_scc1 L_12_d
    s_sleep 1
    s_branch L_12
L_12_d:
    v_add_u32 v249, s66, v220
    s_add_u32 s66, s66, 256
    s_cmp_eq_u32 s66, 1280
    s_cselect_b32 s66, 0, s66
    ds_read_b128 v[152:155], v214 offset:32768
    ds_read_b128 v[156:159], v215 offset:32768
    ds_read_b128 v[160:163], v214 offset:34816
    ds_read_b128 v[164:167], v215 offset:34816
    ds_read_b128 v[232:235], v249 offset:0
    ds_read_b128 v[236:239], v249 offset:64
    ds_read_b128 v[240:243], v249 offset:128
    ds_read_b128 v[244:247], v249 offset:192
    ds_read_b128 v[168:171], v214 offset:49152
    ds_read_b128 v[172:175], v215 offset:49152
    ds_read_b128 v[176:179], v214 offset:51200
    ds_read_b128 v[180:183], v215 offset:51200
    s_waitcnt lgkmcnt(6)
    v_mfma_f32_16x16x32_bf16 v[184:187], v[232:235], v[152:155], v[184:187]
    v_mfma_f32_16x16x32_bf16 v[188:191], v[232:235], v[160:163], v[188:191]
    v_mfma_f32_16x16x32_bf16 v[184:187], v[236:239], v[156:159], v[184:187]
    v_mfma_f32_16x16x32_bf16 v[188:191], v[236:239], v[164:167], v[188:191]
    s_waitcnt lgkmcnt(0)
    v_mfma_f32_16x16x32_bf16 v[184:187], v[240:243], v[168:171], v[184:187]
    v_mfma_f32_16x16x32_bf16 v[188:191], v[240:243], v[176:179], v[188:191]
    v_mfma_f32_16x16x32_bf16 v[184:187], v[244:247], v[172:175], v[184:187]
    v_mfma_f32_16x16x32_bf16 v[188:191], v[244:247], v[180:183], v[188:191]
    v_mov_b32 v0, 159424
    s_mov_b64 exec, 0xffff
    s_nop 4
    ds_write_b64 v221, v[184:185] offset:0
    ds_write_b64 v221, v[188:189] offset:128
    s_mov_b64 exec, -1
    s_waitcnt lgkmcnt(0)
    s_barrier
    ds_read_b64_tr_b16 v[224:225], v2 offset:0
    ds_read_b64_tr_b16 v[226:227], v3 offset:0
    ds_read_b64_tr_b16 v[228:229], v2 offset:32
    ds_read_b64_tr_b16 v[230:231], v3 offset:32
    ds_read_b64_tr_b16 v[232:233], v2 offset:64
    ds_read_b64_tr_b16 v[234:235], v3 offset:64
    ds_read_b64_tr_b16 v[236:237], v2 offset:96
    ds_read_b64_tr_b16 v[238:239], v3 offset:96
    ds_read_b64_tr_b16 v[240:241], v2 offset:128
    ds_read_b64_tr_b16 v[242:243], v3 offset:128
    ds_read_b64_tr_b16 v[244:245], v2 offset:5120
    ds_read_b64_tr_b16 v[246:247], v3 offset:5120
    ds_read_b64_tr_b16 v[248:249], v2 offset:5152
    ds_read_b64_tr_b16 v[250:251], v3 offset:5152
    s_waitcnt lgkmcnt(12)
    v_mfma_f32_16x16x32_bf16 v[184:187], v[224:227], v[24:27], 0
    ds_read_b64_tr_b16 v[252:253], v2 offset:5184
    v_mfma_f32_16x16x32_bf16 v[204:207], v[224:227], v[32:35], 0
    ds_read_b64_tr_b16 v[254:255], v3 offset:5184
    s_waitcnt lgkmcnt(12)
    v_mfma_f32_16x16x32_bf16 v[188:191], v[228:231], v[24:27], 0
    ds_read_b64_tr_b16 v[224:225], v2 offset:5216
    v_mfma_f32_16x16x32_bf16 v[208:211], v[228:231], v[32:35], 0
    ds_read_b64_tr_b16 v[226:227], v3 offset:5216
    s_waitcnt lgkmcnt(12)
    v_mfma_f32_16x16x32_bf16 v[192:195], v[232:235], v[24:27], 0
    ds_read_b64_tr_b16 v[228:229], v2 offset:5248
    v_mfma_f32_16x16x32_bf16 v[212:215], v[232:235], v[32:35], 0
    ds_read_b64_tr_b16 v[230:231], v3 offset:5248
    s_waitcnt lgkmcnt(12)
    v_mfma_f32_16x16x32_bf16 v[196:199], v[236:239], v[24:27], 0
    ds_read_b64_tr_b16 v[232:233], v2 offset:10240
    v_mfma_f32_16x16x32_bf16 v[216:219], v[236:239], v[32:35], 0
    ds_read_b64_tr_b16 v[234:235], v3 offset:10240
    s_waitcnt lgkmcnt(12)
    v_mfma_f32_16x16x32_bf16 v[200:203], v[240:243], v[24:27], 0
    ds_read_b64_tr_b16 v[236:237], v2 offset:10272
    v_mfma_f32_16x16x32_bf16 v[220:223], v[240:243], v[32:35], 0
    ds_read_b64_tr_b16 v[238:239], v3 offset:10272
    s_waitcnt lgkmcnt(12)
    v_mfma_f32_16x16x32_bf16 v[184:187], v[244:247], v[28:31], v[184:187]
    ds_read_b64_tr_b16 v[240:241], v2 offset:10304
    v_mfma_f32_16x16x32_bf16 v[204:207], v[244:247], v[36:39], v[204:207]
    ds_read_b64_tr_b16 v[242:243], v3 offset:10304
    s_waitcnt lgkmcnt(12)
    v_mfma_f32_16x16x32_bf16 v[188:191], v[248:251], v[28:31], v[188:191]
    ds_read_b64_tr_b16 v[244:245], v2 offset:10336
    v_mfma_f32_16x16x32_bf16 v[208:211], v[248:251], v[36:39], v[208:211]
    ds_read_b64_tr_b16 v[246:247], v3 offset:10336
    s_waitcnt lgkmcnt(12)
    v_mfma_f32_16x16x32_bf16 v[192:195], v[252:255], v[28:31], v[192:195]
    ds_read_b64_tr_b16 v[248:249], v2 offset:10368
    v_mfma_f32_16x16x32_bf16 v[212:215], v[252:255], v[36:39], v[212:215]
    ds_read_b64_tr_b16 v[250:251], v3 offset:10368
    s_waitcnt lgkmcnt(12)
    v_mfma_f32_16x16x32_bf16 v[196:199], v[224:227], v[28:31], v[196:199]
    ds_read_b64_tr_b16 v[252:253], v2 offset:15360
    v_mfma_f32_16x16x32_bf16 v[216:219], v[224:227], v[36:39], v[216:219]
    ds_read_b64_tr_b16 v[254:255], v3 offset:15360
    s_waitcnt lgkmcnt(12)
    v_mfma_f32_16x16x32_bf16 v[200:203], v[228:231], v[28:31], v[200:203]
    ds_read_b64_tr_b16 v[224:225], v2 offset:15392
    v_mfma_f32_16x16x32_bf16 v[220:223], v[228:231], v[36:39], v[220:223]
    ds_read_b64_tr_b16 v[226:227], v3 offset:15392
    s_waitcnt lgkmcnt(12)
    v_mfma_f32_16x16x32_bf16 v[184:187], v[232:235], v[40:43], v[184:187]
    ds_read_b64_tr_b16 v[228:229], v2 offset:15424
    v_mfma_f32_16x16x32_bf16 v[204:207], v[232:235], v[48:51], v[204:207]
    ds_read_b64_tr_b16 v[230:231], v3 offset:15424
    s_waitcnt lgkmcnt(12)
    v_mfma_f32_16x16x32_bf16 v[188:191], v[236:239], v[40:43], v[188:191]
    ds_read_b64_tr_b16 v[232:233], v2 offset:15456
    v_mfma_f32_16x16x32_bf16 v[208:211], v[236:239], v[48:51], v[208:211]
    ds_read_b64_tr_b16 v[234:235], v3 offset:15456
    s_waitcnt lgkmcnt(12)
    v_mfma_f32_16x16x32_bf16 v[192:195], v[240:243], v[40:43], v[192:195]
    ds_read_b64_tr_b16 v[236:237], v2 offset:15488
    v_mfma_f32_16x16x32_bf16 v[212:215], v[240:243], v[48:51], v[212:215]
    ds_read_b64_tr_b16 v[238:239], v3 offset:15488
    s_waitcnt lgkmcnt(12)
    v_mfma_f32_16x16x32_bf16 v[196:199], v[244:247], v[40:43], v[196:199]
    s_barrier
    ds_read_b64_tr_b16 v[240:241], v2 offset:20480
    v_mfma_f32_16x16x32_bf16 v[216:219], v[244:247], v[48:51], v[216:219]
    ds_read_b64_tr_b16 v[242:243], v3 offset:20480
    s_waitcnt lgkmcnt(12)
    v_mfma_f32_16x16x32_bf16 v[200:203], v[248:251], v[40:43], v[200:203]
    ds_read_b64_tr_b16 v[244:245], v2 offset:20512
    v_mfma_f32_16x16x32_bf16 v[220:223], v[248:251], v[48:51], v[220:223]
    ds_read_b64_tr_b16 v[246:247], v3 offset:20512
    s_waitcnt lgkmcnt(12)
    v_mfma_f32_16x16x32_bf16 v[184:187], v[252:255], v[44:47], v[184:187]
    ds_read_b64_tr_b16 v[248:249], v2 offset:20544
    v_mfma_f32_16x16x32_bf16 v[204:207], v[252:255], v[52:55], v[204:207]
    ds_read_b64_tr_b16 v[250:251], v3 offset:20544
    s_waitcnt lgkmcnt(12)
    v_mfma_f32_16x16x32_bf16 v[188:191], v[224:227], v[44:47], v[188:191]
    ds_read_b64_tr_b16 v[252:253], v2 offset:20576
    v_mfma_f32_16x16x32_bf16 v[208:211], v[224:227], v[52:55], v[208:211]
    ds_read_b64_tr_b16 v[254:255], v3 offset:20576
    s_waitcnt lgkmcnt(12)
    v_mfma_f32_16x16x32_bf16 v[192:195], v[228:231], v[44:47], v[192:195]
    ds_read_b64_tr_b16 v[224:225], v2 offset:20608
    v_mfma_f32_16x16x32_bf16 v[212:215], v[228:231], v[52:55], v[212:215]
    ds_read_b64_tr_b16 v[226:227], v3 offset:20608
    s_waitcnt lgkmcnt(12)
    v_mfma_f32_16x16x32_bf16 v[196:199], v[232:235], v[44:47], v[196:199]
    ds_read_b64_tr_b16 v[228:229], v2 offset:25600
    v_mfma_f32_16x16x32_bf16 v[216:219], v[232:235], v[52:55], v[216:219]
    ds_read_b64_tr_b16 v[230:231], v3 offset:25600
    s_waitcnt lgkmcnt(12)
    v_mfma_f32_16x16x32_bf16 v[200:203], v[236:239], v[44:47], v[200:203]
    ds_read_b64_tr_b16 v[232:233], v2 offset:25632
    v_mfma_f32_16x16x32_bf16 v[220:223], v[236:239], v[52:55], v[220:223]
    ds_read_b64_tr_b16 v[234:235], v3 offset:25632
    s_waitcnt lgkmcnt(12)
    v_mfma_f32_16x16x32_bf16 v[184:187], v[240:243], v[56:59], v[184:187]
    ds_read_b64_tr_b16 v[236:237], v2 offset:25664
    v_mfma_f32_16x16x32_bf16 v[204:207], v[240:243], v[64:67], v[204:207]
    ds_read_b64_tr_b16 v[238:239], v3 offset:25664
    s_waitcnt lgkmcnt(12)
    v_mfma_f32_16x16x32_bf16 v[188:191], v[244:247], v[56:59], v[188:191]
    ds_read_b64_tr_b16 v[240:241], v2 offset:25696
    v_mfma_f32_16x16x32_bf16 v[208:211], v[244:247], v[64:67], v[208:211]
    ds_read_b64_tr_b16 v[242:243], v3 offset:25696
    s_waitcnt lgkmcnt(12)
    v_mfma_f32_16x16x32_bf16 v[192:195], v[248:251], v[56:59], v[192:195]
    ds_read_b64_tr_b16 v[244:245], v2 offset:25728
    v_mfma_f32_16x16x32_bf16 v[212:215], v[248:251], v[64:67], v[212:215]
    ds_read_b64_tr_b16 v[246:247], v3 offset:25728
    s_waitcnt lgkmcnt(12)
    v_mfma_f32_16x16x32_bf16 v[196:199], v[252:255], v[56:59], v[196:199]
    ds_read_b64_tr_b16 v[248:249], v2 offset:30720
    v_mfma_f32_16x16x32_bf16 v[216:219], v[252:255], v[64:67], v[216:219]
    ds_read_b64_tr_b16 v[250:251], v3 offset:30720
    s_waitcnt lgkmcnt(12)
    v_mfma_f32_16x16x32_bf16 v[200:203], v[224:227], v[56:59], v[200:203]
    ds_read_b64_tr_b16 v[252:253], v2 offset:30752
    v_mfma_f32_16x16x32_bf16 v[220:223], v[224:227], v[64:67], v[220:223]
    ds_read_b64_tr_b16 v[254:255], v3 offset:30752
    s_waitcnt lgkmcnt(12)
    v_mfma_f32_16x16x32_bf16 v[184:187], v[228:231], v[60:63], v[184:187]
    ds_read_b64_tr_b16 v[224:225], v2 offset:30784
    v_mfma_f32_16x16x32_bf16 v[204:207], v[228:231], v[68:71], v[204:207]
    ds_read_b64_tr_b16 v[226:227], v3 offset:30784
    s_waitcnt lgkmcnt(12)
    v_mfma_f32_16x16x32_bf16 v[188:191], v[232:235], v[60:63], v[188:191]
    ds_read_b64_tr_b16 v[228:229], v2 offset:30816
    v_mfma_f32_16x16x32_bf16 v[208:211], v[232:235], v[68:71], v[208:211]
    ds_read_b64_tr_b16 v[230:231], v3 offset:30816
    s_waitcnt lgkmcnt(12)
    v_mfma_f32_16x16x32_bf16 v[192:195], v[236:239], v[60:63], v[192:195]
    ds_read_b64_tr_b16 v[232:233], v2 offset:30848
    v_mfma_f32_16x16x32_bf16 v[212:215], v[236:239], v[68:71], v[212:215]
    ds_read_b64_tr_b16 v[234:235], v3 offset:30848
    s_waitcnt lgkmcnt(12)
    v_mfma_f32_16x16x32_bf16 v[196:199], v[240:243], v[60:63], v[196:199]
    ds_read_b64_tr_b16 v[236:237], v2 offset:35840
    v_mfma_f32_16x16x32_bf16 v[216:219], v[240:243], v[68:71], v[216:219]
    ds_read_b64_tr_b16 v[238:239], v3 offset:35840
    s_waitcnt lgkmcnt(12)
    v_mfma_f32_16x16x32_bf16 v[200:203], v[244:247], v[60:63], v[200:203]
    ds_read_b64_tr_b16 v[240:241], v2 offset:35872
    v_mfma_f32_16x16x32_bf16 v[220:223], v[244:247], v[68:71], v[220:223]
    ds_read_b64_tr_b16 v[242:243], v3 offset:35872
    s_waitcnt lgkmcnt(12)
    v_mfma_f32_16x16x32_bf16 v[184:187], v[248:251], v[72:75], v[184:187]
    ds_read_b32 v10, v0 offset:92
    ds_read_b64_tr_b16 v[244:245], v2 offset:35904
    v_mfma_f32_16x16x32_bf16 v[204:207], v[248:251], v[80:83], v[204:207]
    ds_read_b64_tr_b16 v[246:247], v3 offset:35904
    s_waitcnt lgkmcnt(13)
    v_mfma_f32_16x16x32_bf16 v[188:191], v[252:255], v[72:75], v[188:191]
    ds_read_b64_tr_b16 v[248:249], v2 offset:35936
    v_mfma_f32_16x16x32_bf16 v[208:211], v[252:255], v[80:83], v[208:211]
    ds_read_b64_tr_b16 v[250:251], v3 offset:35936
    s_waitcnt lgkmcnt(13)
    v_mfma_f32_16x16x32_bf16 v[192:195], v[224:227], v[72:75], v[192:195]
    ds_read_b64_tr_b16 v[252:253], v2 offset:35968
    v_mfma_f32_16x16x32_bf16 v[212:215], v[224:227], v[80:83], v[212:215]
    ds_read_b64_tr_b16 v[254:255], v3 offset:35968
    s_waitcnt lgkmcnt(13)
    v_mfma_f32_16x16x32_bf16 v[196:199], v[228:231], v[72:75], v[196:199]
    s_waitcnt lgkmcnt(6)
    v_cmp_gt_u32 vcc, 4, v10
    s_cbranch_vccz L_13
L_14:
    ds_read_b32 v10, v0 offset:92
    s_waitcnt lgkmcnt(0)
    v_cmp_gt_u32 vcc, 4, v10
    s_cbranch_vccz L_14_d
    s_add_u32 s99, s99, 1
    s_cmp_gt_u32 s99, 0x1000000
    s_cbranch_scc1 L_14_d
    s_sleep 1
    s_branch L_14
L_14_d:
L_13:
    ds_read_b64_tr_b16 v[224:225], v2 offset:40960
    v_mfma_f32_16x16x32_bf16 v[216:219], v[228:231], v[80:83], v[216:219]
    ds_read_b64_tr_b16 v[226:227], v3 offset:40960
    v_mfma_f32_16x16x32_bf16 v[200:203], v[232:235], v[72:75], v[200:203]
    ds_read_b64_tr_b16 v[228:229], v2 offset:40992
    v_mfma_f32_16x16x32_bf16 v[220:223], v[232:235], v[80:83], v[220:223]
    ds_read_b64_tr_b16 v[230:231], v3 offset:40992
    v_mfma_f32_16x16x32_bf16 v[184:187], v[236:239], v[76:79], v[184:187]
    ds_read_b64_tr_b16 v[232:233], v2 offset:41024
    v_mfma_f32_16x16x32_bf16 v[204:207], v[236:239], v[84:87], v[204:207]
    ds_read_b64_tr_b16 v[234:235], v3 offset:41024
    v_mfma_f32_16x16x32_bf16 v[188:191], v[240:243], v[76:79], v[188:191]
    ds_read_b64_tr_b16 v[236:237], v2 offset:41056
    v_mfma_f32_16x16x32_bf16 v[208:211], v[240:243], v[84:87], v[208:211]
    ds_read_b64_tr_b16 v[238:239], v3 offset:41056
    s_waitcnt lgkmcnt(12)
    v_mfma_f32_16x16x32_bf16 v[192:195], v[244:247], v[76:79], v[192:195]
    ds_read_b64_tr_b16 v[240:241], v2 offset:41088
    v_mfma_f32_16x16x32_bf16 v[212:215], v[244:247], v[84:87], v[212:215]
    ds_read_b64_tr_b16 v[242:243], v3 offset:41088
    s_waitcnt lgkmcnt(12)
    v_mfma_f32_16x16x32_bf16 v[196:199], v[248:251], v[76:79], v[196:199]
    ds_read_b64_tr_b16 v[244:245], v2 offset:46080
    v_mfma_f32_16x16x32_bf16 v[216:219], v[248:251], v[84:87], v[216:219]
    ds_read_b64_tr_b16 v[246:247], v3 offset:46080
    s_waitcnt lgkmcnt(12)
    v_mfma_f32_16x16x32_bf16 v[200:203], v[252:255], v[76:79], v[200:203]
    ds_read_b64_tr_b16 v[248:249], v2 offset:46112
    v_mfma_f32_16x16x32_bf16 v[220:223], v[252:255], v[84:87], v[220:223]
    ds_read_b64_tr_b16 v[250:251], v3 offset:46112
    s_waitcnt lgkmcnt(12)
    v_mfma_f32_16x16x32_bf16 v[184:187], v[224:227], v[88:91], v[184:187]
    ds_read_b64_tr_b16 v[252:253], v2 offset:46144
    v_mfma_f32_16x16x32_bf16 v[204:207], v[224:227], v[96:99], v[204:207]
    ds_read_b64_tr_b16 v[254:255], v3 offset:46144
    s_waitcnt lgkmcnt(12)
    v_mfma_f32_16x16x32_bf16 v[188:191], v[228:231], v[88:91], v[188:191]
    s_mov_b64 exec, 2
    ds_add_u32 v0, v1 offset:124
    s_mov_b64 exec, -1
    ds_read_b64_tr_b16 v[224:225], v2 offset:46176
    v_mfma_f32_16x16x32_bf16 v[208:211], v[228:231], v[96:99], v[208:211]
    ds_read_b64_tr_b16 v[226:227], v3 offset:46176
    s_waitcnt lgkmcnt(13)
    v_mfma_f32_16x16x32_bf16 v[192:195], v[232:235], v[88:91], v[192:195]
    ds_read_b64_tr_b16 v[228:229], v2 offset:46208
    v_mfma_f32_16x16x32_bf16 v[212:215], v[232:235], v[96:99], v[212:215]
    ds_read_b64_tr_b16 v[230:231], v3 offset:46208
    s_waitcnt lgkmcnt(13)
    v_mfma_f32_16x16x32_bf16 v[196:199], v[236:239], v[88:91], v[196:199]
    ds_read_b64_tr_b16 v[232:233], v2 offset:51200
    v_mfma_f32_16x16x32_bf16 v[216:219], v[236:239], v[96:99], v[216:219]
    ds_read_b64_tr_b16 v[234:235], v3 offset:51200
    s_waitcnt lgkmcnt(13)
    v_mfma_f32_16x16x32_bf16 v[200:203], v[240:243], v[88:91], v[200:203]
    ds_read_b64_tr_b16 v[236:237], v2 offset:51232
    v_mfma_f32_16x16x32_bf16 v[220:223], v[240:243], v[96:99], v[220:223]
    ds_read_b64_tr_b16 v[238:239], v3 offset:51232
    s_waitcnt lgkmcnt(13)
    v_mfma_f32_16x16x32_bf16 v[184:187], v[244:247], v[92:95], v[184:187]
    ds_read_b64_tr_b16 v[240:241], v2 offset:51264
    v_mfma_f32_16x16x32_bf16 v[204:207], v[244:247], v[100:103], v[204:207]
    ds_read_b64_tr_b16 v[242:243], v3 offset:51264
    s_waitcnt lgkmcnt(13)
    v_mfma_f32_16x16x32_bf16 v[188:191], v[248:251], v[92:95], v[188:191]
    ds_read_b64_tr_b16 v[244:245], v2 offset:51296
    v_mfma_f32_16x16x32_bf16 v[208:211], v[248:251], v[100:103], v[208:211]
    ds_read_b64_tr_b16 v[246:247], v3 offset:51296
    s_waitcnt lgkmcnt(13)
    v_mfma_f32_16x16x32_bf16 v[192:195], v[252:255], v[92:95], v[192:195]
    ds_read_b64_tr_b16 v[248:249], v2 offset:51328
    v_mfma_f32_16x16x32_bf16 v[212:215], v[252:255], v[100:103], v[212:215]
    ds_read_b64_tr_b16 v[250:251], v3 offset:51328
    s_waitcnt lgkmcnt(12)
    v_mfma_f32_16x16x32_bf16 v[196:199], v[224:227], v[92:95], v[196:199]
    ds_read_b64_tr_b16 v[252:253], v2 offset:56320
    v_mfma_f32_16x16x32_bf16 v[216:219], v[224:227], v[100:103], v[216:219]
    ds_read_b64_tr_b16 v[254:255], v3 offset:56320
    s_waitcnt lgkmcnt(12)
    v_mfma_f32_16x16x32_bf16 v[200:203], v[228:231], v[92:95], v[200:203]
    ds_read_b64_tr_b16 v[224:225], v2 offset:56352
    v_mfma_f32_16x16x32_bf16 v[220:223], v[228:231], v[100:103], v[220:223]
    ds_read_b64_tr_b16 v[226:227], v3 offset:56352
    s_waitcnt lgkmcnt(12)
    v_mfma_f32_16x16x32_bf16 v[184:187], v[232:235], v[104:107], v[184:187]
    ds_read_b32 v10, v0 offset:100
    ds_read_b64_tr_b16 v[228:229], v2 offset:56384
    v_mfma_f32_16x16x32_bf16 v[204:207], v[232:235], v[112:115], v[204:207]
    ds_read_b64_tr_b16 v[230:231], v3 offset:56384
    s_waitcnt lgkmcnt(13)
    v_mfma_f32_16x16x32_bf16 v[188:191], v[236:239], v[104:107], v[188:191]
    ds_read_b64_tr_b16 v[232:233], v2 offset:56416
    v_mfma_f32_16x16x32_bf16 v[208:211], v[236:239], v[112:115], v[208:211]
    ds_read_b64_tr_b16 v[234:235], v3 offset:56416
    s_waitcnt lgkmcnt(13)
    v_mfma_f32_16x16x32_bf16 v[192:195], v[240:243], v[104:107], v[192:195]
    ds_read_b64_tr_b16 v[236:237], v2 offset:56448
    v_mfma_f32_16x16x32_bf16 v[212:215], v[240:243], v[112:115], v[212:215]
    ds_read_b64_tr_b16 v[238:239], v3 offset:56448
    s_waitcnt lgkmcnt(13)
    v_mfma_f32_16x16x32_bf16 v[196:199], v[244:247], v[104:107], v[196:199]
    s_waitcnt lgkmcnt(6)
    v_cmp_gt_u32 vcc, 4, v10
    s_cbranch_vccz L_15
L_16:
    ds_read_b32 v10, v0 offset:100
    s_waitcnt lgkmcnt(0)
    v_cmp_gt_u32 vcc, 4, v10
    s_cbranch_vccz L_16_d
    s_add_u32 s99, s99, 1
    s_cmp_gt_u32 s99, 0x1000000
    s_cbranch_scc1 L_16_d
    s_sleep 1
    s_branch L_16
L_16_d:
L_15:
    v_add_u32 v2, 61440, v2
    v_add_u32 v3, 61440, v3
    ds_read_b64_tr_b16 v[240:241], v2 offset:0
    v_mfma_f32_16x16x32_bf16 v[216:219], v[244:247], v[112:115], v[216:219]
    ds_read_b64_tr_b16 v[242:243], v3 offset:0
    v_mfma_f32_16x16x32_bf16 v[200:203], v[248:251], v[104:107], v[200:203]
    ds_read_b64_tr_b16 v[244:245], v2 offset:32
    v_mfma_f32_16x16x32_bf16 v[220:223], v[248:251], v[112:115], v[220:223]
    ds_read_b64_tr_b16 v[246:247], v3 offset:32
    v_mfma_f32_16x16x32_bf16 v[184:187], v[252:255], v[108:111], v[184:187]
    ds_read_b64_tr_b16 v[248:249], v2 offset:64
    v_mfma_f32_16x16x32_bf16 v[204:207], v[252:255], v[116:119], v[204:207]
    ds_read_b64_tr_b16 v[250:251], v3 offset:64
    v_mfma_f32_16x16x32_bf16 v[188:191], v[224:227], v[108:111], v[188:191]
    ds_read_b64_tr_b16 v[252:253], v2 offset:96
    v_mfma_f32_16x16x32_bf16 v[208:211], v[224:227], v[116:119], v[208:211]
    ds_read_b64_tr_b16 v[254:255], v3 offset:96
    s_waitcnt lgkmcnt(12)
    v_mfma_f32_16x16x32_bf16 v[192:195], v[228:231], v[108:111], v[192:195]
    ds_read_b64_tr_b16 v[224:225], v2 offset:128
    v_mfma_f32_16x16x32_bf16 v[212:215], v[228:231], v[116:119], v[212:215]
    ds_read_b64_tr_b16 v[226:227], v3 offset:128
    s_waitcnt lgkmcnt(12)
    v_mfma_f32_16x16x32_bf16 v[196:199], v[232:235], v[108:111], v[196:199]
    ds_read_b64_tr_b16 v[228:229], v2 offset:5120
    v_mfma_f32_16x16x32_bf16 v[216:219], v[232:235], v[116:119], v[216:219]
    ds_read_b64_tr_b16 v[230:231], v3 offset:5120
    s_waitcnt lgkmcnt(12)
    v_mfma_f32_16x16x32_bf16 v[200:203], v[236:239], v[108:111], v[200:203]
    ds_read_b64_tr_b16 v[232:233], v2 offset:5152
    v_mfma_f32_16x16x32_bf16 v[220:223], v[236:239], v[116:119], v[220:223]
    ds_read_b64_tr_b16 v[234:235], v3 offset:5152
    s_waitcnt lgkmcnt(12)
    v_mfma_f32_16x16x32_bf16 v[184:187], v[240:243], v[120:123], v[184:187]
    ds_read_b64_tr_b16 v[236:237], v2 offset:5184
    v_mfma_f32_16x16x32_bf16 v[204:207], v[240:243], v[128:131], v[204:207]
    ds_read_b64_tr_b16 v[238:239], v3 offset:5184
    s_waitcnt lgkmcnt(12)
    v_mfma_f32_16x16x32_bf16 v[188:191], v[244:247], v[120:123], v[188:191]
    ds_read_b64_tr_b16 v[240:241], v2 offset:5216
    v_mfma_f32_16x16x32_bf16 v[208:211], v[244:247], v[128:131], v[208:211]
    ds_read_b64_tr_b16 v[242:243], v3 offset:5216
    s_waitcnt lgkmcnt(12)
    v_mfma_f32_16x16x32_bf16 v[192:195], v[248:251], v[120:123], v[192:195]
    ds_read_b64_tr_b16 v[244:245], v2 offset:5248
    v_mfma_f32_16x16x32_bf16 v[212:215], v[248:251], v[128:131], v[212:215]
    ds_read_b64_tr_b16 v[246:247], v3 offset:5248
    s_waitcnt lgkmcnt(12)
    v_mfma_f32_16x16x32_bf16 v[196:199], v[252:255], v[120:123], v[196:199]
    ds_read_b64_tr_b16 v[248:249], v2 offset:10240
    v_mfma_f32_16x16x32_bf16 v[216:219], v[252:255], v[128:131], v[216:219]
    ds_read_b64_tr_b16 v[250:251], v3 offset:10240
    s_waitcnt lgkmcnt(12)
    v_mfma_f32_16x16x32_bf16 v[200:203], v[224:227], v[120:123], v[200:203]
    ds_read_b64_tr_b16 v[252:253], v2 offset:10272
    v_mfma_f32_16x16x32_bf16 v[220:223], v[224:227], v[128:131], v[220:223]
    ds_read_b64_tr_b16 v[254:255], v3 offset:10272
    s_waitcnt lgkmcnt(12)
    v_mfma_f32_16x16x32_bf16 v[184:187], v[228:231], v[124:127], v[184:187]
    ds_read_b64_tr_b16 v[224:225], v2 offset:10304
    v_mfma_f32_16x16x32_bf16 v[204:207], v[228:231], v[132:135], v[204:207]
    ds_read_b64_tr_b16 v[226:227], v3 offset:10304
    s_waitcnt lgkmcnt(12)
    v_mfma_f32_16x16x32_bf16 v[188:191], v[232:235], v[124:127], v[188:191]
    ds_read_b64_tr_b16 v[228:229], v2 offset:10336
    v_mfma_f32_16x16x32_bf16 v[208:211], v[232:235], v[132:135], v[208:211]
    ds_read_b64_tr_b16 v[230:231], v3 offset:10336
    s_waitcnt lgkmcnt(12)
    v_mfma_f32_16x16x32_bf16 v[192:195], v[236:239], v[124:127], v[192:195]
    ds_read_b64_tr_b16 v[232:233], v2 offset:10368
    v_mfma_f32_16x16x32_bf16 v[212:215], v[236:239], v[132:135], v[212:215]
    ds_read_b64_tr_b16 v[234:235], v3 offset:10368
    s_waitcnt lgkmcnt(12)
    v_mfma_f32_16x16x32_bf16 v[196:199], v[240:243], v[124:127], v[196:199]
    ds_read_b64_tr_b16 v[236:237], v2 offset:15360
    v_mfma_f32_16x16x32_bf16 v[216:219], v[240:243], v[132:135], v[216:219]
    ds_read_b64_tr_b16 v[238:239], v3 offset:15360
    s_waitcnt lgkmcnt(12)
    v_mfma_f32_16x16x32_bf16 v[200:203], v[244:247], v[124:127], v[200:203]
    ds_read_b64_tr_b16 v[240:241], v2 offset:15392
    v_mfma_f32_16x16x32_bf16 v[220:223], v[244:247], v[132:135], v[220:223]
    ds_read_b64_tr_b16 v[242:243], v3 offset:15392
    s_waitcnt lgkmcnt(12)
    v_mfma_f32_16x16x32_bf16 v[184:187], v[248:251], v[136:139], v[184:187]
    ds_read_b64_tr_b16 v[244:245], v2 offset:15424
    v_mfma_f32_16x16x32_bf16 v[204:207], v[248:251], v[144:147], v[204:207]
    ds_read_b64_tr_b16 v[246:247], v3 offset:15424
    s_waitcnt lgkmcnt(12)
    v_mfma_f32_16x16x32_bf16 v[188:191], v[252:255], v[136:139], v[188:191]
    ds_read_b64_tr_b16 v[248:249], v2 offset:15456
    v_mfma_f32_16x16x32_bf16 v[208:211], v[252:255], v[144:147], v[208:211]
    ds_read_b64_tr_b16 v[250:251], v3 offset:15456
    s_waitcnt lgkmcnt(12)
    v_mfma_f32_16x16x32_bf16 v[192:195], v[224:227], v[136:139], v[192:195]
    ds_read_b64_tr_b16 v[252:253], v2 offset:15488
    v_mfma_f32_16x16x32_bf16 v[212:215], v[224:227], v[144:147], v[212:215]
    ds_read_b64_tr_b16 v[254:255], v3 offset:15488
    s_waitcnt lgkmcnt(12)
    v_mfma_f32_16x16x32_bf16 v[196:199], v[228:231], v[136:139], v[196:199]
    ds_read_b64_tr_b16 v[224:225], v2 offset:20480
    v_mfma_f32_16x16x32_bf16 v[216:219], v[228:231], v[144:147], v[216:219]
    ds_read_b64_tr_b16 v[226:227], v3 offset:20480
    s_waitcnt lgkmcnt(12)
    v_mfma_f32_16x16x32_bf16 v[200:203], v[232:235], v[136:139], v[200:203]
    ds_read_b64_tr_b16 v[228:229], v2 offset:20512
    v_mfma_f32_16x16x32_bf16 v[220:223], v[232:235], v[144:147], v[220:223]
    ds_read_b64_tr_b16 v[230:231], v3 offset:20512
    s_waitcnt lgkmcnt(12)
    v_mfma_f32_16x16x32_bf16 v[184:187], v[236:239], v[140:143], v[184:187]
    ds_read_b64_tr_b16 v[232:233], v2 offset:20544
    v_mfma_f32_16x16x32_bf16 v[204:207], v[236:239], v[148:151], v[204:207]
    ds_read_b64_tr_b16 v[234:235], v3 offset:20544
    s_waitcnt lgkmcnt(12)
    v_mfma_f32_16x16x32_bf16 v[188:191], v[240:243], v[140:143], v[188:191]
    ds_read_b64_tr_b16 v[236:237], v2 offset:20576
    v_mfma_f32_16x16x32_bf16 v[208:211], v[240:243], v[148:151], v[208:211]
    ds_read_b64_tr_b16 v[238:239], v3 offset:20576
    s_waitcnt lgkmcnt(12)
    v_mfma_f32_16x16x32_bf16 v[192:195], v[244:247], v[140:143], v[192:195]
    ds_read_b64_tr_b16 v[240:241], v2 offset:20608
    v_mfma_f32_16x16x32_bf16 v[212:215], v[244:247], v[148:151], v[212:215]
    ds_read_b64_tr_b16 v[242:243], v3 offset:20608
    s_waitcnt lgkmcnt(12)
    v_mfma_f32_16x16x32_bf16 v[196:199], v[248:251], v[140:143], v[196:199]
    ds_read_b64_tr_b16 v[244:245], v2 offset:25600
    v_mfma_f32_16x16x32_bf16 v[216:219], v[248:251], v[148:151], v[216:219]
    ds_read_b64_tr_b16 v[246:247], v3 offset:25600
    s_waitcnt lgkmcnt(12)
    v_mfma_f32_16x16x32_bf16 v[200:203], v[252:255], v[140:143], v[200:203]
    ds_read_b64_tr_b16 v[248:249], v2 offset:25632
    v_mfma_f32_16x16x32_bf16 v[220:223], v[252:255], v[148:151], v[220:223]
    ds_read_b64_tr_b16 v[250:251], v3 offset:25632
    s_waitcnt lgkmcnt(12)
    v_mfma_f32_16x16x32_bf16 v[184:187], v[224:227], v[152:155], v[184:187]
    ds_read_b64_tr_b16 v[252:253], v2 offset:25664
    v_mfma_f32_16x16x32_bf16 v[204:207], v[224:227], v[160:163], v[204:207]
    ds_read_b64_tr_b16 v[254:255], v3 offset:25664
    s_waitcnt lgkmcnt(12)
    v_mfma_f32_16x16x32_bf16 v[188:191], v[228:231], v[152:155], v[188:191]
    s_mov_b64 exec, 2
    ds_add_u32 v0, v1 offset:160
    s_mov_b64 exec, -1
    ds_read_b64_tr_b16 v[224:225], v2 offset:25696
    v_mfma_f32_16x16x32_bf16 v[208:211], v[228:231], v[160:163], v[208:211]
    ds_read_b64_tr_b16 v[226:227], v3 offset:25696
    s_waitcnt lgkmcnt(13)
    v_mfma_f32_16x16x32_bf16 v[192:195], v[232:235], v[152:155], v[192:195]
    ds_read_b64_tr_b16 v[228:229], v2 offset:25728
    v_mfma_f32_16x16x32_bf16 v[212:215], v[232:235], v[160:163], v[212:215]
    ds_read_b64_tr_b16 v[230:231], v3 offset:25728
    s_waitcnt lgkmcnt(13)
    v_mfma_f32_16x16x32_bf16 v[196:199], v[236:239], v[152:155], v[196:199]
    ds_read_b64_tr_b16 v[232:233], v2 offset:30720
    v_mfma_f32_16x16x32_bf16 v[216:219], v[236:239], v[160:163], v[216:219]
    ds_read_b64_tr_b16 v[234:235], v3 offset:30720
    s_waitcnt lgkmcnt(13)
    v_mfma_f32_16x16x32_bf16 v[200:203], v[240:243], v[152:155], v[200:203]
    ds_read_b64_tr_b16 v[236:237], v2 offset:30752
    v_mfma_f32_16x16x32_bf16 v[220:223], v[240:243], v[160:163], v[220:223]
    ds_read_b64_tr_b16 v[238:239], v3 offset:30752
    s_waitcnt lgkmcnt(13)
    v_mfma_f32_16x16x32_bf16 v[184:187], v[244:247], v[156:159], v[184:187]
    ds_read_b64_tr_b16 v[240:241], v2 offset:30784
    v_mfma_f32_16x16x32_bf16 v[204:207], v[244:247], v[164:167], v[204:207]
    ds_read_b64_tr_b16 v[242:243], v3 offset:30784
    s_waitcnt lgkmcnt(13)
    v_mfma_f32_16x16x32_bf16 v[188:191], v[248:251], v[156:159], v[188:191]
    ds_read_b64_tr_b16 v[244:245], v2 offset:30816
    v_mfma_f32_16x16x32_bf16 v[208:211], v[248:251], v[164:167], v[208:211]
    ds_read_b64_tr_b16 v[246:247], v3 offset:30816
    s_waitcnt lgkmcnt(13)
    v_mfma_f32_16x16x32_bf16 v[192:195], v[252:255], v[156:159], v[192:195]
    ds_read_b64_tr_b16 v[248:249], v2 offset:30848
    v_mfma_f32_16x16x32_bf16 v[212:215], v[252:255], v[164:167], v[212:215]
    ds_read_b64_tr_b16 v[250:251], v3 offset:30848
    s_waitcnt lgkmcnt(12)
    v_mfma_f32_16x16x32_bf16 v[196:199], v[224:227], v[156:159], v[196:199]
    ds_read_b64_tr_b16 v[252:253], v2 offset:35840
    v_mfma_f32_16x16x32_bf16 v[216:219], v[224:227], v[164:167], v[216:219]
    ds_read_b64_tr_b16 v[254:255], v3 offset:35840
    s_waitcnt lgkmcnt(12)
    v_mfma_f32_16x16x32_bf16 v[200:203], v[228:231], v[156:159], v[200:203]
    ds_read_b64_tr_b16 v[224:225], v2 offset:35872
    v_mfma_f32_16x16x32_bf16 v[220:223], v[228:231], v[164:167], v[220:223]
    ds_read_b64_tr_b16 v[226:227], v3 offset:35872
    s_waitcnt lgkmcnt(12)
    v_mfma_f32_16x16x32_bf16 v[184:187], v[232:235], v[168:171], v[184:187]
    ds_read_b32 v10, v0 offset:160
    ds_read_b64_tr_b16 v[228:229], v2 offset:35904
    v_mfma_f32_16x16x32_bf16 v[204:207], v[232:235], v[176:179], v[204:207]
    ds_read_b64_tr_b16 v[230:231], v3 offset:35904
    s_waitcnt lgkmcnt(13)
    v_mfma_f32_16x16x32_bf16 v[188:191], v[236:239], v[168:171], v[188:191]
    ds_read_b64_tr_b16 v[232:233], v2 offset:35936
    v_mfma_f32_16x16x32_bf16 v[208:211], v[236:239], v[176:179], v[208:211]
    ds_read_b64_tr_b16 v[234:235], v3 offset:35936
    s_waitcnt lgkmcnt(13)
    v_mfma_f32_16x16x32_bf16 v[192:195], v[240:243], v[168:171], v[192:195]
    ds_read_b64_tr_b16 v[236:237], v2 offset:35968
    v_mfma_f32_16x16x32_bf16 v[212:215], v[240:243], v[176:179], v[212:215]
    ds_read_b64_tr_b16 v[238:239], v3 offset:35968
    s_waitcnt lgkmcnt(13)
    v_mfma_f32_16x16x32_bf16 v[196:199], v[244:247], v[168:171], v[196:199]
    v_mfma_f32_16x16x32_bf16 v[216:219], v[244:247], v[176:179], v[216:219]
    s_waitcnt lgkmcnt(11)
    v_mfma_f32_16x16x32_bf16 v[200:203], v[248:251], v[168:171], v[200:203]
    v_mfma_f32_16x16x32_bf16 v[220:223], v[248:251], v[176:179], v[220:223]
    s_waitcnt lgkmcnt(9)
    v_mfma_f32_16x16x32_bf16 v[184:187], v[252:255], v[172:175], v[184:187]
    v_mfma_f32_16x16x32_bf16 v[204:207], v[252:255], v[180:183], v[204:207]
    s_waitcnt lgkmcnt(7)
    v_mfma_f32_16x16x32_bf16 v[188:191], v[224:227], v[172:175], v[188:191]
    v_mfma_f32_16x16x32_bf16 v[208:211], v[224:227], v[180:183], v[208:211]
    s_waitcnt lgkmcnt(4)
    v_mfma_f32_16x16x32_bf16 v[192:195], v[228:231], v[172:175], v[192:195]
    v_mfma_f32_16x16x32_bf16 v[212:215], v[228:231], v[180:183], v[212:215]
    s_waitcnt lgkmcnt(2)
    v_mfma_f32_16x16x32_bf16 v[196:199], v[232:235], v[172:175], v[196:199]
    v_mfma_f32_16x16x32_bf16 v[216:219], v[232:235], v[180:183], v[216:219]
    s_waitcnt lgkmcnt(0)
    v_mfma_f32_16x16x32_bf16 v[200:203], v[236:239], v[172:175], v[200:203]
    v_mfma_f32_16x16x32_bf16 v[220:223], v[236:239], v[180:183], v[220:223]
    v_cmp_gt_u32 vcc, 4, v10
    s_cbranch_vccz L_17
L_18:
    ds_read_b32 v10, v0 offset:160
    s_waitcnt lgkmcnt(0)
    v_cmp_gt_u32 vcc, 4, v10
    s_cbranch_vccz L_18_d
    s_add_u32 s99, s99, 1
    s_cmp_gt_u32 s99, 0x1000000
    s_cbranch_scc1 L_18_d
    s_sleep 1
    s_branch L_18
L_18_d:
L_17:
    s_mov_b64 exec, 2
    ds_add_u32 v0, v1 offset:0
    s_mov_b64 exec, -1
    ds_read_b64_tr_b16 v[236:237], v6 offset:0
    ds_read_b64_tr_b16 v[238:239], v7 offset:0
    ds_read_b64_tr_b16 v[240:241], v6 offset:8
    ds_read_b64_tr_b16 v[242:243], v7 offset:8
    ds_read_b64_tr_b16 v[244:245], v6 offset:16
    ds_read_b64_tr_b16 v[246:247], v7 offset:16
    ds_read_b64_tr_b16 v[248:249], v6 offset:24
    ds_read_b64_tr_b16 v[250:251], v7 offset:24
    ds_read_b64_tr_b16 v[252:253], v6 offset:32
    ds_read_b64_tr_b16 v[254:255], v7 offset:32
    v_cmp_gt_u32 vcc, 32, v1
    v_mov_b32 v3, 0x3f803f80
    v_cvt_pk_bf16_f32 v228, v192, v193
    v_cvt_pk_bf16_f32 v229, v194, v195
    v_cvt_pk_bf16_f32 v224, v184, v185
    v_cvt_pk_bf16_f32 v225, v186, v187
    v_cvt_pk_bf16_f32 v226, v188, v189
    v_cvt_pk_bf16_f32 v227, v190, v191
    v_cndmask_b32 v184, v228, v3, vcc
    v_cndmask_b32 v185, v229, v3, vcc
    v_cvt_pk_bf16_f32 v186, v196, v197
    v_cvt_pk_bf16_f32 v187, v198, v199
    v_cvt_pk_bf16_f32 v188, v200, v201
    v_cvt_pk_bf16_f32 v189, v202, v203
    ds_write_b64 v8, v[184:185] offset:0
    ds_write_b64 v8, v[186:187] offset:32
    ds_write_b64 v8, v[188:189] offset:64
    s_waitcnt lgkmcnt(3)
    v_mfma_f32_16x16x16_bf16 v[200:203], v[22:23], v[228:229], 0
    v_cvt_pk_bf16_f32 v234, v212, v213
    v_cvt_pk_bf16_f32 v235, v214, v215
    v_cvt_pk_bf16_f32 v230, v204, v205
    v_mfma_f32_16x16x16_bf16 v[196:199], v[20:21], v[228:229], 0
    v_cvt_pk_bf16_f32 v231, v206, v207
    v_cvt_pk_bf16_f32 v232, v208, v209
    v_cvt_pk_bf16_f32 v233, v210, v211
    v_mfma_f32_16x16x16_bf16 v[192:195], v[18:19], v[228:229], 0
    v_cndmask_b32 v204, v234, v3, vcc
    v_cndmask_b32 v205, v235, v3, vcc
    v_cvt_pk_bf16_f32 v206, v216, v217
    v_mfma_f32_16x16x16_bf16 v[188:191], v[16:17], v[228:229], 0
    v_cvt_pk_bf16_f32 v207, v218, v219
    v_cvt_pk_bf16_f32 v208, v220, v221
    v_cvt_pk_bf16_f32 v209, v222, v223
    v_mfma_f32_16x16x16_bf16 v[184:187], v[14:15], v[228:229], 0
    ds_write_b64 v8, v[204:205] offset:1664
    ds_write_b64 v8, v[206:207] offset:1696
    ds_write_b64 v8, v[208:209] offset:1728
    v_mfma_f32_16x16x32_bf16 v[200:203], v[252:255], v[224:227], v[200:203]
    v_mfma_f32_16x16x32_bf16 v[196:199], v[248:251], v[224:227], v[196:199]
    v_mfma_f32_16x16x32_bf16 v[192:195], v[244:247], v[224:227], v[192:195]
    v_mfma_f32_16x16x32_bf16 v[188:191], v[240:243], v[224:227], v[188:191]
    s_nop 0
    v_mfma_f32_16x16x32_bf16 v[184:187], v[236:239], v[224:227], v[184:187]
    v_mfma_f32_16x16x16_bf16 v[220:223], v[22:23], v[234:235], 0
    v_mfma_f32_16x16x16_bf16 v[216:219], v[20:21], v[234:235], 0
    v_mfma_f32_16x16x16_bf16 v[212:215], v[18:19], v[234:235], 0
    v_mfma_f32_16x16x16_bf16 v[208:211], v[16:17], v[234:235], 0
    v_mfma_f32_16x16x16_bf16 v[204:207], v[14:15], v[234:235], 0
    s_nop 2
    v_max3_f32 v224, v184, v185, v186
    v_max3_f32 v225, v187, v188, v189
    v_max3_f32 v224, v224, v190, v191
    v_max3_f32 v225, v225, v192, v193
    v_mfma_f32_16x16x32_bf16 v[220:223], v[252:255], v[230:233], v[220:223]
    v_max3_f32 v224, v224, v194, v195
    v_max3_f32 v225, v225, v196, v197
    v_mfma_f32_16x16x32_bf16 v[216:219], v[248:251], v[230:233], v[216:219]
    v_max3_f32 v224, v224, v198, v199
    v_max3_f32 v225, v225, v200, v201
    v_mfma_f32_16x16x32_bf16 v[212:215], v[244:247], v[230:233], v[212:215]
    v_max3_f32 v224, v224, v202, v203
    v_max_f32 v224, v224, v225
    v_mfma_f32_16x16x32_bf16 v[208:211], v[240:243], v[230:233], v[208:211]
    v_mul_f32 v224, s41, v224
    v_pk_fma_f32 v[184:185], v[184:185], s[40:41], v[224:225] op_sel_hi:[1,0,0]
    v_mfma_f32_16x16x32_bf16 v[204:207], v[236:239], v[230:233], v[204:207]
    v_pk_fma_f32 v[186:187], v[186:187], s[40:41], v[224:225] op_sel_hi:[1,0,0]
    v_pk_fma_f32 v[188:189], v[188:189], s[40:41], v[224:225] op_sel_hi:[1,0,0]
    v_pk_fma_f32 v[190:191], v[190:191], s[40:41], v[224:225] op_sel_hi:[1,0,0]
    v_pk_fma_f32 v[192:193], v[192:193], s[40:41], v[224:225] op_sel_hi:[1,0,0]
    v_pk_fma_f32 v[194:195], v[194:195], s[40:41], v[224:225] op_sel_hi:[1,0,0]
    v_pk_fma_f32 v[196:197], v[196:197], s[40:41], v[224:225] op_sel_hi:[1,0,0]
    v_pk_fma_f32 v[198:199], v[198:199], s[40:41], v[224:225] op_sel_hi:[1,0,0]
    v_pk_fma_f32 v[200:201], v[200:201], s[40:41], v[224:225] op_sel_hi:[1,0,0]
    v_pk_fma_f32 v[202:203], v[202:203], s[40:41], v[224:225] op_sel_hi:[1,0,0]
    v_exp_f32 v184, v184
    v_exp_f32 v185, v185
    v_exp_f32 v186, v186
    v_exp_f32 v187, v187
    v_exp_f32 v188, v188
    v_exp_f32 v189, v189
    v_exp_f32 v190, v190
    v_exp_f32 v191, v191
    v_exp_f32 v192, v192
    v_exp_f32 v193, v193
    v_exp_f32 v194, v194
    v_exp_f32 v195, v195
    v_exp_f32 v196, v196
    v_exp_f32 v197, v197
    v_exp_f32 v198, v198
    v_exp_f32 v199, v199
    v_exp_f32 v200, v200
    v_exp_f32 v201, v201
    v_exp_f32 v202, v202
    v_exp_f32 v203, v203
    v_pk_add_f32 v[224:225], v[184:185], v[186:187]
    v_pk_add_f32 v[226:227], v[188:189], v[190:191]
    v_pk_add_f32 v[224:225], v[224:225], v[192:193]
    v_pk_add_f32 v[226:227], v[226:227], v[194:195]
    v_pk_add_f32 v[224:225], v[224:225], v[196:197]
    v_pk_add_f32 v[226:227], v[226:227], v[198:199]
    v_pk_add_f32 v[224:225], v[224:225], v[200:201]
    v_pk_add_f32 v[226:227], v[226:227], v[202:203]
    v_pk_add_f32 v[224:225], v[224:225], v[226:227]
    v_add_f32 v224, v224, v225
    v_rcp_f32 v224, v224
    s_nop 0
    v_pk_mul_f32 v[184:185], v[184:185], v[224:225] op_sel_hi:[1,0]
    v_pk_mul_f32 v[186:187], v[186:187], v[224:225] op_sel_hi:[1,0]
    v_pk_mul_f32 v[188:189], v[188:189], v[224:225] op_sel_hi:[1,0]
    v_pk_mul_f32 v[190:191], v[190:191], v[224:225] op_sel_hi:[1,0]
    v_pk_mul_f32 v[192:193], v[192:193], v[224:225] op_sel_hi:[1,0]
    v_pk_mul_f32 v[194:195], v[194:195], v[224:225] op_sel_hi:[1,0]
    v_pk_mul_f32 v[196:197], v[196:197], v[224:225] op_sel_hi:[1,0]
    v_pk_mul_f32 v[198:199], v[198:199], v[224:225] op_sel_hi:[1,0]
    v_pk_mul_f32 v[200:201], v[200:201], v[224:225] op_sel_hi:[1,0]
    v_pk_mul_f32 v[202:203], v[202:203], v[224:225] op_sel_hi:[1,0]
    v_cvt_pk_bf16_f32 v240, v184, v185
    v_cvt_pk_bf16_f32 v241, v186, v187
    ds_write_b64 v9, v[240:241] offset:0
    v_cvt_pk_bf16_f32 v242, v188, v189
    v_cvt_pk_bf16_f32 v243, v190, v191
    ds_write_b64 v9, v[242:243] offset:8
    v_cvt_pk_bf16_f32 v244, v192, v193
    v_cvt_pk_bf16_f32 v245, v194, v195
    ds_write_b64 v9, v[244:245] offset:16
    v_cvt_pk_bf16_f32 v246, v196, v197
    v_cvt_pk_bf16_f32 v247, v198, v199
    ds_write_b64 v9, v[246:247] offset:24
    v_cvt_pk_bf16_f32 v248, v200, v201
    v_cvt_pk_bf16_f32 v249, v202, v203
    ds_write_b64 v9, v[248:249] offset:32
    v_max3_f32 v224, v204, v205, v206
    v_max3_f32 v225, v207, v208, v209
    v_max3_f32 v224, v224, v210, v211
    v_max3_f32 v225, v225, v212, v213
    v_max3_f32 v224, v224, v214, v215
    v_max3_f32 v225, v225, v216, v217
    v_max3_f32 v224, v224, v218, v219
    v_max3_f32 v225, v225, v220, v221
    v_max3_f32 v224, v224, v222, v223
    v_max_f32 v224, v224, v225
    v_mul_f32 v224, s41, v224
    v_pk_fma_f32 v[204:205], v[204:205], s[40:41], v[224:225] op_sel_hi:[1,0,0]
    v_pk_fma_f32 v[206:207], v[206:207], s[40:41], v[224:225] op_sel_hi:[1,0,0]
    v_pk_fma_f32 v[208:209], v[208:209], s[40:41], v[224:225] op_sel_hi:[1,0,0]
    v_pk_fma_f32 v[210:211], v[210:211], s[40:41], v[224:225] op_sel_hi:[1,0,0]
    v_pk_fma_f32 v[212:213], v[212:213], s[40:41], v[224:225] op_sel_hi:[1,0,0]
    v_pk_fma_f32 v[214:215], v[214:215], s[40:41], v[224:225] op_sel_hi:[1,0,0]
    v_pk_fma_f32 v[216:217], v[216:217], s[40:41], v[224:225] op_sel_hi:[1,0,0]
    v_pk_fma_f32 v[218:219], v[218:219], s[40:41], v[224:225] op_sel_hi:[1,0,0]
    v_pk_fma_f32 v[220:221], v[220:221], s[40:41], v[224:225] op_sel_hi:[1,0,0]
    v_pk_fma_f32 v[222:223], v[222:223], s[40:41], v[224:225] op_sel_hi:[1,0,0]
    v_exp_f32 v204, v204
    v_exp_f32 v205, v205
    v_exp_f32 v206, v206
    v_exp_f32 v207, v207
    v_exp_f32 v208, v208
    v_exp_f32 v209, v209
    v_exp_f32 v210, v210
    v_exp_f32 v211, v211
    v_exp_f32 v212, v212
    v_exp_f32 v213, v213
    v_exp_f32 v214, v214
    v_exp_f32 v215, v215
    v_exp_f32 v216, v216
    v_exp_f32 v217, v217
    v_exp_f32 v218, v218
    v_exp_f32 v219, v219
    v_exp_f32 v220, v220
    v_exp_f32 v221, v221
    v_exp_f32 v222, v222
    v_exp_f32 v223, v223
    v_pk_add_f32 v[224:225], v[204:205], v[206:207]
    v_pk_add_f32 v[226:227], v[208:209], v[210:211]
    v_pk_add_f32 v[224:225], v[224:225], v[212:213]
    v_pk_add_f32 v[226:227], v[226:227], v[214:215]
    v_pk_add_f32 v[224:225], v[224:225], v[216:217]
    v_pk_add_f32 v[226:227], v[226:227], v[218:219]
    v_pk_add_f32 v[224:225], v[224:225], v[220:221]
    v_pk_add_f32 v[226:227], v[226:227], v[222:223]
    v_pk_add_f32 v[224:225], v[224:225], v[226:227]
    v_add_f32 v224, v224, v225
    v_rcp_f32 v224, v224
    s_nop 0
    v_pk_mul_f32 v[204:205], v[204:205], v[224:225] op_sel_hi:[1,0]
    v_pk_mul_f32 v[206:207], v[206:207], v[224:225] op_sel_hi:[1,0]
    v_pk_mul_f32 v[208:209], v[208:209], v[224:225] op_sel_hi:[1,0]
    v_pk_mul_f32 v[210:211], v[210:211], v[224:225] op_sel_hi:[1,0]
    v_pk_mul_f32 v[212:213], v[212:213], v[224:225] op_sel_hi:[1,0]
    v_pk_mul_f32 v[214:215], v[214:215], v[224:225] op_sel_hi:[1,0]
    v_pk_mul_f32 v[216:217], v[216:217], v[224:225] op_sel_hi:[1,0]
    v_pk_mul_f32 v[218:219], v[218:219], v[224:225] op_sel_hi:[1,0]
    v_pk_mul_f32 v[220:221], v[220:221], v[224:225] op_sel_hi:[1,0]
    v_pk_mul_f32 v[222:223], v[222:223], v[224:225] op_sel_hi:[1,0]
    v_cvt_pk_bf16_f32 v240, v204, v205
    v_cvt_pk_bf16_f32 v241, v206, v207
    ds_write_b64 v9, v[240:241] offset:2688
    v_cvt_pk_bf16_f32 v242, v208, v209
    v_cvt_pk_bf16_f32 v243, v210, v211
    ds_write_b64 v9, v[242:243] offset:2696
    v_cvt_pk_bf16_f32 v244, v212, v213
    v_cvt_pk_bf16_f32 v245, v214, v215
    ds_write_b64 v9, v[244:245] offset:2704
    v_cvt_pk_bf16_f32 v246, v216, v217
    v_cvt_pk_bf16_f32 v247, v218, v219
    ds_write_b64 v9, v[246:247] offset:2712
    v_cvt_pk_bf16_f32 v248, v220, v221
    v_cvt_pk_bf16_f32 v249, v222, v223
    s_waitcnt lgkmcnt(12)
    ds_write_b64 v9, v[248:249] offset:2720
    s_waitcnt lgkmcnt(0)
    s_barrier
    ds_read_b64_tr_b16 v[224:225], v4 offset:0
    ds_read_b64_tr_b16 v[226:227], v4 offset:80
    ds_read_b64_tr_b16 v[228:229], v4 offset:32
    ds_read_b64_tr_b16 v[230:231], v4 offset:112
    ds_read_b64_tr_b16 v[232:233], v5 offset:64
    ds_read_b64_tr_b16 v[234:235], v5 offset:144
    ds_read_b64_tr_b16 v[236:237], v4 offset:2560
    ds_read_b64_tr_b16 v[238:239], v4 offset:2640
    ds_read_b64_tr_b16 v[240:241], v4 offset:2592
    ds_read_b64_tr_b16 v[242:243], v4 offset:2672
    ds_read_b64_tr_b16 v[244:245], v5 offset:2624
    ds_read_b64_tr_b16 v[246:247], v5 offset:2704
    ds_read_b64_tr_b16 v[248:249], v4 offset:5120
    ds_read_b64_tr_b16 v[250:251], v4 offset:5200
    s_waitcnt lgkmcnt(12)
    v_mfma_f32_16x16x32_bf16 v[184:187], v[224:227], v[24:27], 0
    ds_read_b64_tr_b16 v[252:253], v4 offset:5152
    v_mfma_f32_16x16x32_bf16 v[196:199], v[224:227], v[32:35], 0
    ds_read_b64_tr_b16 v[254:255], v4 offset:5232
    s_waitcnt lgkmcnt(12)
    v_mfma_f32_16x16x32_bf16 v[188:191], v[228:231], v[24:27], 0
    ds_read_b64_tr_b16 v[224:225], v5 offset:5184
    v_mfma_f32_16x16x32_bf16 v[200:203], v[228:231], v[32:35], 0
    ds_read_b64_tr_b16 v[226:227], v5 offset:5264
    s_waitcnt lgkmcnt(12)
    v_mfma_f32_16x16x32_bf16 v[192:195], v[232:235], v[24:27], 0
    ds_read_b64_tr_b16 v[228:229], v4 offset:7680
    v_mfma_f32_16x16x32_bf16 v[204:207], v[232:235], v[32:35], 0
    ds_read_b64_tr_b16 v[230:231], v4 offset:7760
    s_waitcnt lgkmcnt(12)
    v_mfma_f32_16x16x32_bf16 v[184:187], v[236:239], v[28:31], v[184:187]
    ds_read_b64_tr_b16 v[232:233], v4 offset:7712
    v_mfma_f32_16x16x32_bf16 v[196:199], v[236:239], v[36:39], v[196:199]
    ds_read_b64_tr_b16 v[234:235], v4 offset:7792
    s_waitcnt lgkmcnt(12)
    v_mfma_f32_16x16x32_bf16 v[188:191], v[240:243], v[28:31], v[188:191]
    ds_read_b64_tr_b16 v[236:237], v5 offset:7744
    v_mfma_f32_16x16x32_bf16 v[200:203], v[240:243], v[36:39], v[200:203]
    ds_read_b64_tr_b16 v[238:239], v5 offset:7824
    s_waitcnt lgkmcnt(12)
    v_mfma_f32_16x16x32_bf16 v[192:195], v[244:247], v[28:31], v[192:195]
    ds_read_b64_tr_b16 v[240:241], v4 offset:10240
    v_mfma_f32_16x16x32_bf16 v[204:207], v[244:247], v[36:39], v[204:207]
    ds_read_b64_tr_b16 v[242:243], v4 offset:10320
    s_waitcnt lgkmcnt(12)
    v_mfma_f32_16x16x32_bf16 v[184:187], v[248:251], v[40:43], v[184:187]
    ds_read_b64_tr_b16 v[244:245], v4 offset:10272
    v_mfma_f32_16x16x32_bf16 v[196:199], v[248:251], v[48:51], v[196:199]
    ds_read_b64_tr_b16 v[246:247], v4 offset:10352
    s_waitcnt lgkmcnt(12)
    v_mfma_f32_16x16x32_bf16 v[188:191], v[252:255], v[40:43], v[188:191]
    ds_read_b64_tr_b16 v[248:249], v5 offset:10304
    v_mfma_f32_16x16x32_bf16 v[200:203], v[252:255], v[48:51], v[200:203]
    ds_read_b64_tr_b16 v[250:251], v5 offset:10384
    s_waitcnt lgkmcnt(12)
    v_mfma_f32_16x16x32_bf16 v[192:195], v[224:227], v[40:43], v[192:195]
    ds_read_b64_tr_b16 v[252:253], v4 offset:12800
    v_mfma_f32_16x16x32_bf16 v[204:207], v[224:227], v[48:51], v[204:207]
    ds_read_b64_tr_b16 v[254:255], v4 offset:12880
    s_waitcnt lgkmcnt(12)
    v_mfma_f32_16x16x32_bf16 v[184:187], v[228:231], v[44:47], v[184:187]
    ds_read_b64_tr_b16 v[224:225], v4 offset:12832
    v_mfma_f32_16x16x32_bf16 v[196:199], v[228:231], v[52:55], v[196:199]
    ds_read_b64_tr_b16 v[226:227], v4 offset:12912
    s_waitcnt lgkmcnt(12)
    v_mfma_f32_16x16x32_bf16 v[188:191], v[232:235], v[44:47], v[188:191]
    ds_read_b64_tr_b16 v[228:229], v5 offset:12864
    v_mfma_f32_16x16x32_bf16 v[200:203], v[232:235], v[52:55], v[200:203]
    ds_read_b64_tr_b16 v[230:231], v5 offset:12944
    s_waitcnt lgkmcnt(12)
    v_mfma_f32_16x16x32_bf16 v[192:195], v[236:239], v[44:47], v[192:195]
    ds_read_b64_tr_b16 v[232:233], v4 offset:15360
    v_mfma_f32_16x16x32_bf16 v[204:207], v[236:239], v[52:55], v[204:207]
    ds_read_b64_tr_b16 v[234:235], v4 offset:15440
    s_waitcnt lgkmcnt(12)
    v_mfma_f32_16x16x32_bf16 v[184:187], v[240:243], v[56:59], v[184:187]
    ds_read_b64_tr_b16 v[236:237], v4 offset:15392
    v_mfma_f32_16x16x32_bf16 v[196:199], v[240:243], v[64:67], v[196:199]
    ds_read_b64_tr_b16 v[238:239], v4 offset:15472
    s_waitcnt lgkmcnt(12)
    v_mfma_f32_16x16x32_bf16 v[188:191], v[244:247], v[56:59], v[188:191]
    ds_read_b64_tr_b16 v[240:241], v5 offset:15424
    v_mfma_f32_16x16x32_bf16 v[200:203], v[244:247], v[64:67], v[200:203]
    ds_read_b64_tr_b16 v[242:243], v5 offset:15504
    s_waitcnt lgkmcnt(12)
    v_mfma_f32_16x16x32_bf16 v[192:195], v[248:251], v[56:59], v[192:195]
    ds_read_b64_tr_b16 v[244:245], v4 offset:17920
    v_mfma_f32_16x16x32_bf16 v[204:207], v[248:251], v[64:67], v[204:207]
    ds_read_b64_tr_b16 v[246:247], v4 offset:18000
    s_waitcnt lgkmcnt(12)
    v_mfma_f32_16x16x32_bf16 v[184:187], v[252:255], v[60:63], v[184:187]
    ds_read_b64_tr_b16 v[248:249], v4 offset:17952
    v_mfma_f32_16x16x32_bf16 v[196:199], v[252:255], v[68:71], v[196:199]
    ds_read_b64_tr_b16 v[250:251], v4 offset:18032
    s_waitcnt lgkmcnt(12)
    v_mfma_f32_16x16x32_bf16 v[188:191], v[224:227], v[60:63], v[188:191]
    ds_read_b64_tr_b16 v[252:253], v5 offset:17984
    v_mfma_f32_16x16x32_bf16 v[200:203], v[224:227], v[68:71], v[200:203]
    ds_read_b64_tr_b16 v[254:255], v5 offset:18064
    s_waitcnt lgkmcnt(12)
    v_mfma_f32_16x16x32_bf16 v[192:195], v[228:231], v[60:63], v[192:195]
    ds_read_b64_tr_b16 v[224:225], v4 offset:20480
    v_mfma_f32_16x16x32_bf16 v[204:207], v[228:231], v[68:71], v[204:207]
    ds_read_b64_tr_b16 v[226:227], v4 offset:20560
    s_waitcnt lgkmcnt(12)
    v_mfma_f32_16x16x32_bf16 v[184:187], v[232:235], v[72:75], v[184:187]
    ds_read_b64_tr_b16 v[228:229], v4 offset:20512
    v_mfma_f32_16x16x32_bf16 v[196:199], v[232:235], v[80:83], v[196:199]
    ds_read_b64_tr_b16 v[230:231], v4 offset:20592
    s_waitcnt lgkmcnt(12)
    v_mfma_f32_16x16x32_bf16 v[188:191], v[236:239], v[72:75], v[188:191]
    ds_read_b64_tr_b16 v[232:233], v5 offset:20544
    v_mfma_f32_16x16x32_bf16 v[200:203], v[236:239], v[80:83], v[200:203]
    ds_read_b64_tr_b16 v[234:235], v5 offset:20624
    s_waitcnt lgkmcnt(12)
    v_mfma_f32_16x16x32_bf16 v[192:195], v[240:243], v[72:75], v[192:195]
    ds_read_b64_tr_b16 v[236:237], v4 offset:23040
    v_mfma_f32_16x16x32_bf16 v[204:207], v[240:243], v[80:83], v[204:207]
    ds_read_b64_tr_b16 v[238:239], v4 offset:23120
    s_waitcnt lgkmcnt(12)
    v_mfma_f32_16x16x32_bf16 v[184:187], v[244:247], v[76:79], v[184:187]
    ds_read_b64_tr_b16 v[240:241], v4 offset:23072
    v_mfma_f32_16x16x32_bf16 v[196:199], v[244:247], v[84:87], v[196:199]
    ds_read_b64_tr_b16 v[242:243], v4 offset:23152
    s_waitcnt lgkmcnt(12)
    v_mfma_f32_16x16x32_bf16 v[188:191], v[248:251], v[76:79], v[188:191]
    ds_read_b64_tr_b16 v[244:245], v5 offset:23104
    v_mfma_f32_16x16x32_bf16 v[200:203], v[248:251], v[84:87], v[200:203]
    ds_read_b64_tr_b16 v[246:247], v5 offset:23184
    s_waitcnt lgkmcnt(12)
    v_mfma_f32_16x16x32_bf16 v[192:195], v[252:255], v[76:79], v[192:195]
    ds_read_b64_tr_b16 v[248:249], v4 offset:25600
    v_mfma_f32_16x16x32_bf16 v[204:207], v[252:255], v[84:87], v[204:207]
    ds_read_b64_tr_b16 v[250:251], v4 offset:25680
    s_waitcnt lgkmcnt(12)
    v_mfma_f32_16x16x32_bf16 v[184:187], v[224:227], v[88:91], v[184:187]
    ds_read_b64_tr_b16 v[252:253], v4 offset:25632
    v_mfma_f32_16x16x32_bf16 v[196:199], v[224:227], v[96:99], v[196:199]
    ds_read_b64_tr_b16 v[254:255], v4 offset:25712
    s_waitcnt lgkmcnt(12)
    v_mfma_f32_16x16x32_bf16 v[188:191], v[228:231], v[88:91], v[188:191]
    ds_read_b64_tr_b16 v[224:225], v5 offset:25664
    v_mfma_f32_16x16x32_bf16 v[200:203], v[228:231], v[96:99], v[200:203]
    ds_read_b64_tr_b16 v[226:227], v5 offset:25744
    s_waitcnt lgkmcnt(12)
    v_mfma_f32_16x16x32_bf16 v[192:195], v[232:235], v[88:91], v[192:195]
    ds_read_b64_tr_b16 v[228:229], v4 offset:28160
    v_mfma_f32_16x16x32_bf16 v[204:207], v[232:235], v[96:99], v[204:207]
    ds_read_b64_tr_b16 v[230:231], v4 offset:28240
    s_waitcnt lgkmcnt(12)
    v_mfma_f32_16x16x32_bf16 v[184:187], v[236:239], v[92:95], v[184:187]
    ds_read_b64_tr_b16 v[232:233], v4 offset:28192
    v_mfma_f32_16x16x32_bf16 v[196:199], v[236:239], v[100:103], v[196:199]
    ds_read_b64_tr_b16 v[234:235], v4 offset:28272
    s_waitcnt lgkmcnt(12)
    v_mfma_f32_16x16x32_bf16 v[188:191], v[240:243], v[92:95], v[188:191]
    ds_read_b64_tr_b16 v[236:237], v5 offset:28224
    v_mfma_f32_16x16x32_bf16 v[200:203], v[240:243], v[100:103], v[200:203]
    ds_read_b64_tr_b16 v[238:239], v5 offset:28304
    s_waitcnt lgkmcnt(12)
    v_mfma_f32_16x16x32_bf16 v[192:195], v[244:247], v[92:95], v[192:195]
    ds_read_b64_tr_b16 v[240:241], v4 offset:30720
    v_mfma_f32_16x16x32_bf16 v[204:207], v[244:247], v[100:103], v[204:207]
    ds_read_b64_tr_b16 v[242:243], v4 offset:30800
    s_waitcnt lgkmcnt(12)
    v_mfma_f32_16x16x32_bf16 v[184:187], v[248:251], v[104:107], v[184:187]
    ds_read_b64_tr_b16 v[244:245], v4 offset:30752
    v_mfma_f32_16x16x32_bf16 v[196:199], v[248:251], v[112:115], v[196:199]
    ds_read_b64_tr_b16 v[246:247], v4 offset:30832
    s_waitcnt lgkmcnt(12)
    v_mfma_f32_16x16x32_bf16 v[188:191], v[252:255], v[104:107], v[188:191]
    ds_read_b64_tr_b16 v[248:249], v5 offset:30784
    v_mfma_f32_16x16x32_bf16 v[200:203], v[252:255], v[112:115], v[200:203]
    ds_read_b64_tr_b16 v[250:251], v5 offset:30864
    s_waitcnt lgkmcnt(12)
    v_mfma_f32_16x16x32_bf16 v[192:195], v[224:227], v[104:107], v[192:195]
    ds_read_b64_tr_b16 v[252:253], v4 offset:33280
    v_mfma_f32_16x16x32_bf16 v[204:207], v[224:227], v[112:115], v[204:207]
    ds_read_b64_tr_b16 v[254:255], v4 offset:33360
    s_waitcnt lgkmcnt(12)
    v_mfma_f32_16x16x32_bf16 v[184:187], v[228:231], v[108:111], v[184:187]
    ds_read_b64_tr_b16 v[224:225], v4 offset:33312
    v_mfma_f32_16x16x32_bf16 v[196:199], v[228:231], v[116:119], v[196:199]
    ds_read_b64_tr_b16 v[226:227], v4 offset:33392
    s_waitcnt lgkmcnt(12)
    v_mfma_f32_16x16x32_bf16 v[188:191], v[232:235], v[108:111], v[188:191]
    ds_read_b64_tr_b16 v[228:229], v5 offset:33344
    v_mfma_f32_16x16x32_bf16 v[200:203], v[232:235], v[116:119], v[200:203]
    ds_read_b64_tr_b16 v[230:231], v5 offset:33424
    s_waitcnt lgkmcnt(12)
    v_mfma_f32_16x16x32_bf16 v[192:195], v[236:239], v[108:111], v[192:195]
    ds_read_b64_tr_b16 v[232:233], v4 offset:35840
    v_mfma_f32_16x16x32_bf16 v[204:207], v[236:239], v[116:119], v[204:207]
    ds_read_b64_tr_b16 v[234:235], v4 offset:35920
    s_waitcnt lgkmcnt(12)
    v_mfma_f32_16x16x32_bf16 v[184:187], v[240:243], v[120:123], v[184:187]
    ds_read_b64_tr_b16 v[236:237], v4 offset:35872
    v_mfma_f32_16x16x32_bf16 v[196:199], v[240:243], v[128:131], v[196:199]
    ds_read_b64_tr_b16 v[238:239], v4 offset:35952
    s_waitcnt lgkmcnt(12)
    v_mfma_f32_16x16x32_bf16 v[188:191], v[244:247], v[120:123], v[188:191]
    ds_read_b64_tr_b16 v[240:241], v5 offset:35904
    v_mfma_f32_16x16x32_bf16 v[200:203], v[244:247], v[128:131], v[200:203]
    ds_read_b64_tr_b16 v[242:243], v5 offset:35984
    s_waitcnt lgkmcnt(12)
    v_mfma_f32_16x16x32_bf16 v[192:195], v[248:251], v[120:123], v[192:195]
    ds_read_b64_tr_b16 v[244:245], v4 offset:38400
    v_mfma_f32_16x16x32_bf16 v[204:207], v[248:251], v[128:131], v[204:207]
    ds_read_b64_tr_b16 v[246:247], v4 offset:38480
    s_waitcnt lgkmcnt(12)
    v_mfma_f32_16x16x32_bf16 v[184:187], v[252:255], v[124:127], v[184:187]
    ds_read_b64_tr_b16 v[248:249], v4 offset:38432
    v_mfma_f32_16x16x32_bf16 v[196:199], v[252:255], v[132:135], v[196:199]
    ds_read_b64_tr_b16 v[250:251], v4 offset:38512
    s_waitcnt lgkmcnt(12)
    v_mfma_f32_16x16x32_bf16 v[188:191], v[224:227], v[124:127], v[188:191]
    ds_read_b64_tr_b16 v[252:253], v5 offset:38464
    v_mfma_f32_16x16x32_bf16 v[200:203], v[224:227], v[132:135], v[200:203]
    ds_read_b64_tr_b16 v[254:255], v5 offset:38544
    s_waitcnt lgkmcnt(12)
    v_mfma_f32_16x16x32_bf16 v[192:195], v[228:231], v[124:127], v[192:195]
    ds_read_b64_tr_b16 v[224:225], v4 offset:40960
    v_mfma_f32_16x16x32_bf16 v[204:207], v[228:231], v[132:135], v[204:207]
    ds_read_b64_tr_b16 v[226:227], v4 offset:41040
    s_waitcnt lgkmcnt(12)
    v_mfma_f32_16x16x32_bf16 v[184:187], v[232:235], v[136:139], v[184:187]
    ds_read_b64_tr_b16 v[228:229], v4 offset:40992
    v_mfma_f32_16x16x32_bf16 v[196:199], v[232:235], v[144:147], v[196:199]
    ds_read_b64_tr_b16 v[230:231], v4 offset:41072
    s_waitcnt lgkmcnt(12)
    v_mfma_f32_16x16x32_bf16 v[188:191], v[236:239], v[136:139], v[188:191]
    ds_read_b64_tr_b16 v[232:233], v5 offset:41024
    v_mfma_f32_16x16x32_bf16 v[200:203], v[236:239], v[144:147], v[200:203]
    ds_read_b64_tr_b16 v[234:235], v5 offset:41104
    s_waitcnt lgkmcnt(12)
    v_mfma_f32_16x16x32_bf16 v[192:195], v[240:243], v[136:139], v[192:195]
    ds_read_b64_tr_b16 v[236:237], v4 offset:43520
    v_mfma_f32_16x16x32_bf16 v[204:207], v[240:243], v[144:147], v[204:207]
    ds_read_b64_tr_b16 v[238:239], v4 offset:43600
    s_waitcnt lgkmcnt(12)
    v_mfma_f32_16x16x32_bf16 v[184:187], v[244:247], v[140:143], v[184:187]
    ds_read_b64_tr_b16 v[240:241], v4 offset:43552
    v_mfma_f32_16x16x32_bf16 v[196:199], v[244:247], v[148:151], v[196:199]
    ds_read_b64_tr_b16 v[242:243], v4 offset:43632
    s_waitcnt lgkmcnt(12)
    v_mfma_f32_16x16x32_bf16 v[188:191], v[248:251], v[140:143], v[188:191]
    ds_read_b64_tr_b16 v[244:245], v5 offset:43584
    v_mfma_f32_16x16x32_bf16 v[200:203], v[248:251], v[148:151], v[200:203]
    ds_read_b64_tr_b16 v[246:247], v5 offset:43664
    s_waitcnt lgkmcnt(12)
    v_mfma_f32_16x16x32_bf16 v[192:195], v[252:255], v[140:143], v[192:195]
    ds_read_b64_tr_b16 v[248:249], v4 offset:46080
    v_mfma_f32_16x16x32_bf16 v[204:207], v[252:255], v[148:151], v[204:207]
    ds_read_b64_tr_b16 v[250:251], v4 offset:46160
    s_waitcnt lgkmcnt(12)
    v_mfma_f32_16x16x32_bf16 v[184:187], v[224:227], v[152:155], v[184:187]
    ds_read_b64_tr_b16 v[252:253], v4 offset:46112
    v_mfma_f32_16x16x32_bf16 v[196:199], v[224:227], v[160:163], v[196:199]
    ds_read_b64_tr_b16 v[254:255], v4 offset:46192
    s_waitcnt lgkmcnt(12)
    v_mfma_f32_16x16x32_bf16 v[188:191], v[228:231], v[152:155], v[188:191]
    ds_read_b64_tr_b16 v[224:225], v5 offset:46144
    v_mfma_f32_16x16x32_bf16 v[200:203], v[228:231], v[160:163], v[200:203]
    ds_read_b64_tr_b16 v[226:227], v5 offset:46224
    s_waitcnt lgkmcnt(12)
    v_mfma_f32_16x16x32_bf16 v[192:195], v[232:235], v[152:155], v[192:195]
    ds_read_b64_tr_b16 v[228:229], v4 offset:48640
    v_mfma_f32_16x16x32_bf16 v[204:207], v[232:235], v[160:163], v[204:207]
    ds_read_b64_tr_b16 v[230:231], v4 offset:48720
    s_waitcnt lgkmcnt(12)
    v_mfma_f32_16x16x32_bf16 v[184:187], v[236:239], v[156:159], v[184:187]
    ds_read_b64_tr_b16 v[232:233], v4 offset:48672
    v_mfma_f32_16x16x32_bf16 v[196:199], v[236:239], v[164:167], v[196:199]
    ds_read_b64_tr_b16 v[234:235], v4 offset:48752
    s_waitcnt lgkmcnt(12)
    v_mfma_f32_16x16x32_bf16 v[188:191], v[240:243], v[156:159], v[188:191]
    ds_read_b64_tr_b16 v[236:237], v5 offset:48704
    v_mfma_f32_16x16x32_bf16 v[200:203], v[240:243], v[164:167], v[200:203]
    ds_read_b64_tr_b16 v[238:239], v5 offset:48784
    s_waitcnt lgkmcnt(12)
    v_mfma_f32_16x16x32_bf16 v[192:195], v[244:247], v[156:159], v[192:195]
    v_mfma_f32_16x16x32_bf16 v[204:207], v[244:247], v[164:167], v[204:207]
    s_waitcnt lgkmcnt(10)
    v_mfma_f32_16x16x32_bf16 v[184:187], v[248:251], v[168:171], v[184:187]
    v_mfma_f32_16x16x32_bf16 v[196:199], v[248:251], v[176:179], v[196:199]
    s_waitcnt lgkmcnt(8)
    v_mfma_f32_16x16x32_bf16 v[188:191], v[252:255], v[168:171], v[188:191]
    v_mfma_f32_16x16x32_bf16 v[200:203], v[252:255], v[176:179], v[200:203]
    s_waitcnt lgkmcnt(6)
    v_mfma_f32_16x16x32_bf16 v[192:195], v[224:227], v[168:171], v[192:195]
    v_mfma_f32_16x16x32_bf16 v[204:207], v[224:227], v[176:179], v[204:207]
    s_waitcnt lgkmcnt(4)
    v_mfma_f32_16x16x32_bf16 v[184:187], v[228:231], v[172:175], v[184:187]
    v_mfma_f32_16x16x32_bf16 v[196:199], v[228:231], v[180:183], v[196:199]
    s_waitcnt lgkmcnt(2)
    v_mfma_f32_16x16x32_bf16 v[188:191], v[232:235], v[172:175], v[188:191]
    v_mfma_f32_16x16x32_bf16 v[200:203], v[232:235], v[180:183], v[200:203]
    s_waitcnt lgkmcnt(0)
    v_mfma_f32_16x16x32_bf16 v[192:195], v[236:239], v[172:175], v[192:195]
    v_mfma_f32_16x16x32_bf16 v[204:207], v[236:239], v[180:183], v[204:207]
    s_mov_b64 exec, 2
    ds_add_u32 v0, v1 offset:8
    s_mov_b64 exec, -1
    v_add_u32 v2, 162688, v13
    ds_read_b32 v10, v2
    ds_read_b64_tr_b16 v[24:25], v6 offset:0
    ds_read_b64_tr_b16 v[26:27], v7 offset:0
    ds_read_b64_tr_b16 v[28:29], v6 offset:8
    ds_read_b64_tr_b16 v[30:31], v7 offset:8
    ds_read_b64_tr_b16 v[32:33], v6 offset:16
    ds_read_b64_tr_b16 v[34:35], v7 offset:16
    ds_read_b64_tr_b16 v[36:37], v6 offset:24
    ds_read_b64_tr_b16 v[38:39], v7 offset:24
    ds_read_b64_tr_b16 v[40:41], v6 offset:32
    ds_read_b64_tr_b16 v[42:43], v7 offset:32
    v_cvt_pk_bf16_f32 v48, v192, v193
    v_cvt_pk_bf16_f32 v49, v194, v195
    v_cvt_pk_bf16_f32 v44, v184, v185
    v_cvt_pk_bf16_f32 v45, v186, v187
    v_cvt_pk_bf16_f32 v46, v188, v189
    v_cvt_pk_bf16_f32 v47, v190, v191
    v_mfma_f32_16x16x16_bf16 v[72:75], v[22:23], v[48:49], 0
    v_cvt_pk_bf16_f32 v54, v204, v205
    v_cvt_pk_bf16_f32 v55, v206, v207
    v_mfma_f32_16x16x16_bf16 v[68:71], v[20:21], v[48:49], 0
    v_cvt_pk_bf16_f32 v50, v196, v197
    v_cvt_pk_bf16_f32 v51, v198, v199
    v_mfma_f32_16x16x16_bf16 v[64:67], v[18:19], v[48:49], 0
    v_cvt_pk_bf16_f32 v52, v200, v201
    v_cvt_pk_bf16_f32 v53, v202, v203
    v_mfma_f32_16x16x16_bf16 v[60:63], v[16:17], v[48:49], 0
    v_mfma_f32_16x16x16_bf16 v[56:59], v[14:15], v[48:49], 0
    s_waitcnt lgkmcnt(0)
    v_mfma_f32_16x16x32_bf16 v[72:75], v[40:43], v[44:47], v[72:75]
    v_mfma_f32_16x16x32_bf16 v[68:71], v[36:39], v[44:47], v[68:71]
    s_nop 0
    v_mfma_f32_16x16x32_bf16 v[64:67], v[32:35], v[44:47], v[64:67]
    s_nop 1
    v_mfma_f32_16x16x32_bf16 v[60:63], v[28:31], v[44:47], v[60:63]
    v_mfma_f32_16x16x32_bf16 v[56:59], v[24:27], v[44:47], v[56:59]
    v_mfma_f32_16x16x16_bf16 v[92:95], v[22:23], v[54:55], 0
    v_mfma_f32_16x16x16_bf16 v[88:91], v[20:21], v[54:55], 0
    v_mfma_f32_16x16x16_bf16 v[84:87], v[18:19], v[54:55], 0
    v_mfma_f32_16x16x16_bf16 v[80:83], v[16:17], v[54:55], 0
    v_mfma_f32_16x16x16_bf16 v[76:79], v[14:15], v[54:55], 0
    s_nop 2
    v_max3_f32 v116, v56, v57, v58
    v_max3_f32 v117, v59, v60, v61
    v_max3_f32 v116, v116, v62, v63
    v_max3_f32 v117, v117, v64, v65
    v_mfma_f32_16x16x32_bf16 v[92:95], v[40:43], v[50:53], v[92:95]
    v_max3_f32 v116, v116, v66, v67
    v_max3_f32 v117, v117, v68, v69
    v_mfma_f32_16x16x32_bf16 v[88:91], v[36:39], v[50:53], v[88:91]
    v_max3_f32 v116, v116, v70, v71
    v_max3_f32 v117, v117, v72, v73
    v_mfma_f32_16x16x32_bf16 v[84:87], v[32:35], v[50:53], v[84:87]
    v_max3_f32 v116, v116, v74, v75
    v_max_f32 v116, v116, v117
    v_mfma_f32_16x16x32_bf16 v[80:83], v[28:31], v[50:53], v[80:83]
    v_mul_f32 v116, s41, v116
    v_pk_fma_f32 v[56:57], v[56:57], s[40:41], v[116:117] op_sel_hi:[1,0,0]
    v_mfma_f32_16x16x32_bf16 v[76:79], v[24:27], v[50:53], v[76:79]
    v_pk_fma_f32 v[58:59], v[58:59], s[40:41], v[116:117] op_sel_hi:[1,0,0]
    v_pk_fma_f32 v[60:61], v[60:61], s[40:41], v[116:117] op_sel_hi:[1,0,0]
    v_pk_fma_f32 v[62:63], v[62:63], s[40:41], v[116:117] op_sel_hi:[1,0,0]
    v_pk_fma_f32 v[64:65], v[64:65], s[40:41], v[116:117] op_sel_hi:[1,0,0]
    v_pk_fma_f32 v[66:67], v[66:67], s[40:41], v[116:117] op_sel_hi:[1,0,0]
    v_pk_fma_f32 v[68:69], v[68:69], s[40:41], v[116:117] op_sel_hi:[1,0,0]
    v_pk_fma_f32 v[70:71], v[70:71], s[40:41], v[116:117] op_sel_hi:[1,0,0]
    v_pk_fma_f32 v[72:73], v[72:73], s[40:41], v[116:117] op_sel_hi:[1,0,0]
    v_pk_fma_f32 v[74:75], v[74:75], s[40:41], v[116:117] op_sel_hi:[1,0,0]
    v_exp_f32 v56, v56
    v_exp_f32 v57, v57
    v_exp_f32 v58, v58
    v_exp_f32 v59, v59
    v_exp_f32 v60, v60
    v_exp_f32 v61, v61
    v_exp_f32 v62, v62
    v_exp_f32 v63, v63
    v_exp_f32 v64, v64
    v_exp_f32 v65, v65
    v_exp_f32 v66, v66
    v_exp_f32 v67, v67
    v_exp_f32 v68, v68
    v_exp_f32 v69, v69
    v_exp_f32 v70, v70
    v_exp_f32 v71, v71
    v_exp_f32 v72, v72
    v_exp_f32 v73, v73
    v_exp_f32 v74, v74
    v_exp_f32 v75, v75
    v_pk_add_f32 v[116:117], v[56:57], v[58:59]
    v_pk_add_f32 v[118:119], v[60:61], v[62:63]
    v_pk_add_f32 v[116:117], v[116:117], v[64:65]
    v_pk_add_f32 v[118:119], v[118:119], v[66:67]
    v_pk_add_f32 v[116:117], v[116:117], v[68:69]
    v_pk_add_f32 v[118:119], v[118:119], v[70:71]
    v_pk_add_f32 v[116:117], v[116:117], v[72:73]
    v_pk_add_f32 v[118:119], v[118:119], v[74:75]
    v_pk_add_f32 v[116:117], v[116:117], v[118:119]
    v_add_f32 v116, v116, v117
    v_rcp_f32 v116, v116
    s_nop 0
    v_pk_mul_f32 v[56:57], v[56:57], v[116:117] op_sel_hi:[1,0]
    v_pk_mul_f32 v[58:59], v[58:59], v[116:117] op_sel_hi:[1,0]
    v_pk_mul_f32 v[60:61], v[60:61], v[116:117] op_sel_hi:[1,0]
    v_pk_mul_f32 v[62:63], v[62:63], v[116:117] op_sel_hi:[1,0]
    v_pk_mul_f32 v[64:65], v[64:65], v[116:117] op_sel_hi:[1,0]
    v_pk_mul_f32 v[66:67], v[66:67], v[116:117] op_sel_hi:[1,0]
    v_pk_mul_f32 v[68:69], v[68:69], v[116:117] op_sel_hi:[1,0]
    v_pk_mul_f32 v[70:71], v[70:71], v[116:117] op_sel_hi:[1,0]
    v_pk_mul_f32 v[72:73], v[72:73], v[116:117] op_sel_hi:[1,0]
    v_pk_mul_f32 v[74:75], v[74:75], v[116:117] op_sel_hi:[1,0]
    v_cvt_pk_bf16_f32 v96, v56, v57
    v_cvt_pk_bf16_f32 v97, v58, v59
    v_cvt_pk_bf16_f32 v98, v60, v61
    v_cvt_pk_bf16_f32 v99, v62, v63
    v_cvt_pk_bf16_f32 v100, v64, v65
    v_cvt_pk_bf16_f32 v101, v66, v67
    v_cvt_pk_bf16_f32 v102, v68, v69
    v_cvt_pk_bf16_f32 v103, v70, v71
    v_cvt_pk_bf16_f32 v104, v72, v73
    v_cvt_pk_bf16_f32 v105, v74, v75
    v_max3_f32 v116, v76, v77, v78
    v_max3_f32 v117, v79, v80, v81
    v_max3_f32 v116, v116, v82, v83
    v_max3_f32 v117, v117, v84, v85
    v_max3_f32 v116, v116, v86, v87
    v_max3_f32 v117, v117, v88, v89
    v_max3_f32 v116, v116, v90, v91
    v_max3_f32 v117, v117, v92, v93
    v_max3_f32 v116, v116, v94, v95
    v_max_f32 v116, v116, v117
    v_mul_f32 v116, s41, v116
    v_pk_fma_f32 v[76:77], v[76:77], s[40:41], v[116:117] op_sel_hi:[1,0,0]
    v_pk_fma_f32 v[78:79], v[78:79], s[40:41], v[116:117] op_sel_hi:[1,0,0]
    v_pk_fma_f32 v[80:81], v[80:81], s[40:41], v[116:117] op_sel_hi:[1,0,0]
    v_pk_fma_f32 v[82:83], v[82:83], s[40:41], v[116:117] op_sel_hi:[1,0,0]
    v_pk_fma_f32 v[84:85], v[84:85], s[40:41], v[116:117] op_sel_hi:[1,0,0]
    v_pk_fma_f32 v[86:87], v[86:87], s[40:41], v[116:117] op_sel_hi:[1,0,0]
    v_pk_fma_f32 v[88:89], v[88:89], s[40:41], v[116:117] op_sel_hi:[1,0,0]
    v_pk_fma_f32 v[90:91], v[90:91], s[40:41], v[116:117] op_sel_hi:[1,0,0]
    v_pk_fma_f32 v[92:93], v[92:93], s[40:41], v[116:117] op_sel_hi:[1,0,0]
    v_pk_fma_f32 v[94:95], v[94:95], s[40:41], v[116:117] op_sel_hi:[1,0,0]
    v_exp_f32 v76, v76
    v_exp_f32 v77, v77
    v_exp_f32 v78, v78
    v_exp_f32 v79, v79
    v_exp_f32 v80, v80
    v_exp_f32 v81, v81
    v_exp_f32 v82, v82
    v_exp_f32 v83, v83
    v_exp_f32 v84, v84
    v_exp_f32 v85, v85
    v_exp_f32 v86, v86
    v_exp_f32 v87, v87
    v_exp_f32 v88, v88
    v_exp_f32 v89, v89
    v_exp_f32 v90, v90
    v_exp_f32 v91, v91
    v_exp_f32 v92, v92
    v_exp_f32 v93, v93
    v_exp_f32 v94, v94
    v_exp_f32 v95, v95
    v_pk_add_f32 v[116:117], v[76:77], v[78:79]
    v_pk_add_f32 v[118:119], v[80:81], v[82:83]
    v_pk_add_f32 v[116:117], v[116:117], v[84:85]
    v_pk_add_f32 v[118:119], v[118:119], v[86:87]
    v_pk_add_f32 v[116:117], v[116:117], v[88:89]
    v_pk_add_f32 v[118:119], v[118:119], v[90:91]
    v_pk_add_f32 v[116:117], v[116:117], v[92:93]
    v_pk_add_f32 v[118:119], v[118:119], v[94:95]
    v_pk_add_f32 v[116:117], v[116:117], v[118:119]
    v_add_f32 v116, v116, v117
    v_rcp_f32 v116, v116
    s_nop 0
    v_pk_mul_f32 v[76:77], v[76:77], v[116:117] op_sel_hi:[1,0]
    v_pk_mul_f32 v[78:79], v[78:79], v[116:117] op_sel_hi:[1,0]
    v_pk_mul_f32 v[80:81], v[80:81], v[116:117] op_sel_hi:[1,0]
    v_pk_mul_f32 v[82:83], v[82:83], v[116:117] op_sel_hi:[1,0]
    v_pk_mul_f32 v[84:85], v[84:85], v[116:117] op_sel_hi:[1,0]
    v_pk_mul_f32 v[86:87], v[86:87], v[116:117] op_sel_hi:[1,0]
    v_pk_mul_f32 v[88:89], v[88:89], v[116:117] op_sel_hi:[1,0]
    v_pk_mul_f32 v[90:91], v[90:91], v[116:117] op_sel_hi:[1,0]
    v_pk_mul_f32 v[92:93], v[92:93], v[116:117] op_sel_hi:[1,0]
    v_pk_mul_f32 v[94:95], v[94:95], v[116:117] op_sel_hi:[1,0]
    v_cvt_pk_bf16_f32 v106, v76, v77
    v_cvt_pk_bf16_f32 v107, v78, v79
    v_cvt_pk_bf16_f32 v108, v80, v81
    v_cvt_pk_bf16_f32 v109, v82, v83
    v_cvt_pk_bf16_f32 v110, v84, v85
    v_cvt_pk_bf16_f32 v111, v86, v87
    v_cvt_pk_bf16_f32 v112, v88, v89
    v_cvt_pk_bf16_f32 v113, v90, v91
    v_cvt_pk_bf16_f32 v114, v92, v93
    v_cvt_pk_bf16_f32 v115, v94, v95
    s_mul_i32 s60, s51, 2560
    s_add_u32 s60, s60, s64
    s_add_u32 s60, s60, 0
    v_and_b32 v26, 15, v1
    v_lshrrev_b32 v27, 4, v1
    v_lshlrev_b32 v26, 4, v26
    v_lshl_add_u32 v26, v27, 2, v26
    s_lshl_b32 s63, s48, 8
    s_lshl_b32 s59, s49, 2
    s_add_u32 s63, s63, s59
    s_add_u32 s63, s63, 28672
    v_mov_b32 v3, s3
L_19:
    ds_read_b32 v2, v0 offset:148
    s_waitcnt lgkmcnt(0)
    v_cmp_gt_u32 vcc, 4, v2
    s_cbranch_vccz L_19_d
    s_add_u32 s99, s99, 1
    s_cmp_gt_u32 s99, 0x1000000
    s_cbranch_scc1 L_19_d
    s_sleep 0
    s_branch L_19
L_19_d:
    s_cmp_eq_u32 s50, 0
    s_cbranch_scc0 L_20
    s_mov_b64 exec, 1
    buffer_atomic_swap v3, off, s[16:19], s63 sc1
    s_mov_b64 exec, -1
L_20:
    ds_read_b64 v[128:129], v10 offset:32
    ds_read_b64 v[138:139], v11 offset:32
    ds_read_b64 v[148:149], v12 offset:32
    ds_read_b128 v[140:143], v12
    ds_read_b128 v[144:147], v12 offset:16
    ds_read_b128 v[120:123], v10
    ds_read_b128 v[124:127], v10 offset:16
    ds_read_b128 v[130:133], v11
    ds_read_b128 v[134:137], v11 offset:16
    s_waitcnt lgkmcnt(8)
    v_mfma_f32_16x16x16_bf16 v[152:155], v[128:129], v[104:105], 0
    v_mfma_f32_16x16x16_bf16 v[164:167], v[128:129], v[114:115], 0
    s_waitcnt lgkmcnt(7)
    v_mfma_f32_16x16x16_bf16 v[156:159], v[138:139], v[104:105], 0
    v_mfma_f32_16x16x16_bf16 v[168:171], v[138:139], v[114:115], 0
    s_waitcnt lgkmcnt(6)
    v_mfma_f32_16x16x16_bf16 v[160:163], v[148:149], v[104:105], 0
    v_mfma_f32_16x16x16_bf16 v[172:175], v[148:149], v[114:115], 0
    s_waitcnt lgkmcnt(4)
    s_nop 5
    v_mfma_f32_16x16x32_bf16 v[160:163], v[140:143], v[96:99], v[160:163]
    v_mfma_f32_16x16x32_bf16 v[160:163], v[144:147], v[100:103], v[160:163]
    s_waitcnt lgkmcnt(2)
    v_mfma_f32_16x16x32_bf16 v[152:155], v[120:123], v[96:99], v[152:155]
    v_mfma_f32_16x16x32_bf16 v[152:155], v[124:127], v[100:103], v[152:155]
    s_waitcnt lgkmcnt(0)
    v_mfma_f32_16x16x32_bf16 v[156:159], v[130:133], v[96:99], v[156:159]
    v_mfma_f32_16x16x32_bf16 v[156:159], v[134:137], v[100:103], v[156:159]
    v_mfma_f32_16x16x32_bf16 v[172:175], v[140:143], v[106:109], v[172:175]
    v_mfma_f32_16x16x32_bf16 v[172:175], v[144:147], v[110:113], v[172:175]
    v_mfma_f32_16x16x32_bf16 v[164:167], v[120:123], v[106:109], v[164:167]
    v_mfma_f32_16x16x32_bf16 v[164:167], v[124:127], v[110:113], v[164:167]
    v_mfma_f32_16x16x32_bf16 v[168:171], v[130:133], v[106:109], v[168:171]
    v_mfma_f32_16x16x32_bf16 v[168:171], v[134:137], v[110:113], v[168:171]
    v_add_f32 v176, 0x358637bd, v162
    v_rcp_f32 v176, v176
    s_nop 0
    v_pk_mul_f32 v[152:153], v[152:153], v[176:177] op_sel_hi:[1,0]
    v_pk_mul_f32 v[154:155], v[154:155], v[176:177] op_sel_hi:[1,0]
    v_pk_mul_f32 v[156:157], v[156:157], v[176:177] op_sel_hi:[1,0]
    v_pk_mul_f32 v[158:159], v[158:159], v[176:177] op_sel_hi:[1,0]
    v_pk_mul_f32 v[160:161], v[160:161], v[176:177] op_sel_hi:[1,0]
    v_cvt_pk_bf16_f32 v180, v152, v153
    v_cvt_pk_bf16_f32 v181, v154, v155
    v_cvt_pk_bf16_f32 v182, v156, v157
    v_cvt_pk_bf16_f32 v183, v158, v159
    v_cvt_pk_bf16_f32 v184, v160, v161
    v_min_u32 v180, -2, v180
    v_min_u32 v181, -2, v181
    v_min_u32 v182, -2, v182
    v_min_u32 v183, -2, v183
    v_min_u32 v184, -2, v184
    buffer_store_dwordx4 v[180:183], v13, s[16:19], s60 offen offset:0 sc1
    buffer_store_dword v184, v26, s[16:19], s60 offen offset:1024 sc1
    v_add_f32 v178, 0x358637bd, v174
    v_rcp_f32 v178, v178
    s_nop 0
    v_pk_mul_f32 v[164:165], v[164:165], v[178:179] op_sel_hi:[1,0]
    v_pk_mul_f32 v[166:167], v[166:167], v[178:179] op_sel_hi:[1,0]
    v_pk_mul_f32 v[168:169], v[168:169], v[178:179] op_sel_hi:[1,0]
    v_pk_mul_f32 v[170:171], v[170:171], v[178:179] op_sel_hi:[1,0]
    v_pk_mul_f32 v[172:173], v[172:173], v[178:179] op_sel_hi:[1,0]
    v_cvt_pk_bf16_f32 v188, v164, v165
    v_cvt_pk_bf16_f32 v189, v166, v167
    v_cvt_pk_bf16_f32 v190, v168, v169
    v_cvt_pk_bf16_f32 v191, v170, v171
    v_cvt_pk_bf16_f32 v192, v172, v173
    v_min_u32 v188, -2, v188
    v_min_u32 v189, -2, v189
    v_min_u32 v190, -2, v190
    v_min_u32 v191, -2, v191
    v_min_u32 v192, -2, v192
    buffer_store_dwordx4 v[188:191], v13, s[16:19], s60 offen offset:1280 sc1
    buffer_store_dword v192, v26, s[16:19], s60 offen offset:2304 sc1
    s_lshl_b32 s60, s50, 6
    v_add_u32 v0, s60, v1
    v_and_b32 v2, 15, v1
    v_lshrrev_b32 v3, 4, v1
    v_mov_b32 v11, v13
    v_mov_b32 v31, 2146435072
    s_branch L_fin_2
L_B_1:
    s_lshl_b32 s54, s58, 2
    s_lshr_b32 s60, s59, 3
    s_add_u32 s54, s54, s60
    s_and_b32 s55, s59, 7
    s_mov_b32 s18, 268435456
    s_mov_b32 s19, 0x20000
    s_mov_b32 s22, 2621440
    s_mov_b32 s23, 0x20000
    s_mov_b32 s69, 0
    s_mov_b32 s98, 0
    s_mov_b32 s99, 0
    s_mul_i32 s65, s49, 266240
    s_add_u32 s65, s65, 3342336
    s_mul_i32 s64, s48, 16640
    s_add_u32 s64, s64, s65
    s_mul_i32 s46, s49, 102400
    s_add_u32 s46, s46, 65536
    s_mov_b32 s26, 1966080
    s_mov_b32 s27, 0x20000
    s_mov_b32 s30, 1966080
    s_mov_b32 s31, 0x20000
    s_mov_b32 s34, 1966080
    s_mov_b32 s35, 0x20000
    s_lshl_b32 s45, s51, 10
    s_mul_i32 s47, s55, 102400
    s_add_u32 s47, s47, 2523136
    v_mov_b32 v31, 2146435072
    v_and_b32 v2, 15, v1
    v_lshrrev_b32 v3, 4, v1
    v_lshlrev_b32 v26, 2, v1
    v_and_b32 v9, 255, v0
    v_lshlrev_b32 v10, 4, v9
    v_mov_b32 v248, -1
    v_mov_b32 v249, -1
    v_mov_b32 v250, -1
    v_mov_b32 v251, -1
    v_mov_b32 v44, 159424
    v_mov_b32 v45, 1
    s_lshl_b32 s60, s51, 2
    v_add_u32 v46, s60, v44
    v_lshlrev_b32 v8, 2, v1
    s_mul_i32 s70, s48, 122880
    s_mul_i32 s60, s49, 192
    s_add_u32 s70, s70, s60
    s_mul_i32 s71, s49, 122880
    s_mul_i32 s60, s48, 80
    s_add_u32 s71, s71, s60
    s_mul_i32 s67, s49, 51200
    s_add_u32 s67, s67, 1703936
    s_waitcnt lgkmcnt(0)
    s_add_u32 m0, s68, 98304
    s_nop 0
    buffer_load_dwordx4 v4, s[4:7], s66 offen  lds
    s_add_u32 m0, s68, 99328
    s_nop 0
    buffer_load_dwordx4 v5, s[4:7], s66 offen  lds
    s_add_u32 m0, s68, 100352
    s_nop 0
    buffer_load_dwordx4 v6, s[4:7], s66 offen  lds
    s_add_u32 m0, s68, 101376
    s_nop 0
    buffer_load_dwordx4 v7, s[4:7], s66 offen  lds
    s_add_u32 s66, s66, 128
    s_add_u32 m0, s68, 114688
    s_nop 0
    buffer_load_dwordx4 v4, s[4:7], s66 offen  lds
    s_add_u32 m0, s68, 115712
    s_nop 0
    buffer_load_dwordx4 v5, s[4:7], s66 offen  lds
    s_add_u32 m0, s68, 116736
    s_nop 0
    buffer_load_dwordx4 v6, s[4:7], s66 offen  lds
    s_add_u32 m0, s68, 117760
    s_nop 0
    buffer_load_dwordx4 v7, s[4:7], s66 offen  lds
    s_add_u32 s66, s66, 128
    s_cmp_eq_u32 s66, 1280
    s_cselect_b32 s66, 0, s66
    s_add_u32 m0, s68, 0
    s_nop 0
    buffer_load_dwordx4 v4, s[4:7], s66 offen  lds
    s_add_u32 m0, s68, 1024
    s_nop 0
    buffer_load_dwordx4 v5, s[4:7], s66 offen  lds
    s_add_u32 m0, s68, 2048
    s_nop 0
    buffer_load_dwordx4 v6, s[4:7], s66 offen  lds
    s_add_u32 m0, s68, 3072
    s_nop 0
    buffer_load_dwordx4 v7, s[4:7], s66 offen  lds
    s_add_u32 s66, s66, 128
    s_add_u32 m0, s68, 16384
    s_nop 0
    buffer_load_dwordx4 v4, s[4:7], s66 offen  lds
    s_add_u32 m0, s68, 17408
    s_nop 0
    buffer_load_dwordx4 v5, s[4:7], s66 offen  lds
    s_add_u32 m0, s68, 18432
    s_nop 0
    buffer_load_dwordx4 v6, s[4:7], s66 offen  lds
    s_add_u32 m0, s68, 19456
    s_nop 0
    buffer_load_dwordx4 v7, s[4:7], s66 offen  lds
    s_add_u32 s66, s66, 128
    s_cmp_eq_u32 s66, 1280
    s_cselect_b32 s66, 0, s66
    s_waitcnt vmcnt(8)
    s_mov_b64 exec, 1
    ds_add_u32 v46, v45 offset:32
    s_mov_b64 exec, -1
    s_waitcnt lgkmcnt(0)
    s_add_u32 m0, s68, 32768
    s_nop 0
    buffer_load_dwordx4 v4, s[4:7], s66 offen  lds
    s_add_u32 m0, s68, 33792
    s_nop 0
    buffer_load_dwordx4 v5, s[4:7], s66 offen  lds
    s_add_u32 m0, s68, 34816
    s_nop 0
    buffer_load_dwordx4 v6, s[4:7], s66 offen  lds
    s_add_u32 m0, s68, 35840
    s_nop 0
    buffer_load_dwordx4 v7, s[4:7], s66 offen  lds
    s_add_u32 s66, s66, 128
    s_add_u32 m0, s68, 49152
    s_nop 0
    buffer_load_dwordx4 v4, s[4:7], s66 offen  lds
    s_add_u32 m0, s68, 50176
    s_nop 0
    buffer_load_dwordx4 v5, s[4:7], s66 offen  lds
    s_add_u32 m0, s68, 51200
    s_nop 0
    buffer_load_dwordx4 v6, s[4:7], s66 offen  lds
    s_add_u32 m0, s68, 52224
    s_nop 0
    buffer_load_dwordx4 v7, s[4:7], s66 offen  lds
    s_add_u32 s66, s66, 128
    s_cmp_eq_u32 s66, 1280
    s_cselect_b32 s66, 0, s66
    s_mul_i32 s3, s3, 0x9E3779B1
    s_add_u32 s3, s3, 0x7F4A7C15
    s_mov_b32 s44, s53
    s_lshl_b32 s56, s49, 8
    s_add_u32 s56, s56, 16384
    s_waitcnt vmcnt(8)
    s_mov_b64 exec, 1
    ds_add_u32 v46, v45 offset:32
    s_mov_b64 exec, -1
    s_add_u32 m0, s68, 65536
    s_nop 0
    buffer_load_dwordx4 v4, s[4:7], s66 offen  lds
    s_add_u32 m0, s68, 66560
    s_nop 0
    buffer_load_dwordx4 v5, s[4:7], s66 offen  lds
    s_add_u32 m0, s68, 67584
    s_nop 0
    buffer_load_dwordx4 v6, s[4:7], s66 offen  lds
    s_add_u32 m0, s68, 68608
    s_nop 0
    buffer_load_dwordx4 v7, s[4:7], s66 offen  lds
    s_add_u32 s66, s66, 128
    s_add_u32 m0, s68, 81920
    s_nop 0
    buffer_load_dwordx4 v4, s[4:7], s66 offen  lds
    s_add_u32 m0, s68, 82944
    s_nop 0
    buffer_load_dwordx4 v5, s[4:7], s66 offen  lds
    s_add_u32 m0, s68, 83968
    s_nop 0
    buffer_load_dwordx4 v6, s[4:7], s66 offen  lds
    s_add_u32 m0, s68, 84992
    s_nop 0
    buffer_load_dwordx4 v7, s[4:7], s66 offen  lds
    s_add_u32 s66, s66, 128
    s_cmp_eq_u32 s66, 1280
    s_cselect_b32 s66, 0, s66
    s_cmp_eq_u32 s50, 4
    s_cbranch_scc0 L_21
    v_mov_b32 v27, 0
    buffer_atomic_or v27, v26, s[16:19], s56 offen sc0 sc1
L_21:
    s_waitcnt vmcnt(8)
    s_mov_b64 exec, 1
    ds_add_u32 v46, v45 offset:32
    s_mov_b64 exec, -1
L_22:
    ds_read_b32 v47, v46 offset:48
    s_waitcnt lgkmcnt(0)
    v_cmp_gt_u32 vcc, 1, v47
    s_cbranch_vccz L_22_d
    s_add_u32 s99, s99, 1
    s_cmp_gt_u32 s99, 0x1000000
    s_cbranch_scc1 L_22_d
    s_sleep 1
    s_branch L_22
L_22_d:
    s_add_u32 m0, s68, 98304
    s_nop 0
    buffer_load_dwordx4 v4, s[4:7], s66 offen  lds
    s_add_u32 m0, s68, 99328
    s_nop 0
    buffer_load_dwordx4 v5, s[4:7], s66 offen  lds
    s_add_u32 m0, s68, 100352
    s_nop 0
    buffer_load_dwordx4 v6, s[4:7], s66 offen  lds
    s_add_u32 m0, s68, 101376
    s_nop 0
    buffer_load_dwordx4 v7, s[4:7], s66 offen  lds
    s_add_u32 s66, s66, 128
    s_add_u32 m0, s68, 114688
    s_nop 0
    buffer_load_dwordx4 v4, s[4:7], s66 offen  lds
    s_add_u32 m0, s68, 115712
    s_nop 0
    buffer_load_dwordx4 v5, s[4:7], s66 offen  lds
    s_add_u32 m0, s68, 116736
    s_nop 0
    buffer_load_dwordx4 v6, s[4:7], s66 offen  lds
    s_add_u32 m0, s68, 117760
    s_nop 0
    buffer_load_dwordx4 v7, s[4:7], s66 offen  lds
    s_add_u32 s66, s66, 128
    s_cmp_eq_u32 s66, 1280
    s_cselect_b32 s66, 0, s66
    s_waitcnt vmcnt(8)
    s_mov_b64 exec, 1
    ds_add_u32 v46, v45 offset:32
    s_mov_b64 exec, -1
    s_cmp_eq_u32 s50, 4
    s_cbranch_scc0 L_23
L_24:
    v_cmp_ne_u32 vcc, s3, v27
    s_cbranch_vccz L_25
    s_add_u32 s69, s69, 1
    s_cmp_gt_u32 s69, 0x40000
    s_cbranch_scc1 L_25
    s_sleep 2
    s_sleep 4
    v_mov_b32 v27, 0
    buffer_atomic_or v27, v26, s[16:19], s56 offen sc0 sc1
    s_waitcnt vmcnt(0)
    s_branch L_24
L_25:
    s_mov_b64 exec, 1
    ds_add_u32 v44, v45 offset:24
    s_mov_b64 exec, -1
L_23:
L_26:
    ds_read_b32 v47, v44 offset:24
    s_waitcnt lgkmcnt(0)
    v_cmp_gt_u32 vcc, 1, v47
    s_cbranch_vccz L_26_d
    s_add_u32 s99, s99, 1
    s_cmp_gt_u32 s99, 0x1000000
    s_cbranch_scc1 L_26_d
    s_sleep 1
    s_branch L_26
L_26_d:
    s_mul_i32 s63, s44, 20480
    s_add_u32 s63, s63, s46
    s_add_u32 s44, s44, 1
    s_cmp_eq_u32 s44, 5
    s_cselect_b32 s44, 0, s44
    s_add_u32 m0, s45, 0
    s_add_u32 s60, s63, 0
    buffer_load_dwordx4 v10, s[16:19], s60 offen sc1 lds
    s_add_u32 m0, s45, 4096
    s_add_u32 s60, s63, 4096
    buffer_load_dwordx4 v10, s[16:19], s60 offen sc1 lds
    s_add_u32 m0, s45, 8192
    s_add_u32 s60, s63, 8192
    buffer_load_dwordx4 v10, s[16:19], s60 offen sc1 lds
    s_add_u32 m0, s45, 12288
    s_add_u32 s60, s63, 12288
    buffer_load_dwordx4 v10, s[16:19], s60 offen sc1 lds
    s_add_u32 m0, s45, 16384
    s_add_u32 s60, s63, 16384
    buffer_load_dwordx4 v10, s[16:19], s60 offen sc1 lds
    s_waitcnt vmcnt(5)
    s_mov_b64 exec, 1
    ds_add_u32 v46, v45 offset:32
    s_mov_b64 exec, -1
L_27:
    ds_read_b32 v47, v44 offset:20
    s_waitcnt lgkmcnt(0)
    v_cmp_gt_u32 vcc, 4, v47
    s_cbranch_vccz L_27_d
    s_add_u32 s99, s99, 1
    s_cmp_gt_u32 s99, 0x1000000
    s_cbranch_scc1 L_27_d
    s_sleep 1
    s_branch L_27
L_27_d:
    s_mul_i32 s63, s44, 20480
    s_add_u32 s63, s63, s46
    s_add_u32 s44, s44, 1
    s_cmp_eq_u32 s44, 5
    s_cselect_b32 s44, 0, s44
    s_add_u32 m0, s45, 20480
    s_add_u32 s60, s63, 0
    buffer_load_dwordx4 v10, s[16:19], s60 offen sc1 lds
    s_add_u32 m0, s45, 24576
    s_add_u32 s60, s63, 4096
    buffer_load_dwordx4 v10, s[16:19], s60 offen sc1 lds
    s_add_u32 m0, s45, 28672
    s_add_u32 s60, s63, 8192
    buffer_load_dwordx4 v10, s[16:19], s60 offen sc1 lds
    s_add_u32 m0, s45, 32768
    s_add_u32 s60, s63, 12288
    buffer_load_dwordx4 v10, s[16:19], s60 offen sc1 lds
    s_add_u32 m0, s45, 36864
    s_add_u32 s60, s63, 16384
    buffer_load_dwordx4 v10, s[16:19], s60 offen sc1 lds
    s_waitcnt vmcnt(5)
    s_barrier
    s_mul_i32 s63, s44, 20480
    s_add_u32 s63, s63, s46
    s_add_u32 s44, s44, 1
    s_cmp_eq_u32 s44, 5
    s_cselect_b32 s44, 0, s44
    s_add_u32 m0, s45, 40960
    s_add_u32 s60, s63, 0
    buffer_load_dwordx4 v10, s[16:19], s60 offen sc1 lds
    s_add_u32 m0, s45, 45056
    s_add_u32 s60, s63, 4096
    buffer_load_dwordx4 v10, s[16:19], s60 offen sc1 lds
    s_add_u32 m0, s45, 49152
    s_add_u32 s60, s63, 8192
    buffer_load_dwordx4 v10, s[16:19], s60 offen sc1 lds
    s_add_u32 m0, s45, 53248
    s_add_u32 s60, s63, 12288
    buffer_load_dwordx4 v10, s[16:19], s60 offen sc1 lds
    s_add_u32 m0, s45, 57344
    s_add_u32 s60, s63, 16384
    buffer_load_dwordx4 v10, s[16:19], s60 offen sc1 lds
    v_add_u32 v18, 13312, v10
    global_load_dwordx4 v[40:43], v18, s[12:13]
    s_mul_i32 s63, s44, 20480
    s_add_u32 s63, s63, s46
    s_add_u32 s44, s44, 1
    s_cmp_eq_u32 s44, 5
    s_cselect_b32 s44, 0, s44
    s_add_u32 m0, s45, 61440
    s_add_u32 s60, s63, 0
    buffer_load_dwordx4 v10, s[16:19], s60 offen sc1 lds
    s_add_u32 m0, s45, 65536
    s_add_u32 s60, s63, 4096
    buffer_load_dwordx4 v10, s[16:19], s60 offen sc1 lds
    s_add_u32 m0, s45, 69632
    s_add_u32 s60, s63, 8192
    buffer_load_dwordx4 v10, s[16:19], s60 offen sc1 lds
    s_add_u32 m0, s45, 73728
    s_add_u32 s60, s63, 12288
    buffer_load_dwordx4 v10, s[16:19], s60 offen sc1 lds
    s_add_u32 m0, s45, 77824
    s_add_u32 s60, s63, 16384
    buffer_load_dwordx4 v10, s[16:19], s60 offen sc1 lds
    s_lshl_b32 s56, s49, 7
    s_add_u32 s56, s56, 8192
    s_lshl_b32 s14, s55, 8
    s_add_u32 s14, s14, 8192
    s_cmp_eq_u32 s50, 5
    s_cbranch_scc0 L_28
    s_mov_b64 exec, 0xffff
    v_mov_b32 v27, 0
    buffer_atomic_or v27, v26, s[16:19], s56 offen sc0 sc1
    s_mov_b64 exec, -1
L_28:
    s_waitcnt vmcnt(11)
    s_barrier
    s_mul_i32 s63, s44, 20480
    s_add_u32 s63, s63, s46
    s_add_u32 s44, s44, 1
    s_cmp_eq_u32 s44, 5
    s_cselect_b32 s44, 0, s44
    s_add_u32 m0, s45, 81920
    s_add_u32 s60, s63, 0
    buffer_load_dwordx4 v10, s[16:19], s60 offen sc1 lds
    s_add_u32 m0, s45, 86016
    s_add_u32 s60, s63, 4096
    buffer_load_dwordx4 v10, s[16:19], s60 offen sc1 lds
    s_add_u32 m0, s45, 90112
    s_add_u32 s60, s63, 8192
    buffer_load_dwordx4 v10, s[16:19], s60 offen sc1 lds
    s_add_u32 m0, s45, 94208
    s_add_u32 s60, s63, 12288
    buffer_load_dwordx4 v10, s[16:19], s60 offen sc1 lds
    s_add_u32 m0, s45, 98304
    s_add_u32 s60, s63, 16384
    buffer_load_dwordx4 v10, s[16:19], s60 offen sc1 lds
    v_add_u32 v16, 5120, v10
    v_add_u32 v17, 9216, v10
    v_add_u32 v18, 13312, v10
    global_load_dwordx4 v[32:35], v16, s[12:13]
    global_load_dwordx4 v[36:39], v17, s[12:13]
    v_cmp_gt_u32 vcc, 232, v9
    s_nop 1
    v_cndmask_b32 v19, v31, v10, vcc
    s_waitcnt vmcnt(13)
    s_mov_b64 exec, 1
    ds_add_u32 v44, v45 offset:92
    s_mov_b64 exec, -1
    s_cmp_eq_u32 s50, 6
    s_cbranch_scc0 L_29
    s_mov_b32 exec_lo, 0xffff
    s_mov_b32 exec_hi, 0xffff
    v_mov_b32 v27, 0
    buffer_atomic_or v27, v26, s[16:19], s14 offen sc0 sc1
    s_mov_b64 exec, -1
L_29:
    s_add_u32 s60, s64, 12288
    buffer_store_dwordx4 v[248:251], v19, s[16:19], s60 offen sc1
    s_waitcnt vmcnt(8)
    s_mov_b64 exec, 1
    ds_add_u32 v44, v45 offset:96
    s_mov_b64 exec, -1
    s_cmp_eq_u32 s50, 5
    s_cbranch_scc0 L_30
    s_waitcnt vmcnt(3)
    s_mov_b64 exec, 1
    ds_add_u32 v44, v45 offset:100
    s_mov_b64 exec, -1
L_31:
    v_cmp_ne_u32 vcc, s3, v27
    s_nop 0
    s_and_b64 vcc, vcc, 0xffff
    s_cbranch_vccz L_32
    s_add_u32 s69, s69, 1
    s_cmp_gt_u32 s69, 0x40000
    s_cbranch_scc1 L_32
    s_sleep 2
    s_sleep 4
    s_mov_b64 exec, 0xffff
    v_mov_b32 v27, 0
    buffer_atomic_or v27, v26, s[16:19], s56 offen sc0 sc1
    s_mov_b64 exec, -1
    s_waitcnt vmcnt(0)
    s_branch L_31
L_32:
    s_mov_b64 exec, 1
    ds_add_u32 v44, v45 offset:24
    s_mov_b64 exec, -1
    s_branch L_33
L_30:
    s_waitcnt vmcnt(3)
    s_mov_b64 exec, 1
    ds_add_u32 v44, v45 offset:100
    s_mov_b64 exec, -1
L_33:
    s_cmp_eq_u32 s50, 7
    s_cbranch_scc0 L_34
    v_add_u32 v16, 159744, v11
    ds_read_b128 v[240:243], v16
    s_waitcnt lgkmcnt(0)
    v_cvt_pk_bf16_f32 v244, v240, v242
    v_cvt_pk_bf16_f32 v245, v241, v243
    v_lshlrev_b32 v240, 16, v244
    v_and_b32 v242, 0xffff0000, v244
    v_ashrrev_i32 v241, 31, v240
    v_ashrrev_i32 v243, 31, v242
    v_or_b32 v241, 0x80000000, v241
    v_or_b32 v243, 0x80000000, v243
    v_xor_b32 v240, v240, v241
    v_xor_b32 v242, v242, v243
    s_lshl_b32 s60, s48, 7
    s_sub_u32 s60, 2047, s60
    v_lshlrev_b32 v241, 1, v1
    v_sub_u32 v241, s60, v241
    v_subrev_u32 v243, 1, v241
    v_and_b32 v240, 0xffff0000, v240
    v_and_b32 v242, 0xffff0000, v242
    v_or_b32 v240, v240, v241
    v_or_b32 v242, v242, v243
    v_max_u32 v241, v240, v242
    s_nop 1
    v_max_u32_dpp v241, v241, v241 row_ror:8 row_mask:0xf bank_mask:0xf
    s_nop 1
    v_max_u32_dpp v241, v241, v241 row_ror:4 row_mask:0xf bank_mask:0xf
    s_nop 1
    v_max_u32_dpp v241, v241, v241 row_ror:2 row_mask:0xf bank_mask:0xf
    s_nop 1
    v_max_u32_dpp v241, v241, v241 row_ror:1 row_mask:0xf bank_mask:0xf
    s_nop 0
    v_readlane_b32 s42, v241, 0
    v_readlane_b32 s57, v241, 16
    v_readlane_b32 s58, v241, 32
    v_readlane_b32 s59, v241, 48
    s_max_u32 s42, s42, s57
    s_max_u32 s58, s58, s59
    s_max_u32 s42, s42, s58
    v_cmp_ne_u32 vcc, s42, v240
    s_nop 1
    v_cndmask_b32 v240, 0, v240, vcc
    v_cmp_ne_u32 vcc, s42, v242
    s_nop 1
    v_cndmask_b32 v242, 0, v242, vcc
    v_max_u32 v241, v240, v242
    s_nop 1
    v_max_u32_dpp v241, v241, v241 row_ror:8 row_mask:0xf bank_mask:0xf
    s_nop 1
    v_max_u32_dpp v241, v241, v241 row_ror:4 row_mask:0xf bank_mask:0xf
    s_nop 1
    v_max_u32_dpp v241, v241, v241 row_ror:2 row_mask:0xf bank_mask:0xf
    s_nop 1
    v_max_u32_dpp v241, v241, v241 row_ror:1 row_mask:0xf bank_mask:0xf
    s_nop 0
    v_readlane_b32 s43, v241, 0
    v_readlane_b32 s57, v241, 16
    v_readlane_b32 s58, v241, 32
    v_readlane_b32 s59, v241, 48
    s_max_u32 s43, s43, s57
    s_max_u32 s58, s58, s59
    s_max_u32 s43, s43, s58
    v_mov_b32 v240, s42
    v_mov_b32 v241, s3
    v_mov_b32 v242, s43
    v_mov_b32 v243, s3
    s_lshl_b32 s60, s49, 4
    s_add_u32 s60, s60, s48
    s_lshl_b32 s60, s60, 7
    s_add_u32 s60, s60, 32768
    s_mov_b64 exec, 1
    buffer_store_dwordx4 v[240:243], off, s[16:19], s60 sc1
    s_mov_b64 exec, -1
    s_cmp_lg_u32 s48, s49
    s_cbranch_scc1 L_34
    v_lshlrev_b32 v246, 16, v245
    v_and_b32 v247, 0xffff0000, v245
    v_mul_f32 v246, 0xbfb8aa3b, v246
    v_exp_f32 v246, v246
    s_nop 0
    v_add_f32 v246, 1.0, v246
    v_rcp_f32 v246, v246
    v_mul_f32 v247, 0xbfb8aa3b, v247
    v_exp_f32 v247, v247
    s_nop 0
    v_add_f32 v247, 1.0, v247
    v_rcp_f32 v247, v247
    s_nop 0
    v_cvt_pk_bf16_f32 v245, v246, v247
    v_lshlrev_b32 v246, 16, v245
    v_and_b32 v247, 0xffff0000, v245
    v_lshlrev_b32 v16, 3, v1
    s_add_u32 s60, s64, 16128
    buffer_store_dwordx2 v[246:247], v16, s[16:19], s60 offen sc1
L_34:
L_35:
    ds_read_b32 v47, v44 offset:24
    s_waitcnt lgkmcnt(0)
    v_cmp_gt_u32 vcc, 2, v47
    s_cbranch_vccz L_35_d
    s_add_u32 s99, s99, 1
    s_cmp_gt_u32 s99, 0x1000000
    s_cbranch_scc1 L_35_d
    s_sleep 2
    s_branch L_35
L_35_d:
    s_mul_i32 s63, s44, 10240
    s_add_u32 s63, s63, s67
    s_add_u32 s44, s44, 1
    s_cmp_eq_u32 s44, 5
    s_cselect_b32 s44, 0, s44
    s_cmp_lt_u32 s50, 6
    s_cbranch_scc0 L_36
    s_add_u32 m0, s45, 110592
    s_add_u32 s60, s63, 8192
    buffer_load_dwordx4 v10, s[16:19], s60 offen sc1 lds
L_36:
    s_add_u32 m0, s45, 102400
    s_add_u32 s60, s63, 0
    buffer_load_dwordx4 v10, s[16:19], s60 offen sc1 lds
    s_add_u32 m0, s45, 106496
    s_add_u32 s60, s63, 4096
    buffer_load_dwordx4 v10, s[16:19], s60 offen sc1 lds
    s_mul_i32 s63, s44, 10240
    s_add_u32 s63, s63, s67
    s_add_u32 s44, s44, 1
    s_cmp_eq_u32 s44, 5
    s_cselect_b32 s44, 0, s44
    s_cmp_lt_u32 s50, 6
    s_cbranch_scc0 L_37
    s_add_u32 m0, s45, 120832
    s_add_u32 s60, s63, 8192
    buffer_load_dwordx4 v10, s[16:19], s60 offen sc1 lds
L_37:
    s_add_u32 m0, s45, 112640
    s_add_u32 s60, s63, 0
    buffer_load_dwordx4 v10, s[16:19], s60 offen sc1 lds
    s_add_u32 m0, s45, 116736
    s_add_u32 s60, s63, 4096
    buffer_load_dwordx4 v10, s[16:19], s60 offen sc1 lds
    s_mul_i32 s63, s44, 10240
    s_add_u32 s63, s63, s67
    s_add_u32 s44, s44, 1
    s_cmp_eq_u32 s44, 5
    s_cselect_b32 s44, 0, s44
    s_cmp_lt_u32 s50, 6
    s_cbranch_scc0 L_38
    s_add_u32 m0, s45, 131072
    s_add_u32 s60, s63, 8192
    buffer_load_dwordx4 v10, s[16:19], s60 offen sc1 lds
L_38:
    s_add_u32 m0, s45, 122880
    s_add_u32 s60, s63, 0
    buffer_load_dwordx4 v10, s[16:19], s60 offen sc1 lds
    s_add_u32 m0, s45, 126976
    s_add_u32 s60, s63, 4096
    buffer_load_dwordx4 v10, s[16:19], s60 offen sc1 lds
    s_mul_i32 s63, s44, 10240
    s_add_u32 s63, s63, s67
    s_add_u32 s44, s44, 1
    s_cmp_eq_u32 s44, 5
    s_cselect_b32 s44, 0, s44
    s_cmp_lt_u32 s50, 6
    s_cbranch_scc0 L_39
    s_add_u32 m0, s45, 141312
    s_add_u32 s60, s63, 8192
    buffer_load_dwordx4 v10, s[16:19], s60 offen sc1 lds
L_39:
    s_add_u32 m0, s45, 133120
    s_add_u32 s60, s63, 0
    buffer_load_dwordx4 v10, s[16:19], s60 offen sc1 lds
    s_add_u32 m0, s45, 137216
    s_add_u32 s60, s63, 4096
    buffer_load_dwordx4 v10, s[16:19], s60 offen sc1 lds
    s_mul_i32 s63, s44, 10240
    s_add_u32 s63, s63, s67
    s_add_u32 s44, s44, 1
    s_cmp_eq_u32 s44, 5
    s_cselect_b32 s44, 0, s44
    s_cmp_lt_u32 s50, 6
    s_cbranch_scc0 L_40
    s_add_u32 m0, s45, 151552
    s_add_u32 s60, s63, 8192
    buffer_load_dwordx4 v10, s[16:19], s60 offen sc1 lds
L_40:
    s_add_u32 m0, s45, 143360
    s_add_u32 s60, s63, 0
    buffer_load_dwordx4 v10, s[16:19], s60 offen sc1 lds
    s_add_u32 m0, s45, 147456
    s_add_u32 s60, s63, 4096
    buffer_load_dwordx4 v10, s[16:19], s60 offen sc1 lds
    s_add_u32 s60, s64, 8192
    buffer_store_dwordx4 v[248:251], v10, s[16:19], s60 offen sc1
L_41:
    ds_read_b32 v47, v44 offset:124
    s_waitcnt lgkmcnt(0)
    v_cmp_gt_u32 vcc, 4, v47
    s_cbranch_vccz L_41_d
    s_add_u32 s99, s99, 1
    s_cmp_gt_u32 s99, 0x1000000
    s_cbranch_scc1 L_41_d
    s_sleep 2
    s_branch L_41
L_41_d:
    s_add_u32 m0, s45, 0
    s_nop 0
    buffer_load_dwordx4 v40, s[24:27], s70 offen  lds
    s_add_u32 m0, s45, 8192
    s_nop 0
    buffer_load_dwordx4 v40, s[28:31], s70 offen  lds
    s_add_u32 m0, s45, 4096
    s_nop 0
    buffer_load_dwordx4 v42, s[24:27], s70 offen  lds
    s_add_u32 m0, s45, 12288
    s_nop 0
    buffer_load_dwordx4 v42, s[28:31], s70 offen  lds
    s_cmp_eq_u32 s50, 6
    s_cbranch_scc0 L_42
    s_waitcnt vmcnt(16)
L_43:
    v_cmp_ne_u32 vcc, s3, v27
    s_nop 0
    s_and_b32 vcc_lo, vcc_lo, 0xffff
    s_and_b32 vcc_hi, vcc_hi, 0xffff
    s_or_b64 vcc, vcc, vcc
    s_cbranch_vccz L_44
    s_add_u32 s69, s69, 1
    s_cmp_gt_u32 s69, 0x40000
    s_cbranch_scc1 L_44
    s_sleep 2
    s_sleep 4
    s_mov_b32 exec_lo, 0xffff
    s_mov_b32 exec_hi, 0xffff
    v_mov_b32 v27, 0
    buffer_atomic_or v27, v26, s[16:19], s14 offen sc0 sc1
    s_mov_b64 exec, -1
    s_waitcnt vmcnt(0)
    s_branch L_43
L_44:
    s_mov_b64 exec, 1
    ds_add_u32 v44, v45 offset:136
    s_mov_b64 exec, -1
L_42:
    s_add_u32 s60, s64, 4096
    buffer_store_dwordx4 v[248:251], v10, s[16:19], s60 offen sc1
L_46:
    ds_read_b32 v47, v44 offset:136
    s_waitcnt lgkmcnt(0)
    v_cmp_gt_u32 vcc, 1, v47
    s_cbranch_vccz L_46_d
    s_add_u32 s99, s99, 1
    s_cmp_gt_u32 s99, 0x1000000
    s_cbranch_scc1 L_46_d
    s_sleep 2
    s_branch L_46
L_46_d:
L_47:
    ds_read_b32 v47, v44 offset:160
    s_waitcnt lgkmcnt(0)
    v_cmp_gt_u32 vcc, 4, v47
    s_cbranch_vccz L_47_d
    s_add_u32 s99, s99, 1
    s_cmp_gt_u32 s99, 0x1000000
    s_cbranch_scc1 L_47_d
    s_sleep 2
    s_branch L_47
L_47_d:
    s_lshl_b32 s56, s49, 8
    s_add_u32 s56, s56, 24576
    s_lshl_b32 s62, s48, 2
    s_add_u32 s62, s62, s56
    s_lshl_b32 s14, 1, s48
    s_xor_b32 s14, s14, 0xffff
    s_mov_b32 s15, 0
    s_and_b32 s63, s54, 3
    s_lshl_b32 s63, s63, 12
    s_add_u32 s66, s45, 61440
    s_add_u32 s68, s47, 30720
    s_add_u32 m0, s66, s63
    s_add_u32 s60, s68, s63
    buffer_load_dwordx4 v10, s[16:19], s60 offen sc1 lds
    s_add_u32 s63, s63, 4096
    s_cmp_eq_u32 s63, 20480
    s_cselect_b32 s63, 0, s63
    s_add_u32 m0, s66, s63
    s_add_u32 s60, s68, s63
    buffer_load_dwordx4 v10, s[16:19], s60 offen sc1 lds
    s_add_u32 s63, s63, 4096
    s_cmp_eq_u32 s63, 20480
    s_cselect_b32 s63, 0, s63
    s_add_u32 m0, s66, s63
    s_add_u32 s60, s68, s63
    buffer_load_dwordx4 v10, s[16:19], s60 offen sc1 lds
    s_add_u32 s63, s63, 4096
    s_cmp_eq_u32 s63, 20480
    s_cselect_b32 s63, 0, s63
    s_add_u32 m0, s66, s63
    s_add_u32 s60, s68, s63
    buffer_load_dwordx4 v10, s[16:19], s60 offen sc1 lds
    s_add_u32 s63, s63, 4096
    s_cmp_eq_u32 s63, 20480
    s_cselect_b32 s63, 0, s63
    s_add_u32 m0, s66, s63
    s_add_u32 s60, s68, s63
    buffer_load_dwordx4 v10, s[16:19], s60 offen sc1 lds
    s_add_u32 s63, s63, 4096
    s_cmp_eq_u32 s63, 20480
    s_cselect_b32 s63, 0, s63
L_48:
    ds_read_b32 v47, v44 offset:0
    s_waitcnt lgkmcnt(0)
    v_cmp_gt_u32 vcc, 4, v47
    s_cbranch_vccz L_48_d
    s_add_u32 s99, s99, 1
    s_cmp_gt_u32 s99, 0x1000000
    s_cbranch_scc1 L_48_d
    s_sleep 2
    s_branch L_48
L_48_d:
    s_add_u32 s66, s66, 20480
    s_add_u32 s68, s68, 20480
    s_add_u32 m0, s66, s63
    s_add_u32 s60, s68, s63
    buffer_load_dwordx4 v10, s[16:19], s60 offen sc1 lds
    s_add_u32 s63, s63, 4096
    s_cmp_eq_u32 s63, 20480
    s_cselect_b32 s63, 0, s63
    s_add_u32 m0, s66, s63
    s_add_u32 s60, s68, s63
    buffer_load_dwordx4 v10, s[16:19], s60 offen sc1 lds
    s_add_u32 s63, s63, 4096
    s_cmp_eq_u32 s63, 20480
    s_cselect_b32 s63, 0, s63
    s_add_u32 m0, s66, s63
    s_add_u32 s60, s68, s63
    buffer_load_dwordx4 v10, s[16:19], s60 offen sc1 lds
    s_add_u32 s63, s63, 4096
    s_cmp_eq_u32 s63, 20480
    s_cselect_b32 s63, 0, s63
    s_add_u32 m0, s66, s63
    s_add_u32 s60, s68, s63
    buffer_load_dwordx4 v10, s[16:19], s60 offen sc1 lds
    s_add_u32 s63, s63, 4096
    s_cmp_eq_u32 s63, 20480
    s_cselect_b32 s63, 0, s63
    s_add_u32 m0, s66, s63
    s_add_u32 s60, s68, s63
    buffer_load_dwordx4 v10, s[16:19], s60 offen sc1 lds
    s_cmp_eq_u32 s50, 7
    s_cbranch_scc0 L_49
    v_lshlrev_b32 v18, 7, v1
    v_cmp_gt_u32 vcc, 16, v1
    s_nop 1
    v_cndmask_b32 v18, v31, v18, vcc
    s_lshl_b32 s60, s49, 11
    s_add_u32 s60, s60, 32768
    buffer_load_dwordx4 v[244:247], v18, s[16:19], s60 offen sc1
L_49:
    s_waitcnt vmcnt(11)
    s_mov_b32 s68, 0
    s_cmp_eq_u32 s50, 7
    s_cbranch_scc0 L_50
    s_branch L_50
    s_waitcnt vmcnt(1)
    v_cmp_ne_u32 vcc, s3, v245
    v_cmp_ne_u32 s[58:59], s3, v247
    s_nop 0
    s_or_b64 vcc, vcc, s[58:59]
    s_and_b64 vcc, vcc, 0xffff
    s_cbranch_vccnz L_50
L_51:
    v_cmp_ne_u32 vcc, s3, v245
    v_cmp_ne_u32 s[58:59], s3, v247
    s_nop 0
    s_or_b64 vcc, vcc, s[58:59]
    s_and_b64 vcc, vcc, 0xffff
    s_cbranch_vccz L_52
    s_add_u32 s69, s69, 1
    s_cmp_gt_u32 s69, 0x40000
    s_cbranch_scc1 L_52
    s_sleep 2
    s_lshl_b32 s60, s49, 11
    s_add_u32 s60, s60, 32768
    buffer_load_dwordx4 v[244:247], v18, s[16:19], s60 offen sc1
    s_waitcnt vmcnt(0)
    s_branch L_51
L_52:
    v_max_u32 v242, v244, v246
    s_nop 1
    v_max_u32_dpp v242, v242, v242 row_ror:8 row_mask:0xf bank_mask:0xf
    s_nop 1
    v_max_u32_dpp v242, v242, v242 row_ror:4 row_mask:0xf bank_mask:0xf
    s_nop 1
    v_max_u32_dpp v242, v242, v242 row_ror:2 row_mask:0xf bank_mask:0xf
    s_nop 1
    v_max_u32_dpp v242, v242, v242 row_ror:1 row_mask:0xf bank_mask:0xf
    s_nop 0
    v_readlane_b32 s42, v242, 0
    v_readlane_b32 s57, v242, 16
    v_readlane_b32 s58, v242, 32
    v_readlane_b32 s59, v242, 48
    s_max_u32 s42, s42, s57
    s_max_u32 s58, s58, s59
    s_max_u32 s42, s42, s58
    v_cmp_ne_u32 vcc, s42, v244
    s_nop 1
    v_cndmask_b32 v244, 0, v244, vcc
    v_cmp_ne_u32 vcc, s42, v246
    s_nop 1
    v_cndmask_b32 v246, 0, v246, vcc
    v_max_u32 v242, v244, v246
    s_nop 1
    v_max_u32_dpp v242, v242, v242 row_ror:8 row_mask:0xf bank_mask:0xf
    s_nop 1
    v_max_u32_dpp v242, v242, v242 row_ror:4 row_mask:0xf bank_mask:0xf
    s_nop 1
    v_max_u32_dpp v242, v242, v242 row_ror:2 row_mask:0xf bank_mask:0xf
    s_nop 1
    v_max_u32_dpp v242, v242, v242 row_ror:1 row_mask:0xf bank_mask:0xf
    s_nop 0
    v_readlane_b32 s43, v242, 0
    v_readlane_b32 s57, v242, 16
    v_readlane_b32 s58, v242, 32
    v_readlane_b32 s59, v242, 48
    s_max_u32 s43, s43, s57
    s_max_u32 s58, s58, s59
    s_max_u32 s43, s43, s58
    s_and_b32 s57, s42, 0x7ff
    s_and_b32 s58, s43, 0x7ff
    s_sub_u32 s57, 2047, s57
    s_sub_u32 s58, 2047, s58
    v_mov_b32 v244, s57
    v_mov_b32 v245, s58
    v_and_b32 v17, 3, v1
    v_bfe_u32 v12, v1, 2, 2
    v_cmp_eq_u32 vcc, v12, v3
    v_cmp_gt_u32 s[58:59], 2, v17
    s_nop 0
    s_and_b64 s[58:59], vcc, s[58:59]
    v_cmp_eq_u32 vcc, 0, v17
    s_mul_i32 s60, s48, 80
    s_nop 0
    v_cndmask_b32 v16, v245, v244, vcc
    v_mul_u32_u24 v16, 1280, v16
    v_cndmask_b32 v16, v31, v16, s[58:59]
    buffer_load_dwordx4 v[120:123], v16, s[4:7], s60 offen offset:0
    buffer_load_dwordx4 v[124:127], v16, s[4:7], s60 offen offset:16
    buffer_load_dwordx4 v[128:131], v16, s[4:7], s60 offen offset:32
    buffer_load_dwordx4 v[132:135], v16, s[4:7], s60 offen offset:48
    buffer_load_dwordx4 v[136:139], v16, s[4:7], s60 offen offset:64
    s_mov_b32 s68, 1
L_50:
    s_add_u32 m0, s45, 16384
    s_nop 0
    buffer_load_dwordx4 v41, s[32:35], s71 offen  lds
    s_add_u32 m0, s45, 20480
    s_nop 0
    buffer_load_dwordx4 v43, s[32:35], s71 offen  lds
    s_setprio 2
    s_barrier
    s_cmp_eq_u32 s50, 4
    s_cbranch_scc0 L_53
    s_mov_b64 exec, s[14:15]
    v_mov_b32 v27, 0
    buffer_atomic_or v27, v8, s[16:19], s56 offen sc0 sc1
    s_mov_b64 exec, -1
L_53:
    s_cmp_eq_u32 s50, 7
    s_cbranch_scc1 L_55
    s_cmp_eq_u32 s50, 6
    s_cbranch_scc1 L_54
    ds_read_b64_tr_b16 v[48:49], v33 offset:0
    ds_read_b64_tr_b16 v[52:53], v34 offset:0
    ds_read_b64_tr_b16 v[56:57], v35 offset:0
    ds_read_b64_tr_b16 v[60:61], v33 offset:64
    ds_read_b64_tr_b16 v[50:51], v33 offset:2688
    ds_read_b64_tr_b16 v[54:55], v34 offset:1664
    ds_read_b64_tr_b16 v[58:59], v35 offset:1664
    ds_read_b64_tr_b16 v[62:63], v33 offset:2752
    ds_read_b64_tr_b16 v[64:65], v33 offset:5376
    ds_read_b64_tr_b16 v[68:69], v34 offset:3328
    ds_read_b64_tr_b16 v[72:73], v35 offset:3328
    ds_read_b64_tr_b16 v[76:77], v33 offset:5440
    ds_read_b64_tr_b16 v[66:67], v33 offset:8064
    ds_read_b64_tr_b16 v[70:71], v34 offset:4992
    ds_read_b64_tr_b16 v[74:75], v35 offset:4992
    s_waitcnt lgkmcnt(12)
    ds_read_b64_tr_b16 v[78:79], v33 offset:8128
    s_waitcnt lgkmcnt(8)
    v_mfma_f32_16x16x32_bf16 v[144:147], v[48:51], v[52:55], 0
    v_mfma_f32_16x16x32_bf16 v[148:151], v[48:51], v[56:59], 0
    v_mfma_f32_16x16x32_bf16 v[152:155], v[60:63], v[52:55], 0
    v_mfma_f32_16x16x32_bf16 v[156:159], v[60:63], v[56:59], 0
    ds_read_b64_tr_b16 v[80:81], v33 offset:10752
    ds_read_b64_tr_b16 v[84:85], v34 offset:6656
    ds_read_b64_tr_b16 v[88:89], v35 offset:6656
    ds_read_b64_tr_b16 v[92:93], v33 offset:10816
    ds_read_b64_tr_b16 v[82:83], v33 offset:13440
    ds_read_b64_tr_b16 v[86:87], v34 offset:8320
    ds_read_b64_tr_b16 v[90:91], v35 offset:8320
    s_waitcnt lgkmcnt(12)
    ds_read_b64_tr_b16 v[94:95], v33 offset:13504
    s_waitcnt lgkmcnt(8)
    v_mfma_f32_16x16x32_bf16 v[144:147], v[64:67], v[68:71], v[144:147]
    v_mfma_f32_16x16x32_bf16 v[148:151], v[64:67], v[72:75], v[148:151]
    v_mfma_f32_16x16x32_bf16 v[152:155], v[76:79], v[68:71], v[152:155]
    v_mfma_f32_16x16x32_bf16 v[156:159], v[76:79], v[72:75], v[156:159]
    ds_read_b64_tr_b16 v[96:97], v33 offset:16128
    ds_read_b64_tr_b16 v[100:101], v34 offset:9984
    ds_read_b64_tr_b16 v[104:105], v35 offset:9984
    ds_read_b64_tr_b16 v[108:109], v33 offset:16192
    ds_read_b64_tr_b16 v[98:99], v33 offset:18816
    ds_read_b64_tr_b16 v[102:103], v34 offset:11648
    ds_read_b64_tr_b16 v[106:107], v35 offset:11648
    s_waitcnt lgkmcnt(12)
    ds_read_b64_tr_b16 v[110:111], v33 offset:18880
    s_waitcnt lgkmcnt(8)
    v_mfma_f32_16x16x32_bf16 v[144:147], v[80:83], v[84:87], v[144:147]
    v_mfma_f32_16x16x32_bf16 v[148:151], v[80:83], v[88:91], v[148:151]
    v_mfma_f32_16x16x32_bf16 v[152:155], v[92:95], v[84:87], v[152:155]
    v_mfma_f32_16x16x32_bf16 v[156:159], v[92:95], v[88:91], v[156:159]
    s_waitcnt lgkmcnt(0)
    v_mfma_f32_16x16x32_bf16 v[144:147], v[96:99], v[100:103], v[144:147]
    v_mfma_f32_16x16x32_bf16 v[148:151], v[96:99], v[104:107], v[148:151]
    v_mfma_f32_16x16x32_bf16 v[152:155], v[108:111], v[100:103], v[152:155]
    v_mfma_f32_16x16x32_bf16 v[156:159], v[108:111], v[104:107], v[156:159]
    s_nop 4
    v_cvt_pk_bf16_f32 v160, v144, v145
    v_cvt_pk_bf16_f32 v161, v146, v147
    v_cvt_pk_bf16_f32 v162, v148, v149
    v_cvt_pk_bf16_f32 v163, v150, v151
    v_min_u32 v160, -2, v160
    v_min_u32 v161, -2, v161
    v_min_u32 v162, -2, v162
    v_min_u32 v163, -2, v163
    buffer_store_dwordx4 v[160:163], v36, s[16:19], s64 offen offset:0 sc1
    v_cvt_pk_bf16_f32 v164, v152, v153
    v_cvt_pk_bf16_f32 v165, v154, v155
    v_cvt_pk_bf16_f32 v166, v156, v157
    v_cvt_pk_bf16_f32 v167, v158, v159
    v_min_u32 v164, -2, v164
    v_min_u32 v165, -2, v165
    v_min_u32 v166, -2, v166
    v_min_u32 v167, -2, v167
    buffer_store_dwordx4 v[164:167], v37, s[16:19], s64 offen offset:1536 sc1
    s_branch L_56
L_54:
    ds_read_b64_tr_b16 v[48:49], v33 offset:0
    ds_read_b64_tr_b16 v[52:53], v34 offset:0
    ds_read_b64_tr_b16 v[56:57], v35 offset:0
    ds_read_b64_tr_b16 v[60:61], v33 offset:80
    ds_read_b64_tr_b16 v[64:65], v34 offset:40
    ds_read_b64_tr_b16 v[68:69], v32 offset:0
    ds_read_b64_tr_b16 v[50:51], v33 offset:2688
    ds_read_b64_tr_b16 v[54:55], v34 offset:1664
    ds_read_b64_tr_b16 v[58:59], v35 offset:1664
    ds_read_b64_tr_b16 v[62:63], v33 offset:2768
    ds_read_b64_tr_b16 v[66:67], v34 offset:1704
    ds_read_b64_tr_b16 v[70:71], v32 offset:1664
    ds_read_b64_tr_b16 v[72:73], v33 offset:5376
    ds_read_b64_tr_b16 v[76:77], v34 offset:3328
    ds_read_b64_tr_b16 v[80:81], v35 offset:3328
    s_waitcnt lgkmcnt(12)
    ds_read_b64_tr_b16 v[84:85], v33 offset:5456
    ds_read_b64_tr_b16 v[88:89], v34 offset:3368
    ds_read_b64_tr_b16 v[92:93], v32 offset:3328
    s_waitcnt lgkmcnt(12)
    ds_read_b64_tr_b16 v[74:75], v33 offset:8064
    ds_read_b64_tr_b16 v[78:79], v34 offset:4992
    ds_read_b64_tr_b16 v[82:83], v35 offset:4992
    s_waitcnt lgkmcnt(12)
    ds_read_b64_tr_b16 v[86:87], v33 offset:8144
    ds_read_b64_tr_b16 v[90:91], v34 offset:5032
    ds_read_b64_tr_b16 v[94:95], v32 offset:4992
    s_waitcnt lgkmcnt(12)
    v_mfma_f32_16x16x32_bf16 v[144:147], v[48:51], v[52:55], 0
    v_mfma_f32_16x16x32_bf16 v[148:151], v[48:51], v[56:59], 0
    v_mfma_f32_16x16x32_bf16 v[152:155], v[60:63], v[64:67], 0
    v_mfma_f32_16x16x32_bf16 v[156:159], v[60:63], v[68:71], 0
    ds_read_b64_tr_b16 v[96:97], v33 offset:10752
    ds_read_b64_tr_b16 v[100:101], v34 offset:6656
    ds_read_b64_tr_b16 v[104:105], v35 offset:6656
    s_waitcnt lgkmcnt(12)
    ds_read_b64_tr_b16 v[108:109], v33 offset:10832
    ds_read_b64_tr_b16 v[112:113], v34 offset:6696
    ds_read_b64_tr_b16 v[116:117], v32 offset:6656
    s_waitcnt lgkmcnt(12)
    ds_read_b64_tr_b16 v[98:99], v33 offset:13440
    ds_read_b64_tr_b16 v[102:103], v34 offset:8320
    ds_read_b64_tr_b16 v[106:107], v35 offset:8320
    s_waitcnt lgkmcnt(12)
    ds_read_b64_tr_b16 v[110:111], v33 offset:13520
    ds_read_b64_tr_b16 v[114:115], v34 offset:8360
    ds_read_b64_tr_b16 v[118:119], v32 offset:8320
    s_waitcnt lgkmcnt(12)
    v_mfma_f32_16x16x32_bf16 v[144:147], v[72:75], v[76:79], v[144:147]
    v_mfma_f32_16x16x32_bf16 v[148:151], v[72:75], v[80:83], v[148:151]
    v_mfma_f32_16x16x32_bf16 v[152:155], v[84:87], v[88:91], v[152:155]
    v_mfma_f32_16x16x32_bf16 v[156:159], v[84:87], v[92:95], v[156:159]
    v_mov_b32 v16, s3
    s_mov_b64 exec, 1
    buffer_atomic_swap v16, off, s[16:19], s62 sc1
    s_mov_b64 exec, -1
    ds_read_b64_tr_b16 v[120:121], v33 offset:16128
    ds_read_b64_tr_b16 v[124:125], v34 offset:9984
    ds_read_b64_tr_b16 v[128:129], v35 offset:9984
    s_waitcnt lgkmcnt(12)
    ds_read_b64_tr_b16 v[132:133], v33 offset:16208
    ds_read_b64_tr_b16 v[136:137], v34 offset:10024
    ds_read_b64_tr_b16 v[140:141], v32 offset:9984
    s_waitcnt lgkmcnt(12)
    ds_read_b64_tr_b16 v[122:123], v33 offset:18816
    ds_read_b64_tr_b16 v[126:127], v34 offset:11648
    ds_read_b64_tr_b16 v[130:131], v35 offset:11648
    s_waitcnt lgkmcnt(12)
    ds_read_b64_tr_b16 v[134:135], v33 offset:18896
    ds_read_b64_tr_b16 v[138:139], v34 offset:11688
    ds_read_b64_tr_b16 v[142:143], v32 offset:11648
    s_waitcnt lgkmcnt(12)
    v_mfma_f32_16x16x32_bf16 v[144:147], v[96:99], v[100:103], v[144:147]
    v_mfma_f32_16x16x32_bf16 v[148:151], v[96:99], v[104:107], v[148:151]
    v_mfma_f32_16x16x32_bf16 v[152:155], v[108:111], v[112:115], v[152:155]
    v_mfma_f32_16x16x32_bf16 v[156:159], v[108:111], v[116:119], v[156:159]
    s_waitcnt lgkmcnt(0)
    v_mfma_f32_16x16x32_bf16 v[144:147], v[120:123], v[124:127], v[144:147]
    v_mfma_f32_16x16x32_bf16 v[148:151], v[120:123], v[128:131], v[148:151]
    v_mfma_f32_16x16x32_bf16 v[152:155], v[132:135], v[136:139], v[152:155]
    v_mfma_f32_16x16x32_bf16 v[156:159], v[132:135], v[140:143], v[156:159]
    s_nop 4
    v_cvt_pk_bf16_f32 v160, v144, v145
    v_cvt_pk_bf16_f32 v161, v146, v147
    v_cvt_pk_bf16_f32 v162, v148, v149
    v_cvt_pk_bf16_f32 v163, v150, v151
    v_min_u32 v160, -2, v160
    v_min_u32 v161, -2, v161
    v_min_u32 v162, -2, v162
    v_min_u32 v163, -2, v163
    buffer_store_dwordx4 v[160:163], v36, s[16:19], s64 offen offset:0 sc1
    v_cvt_pk_bf16_f32 v164, v152, v153
    v_cvt_pk_bf16_f32 v165, v154, v155
    v_cvt_pk_bf16_f32 v166, v156, v157
    v_cvt_pk_bf16_f32 v167, v158, v159
    v_min_u32 v164, -2, v164
    v_min_u32 v165, -2, v165
    v_min_u32 v166, -2, v166
    v_min_u32 v167, -2, v167
    buffer_store_dwordx4 v[164:167], v36, s[16:19], s64 offen offset:1920 sc1
    s_branch L_56
L_55:
    s_cmp_eq_u32 s68, 0
    s_cbranch_scc0 L_57
    s_waitcnt vmcnt(2)
L_58:
    v_cmp_ne_u32 vcc, s3, v245
    v_cmp_ne_u32 s[58:59], s3, v247
    s_nop 0
    s_or_b64 vcc, vcc, s[58:59]
    s_and_b64 vcc, vcc, 0xffff
    s_cbranch_vccz L_59
    s_add_u32 s69, s69, 1
    s_cmp_gt_u32 s69, 0x40000
    s_cbranch_scc1 L_59
    s_sleep 2
    s_lshl_b32 s60, s49, 11
    s_add_u32 s60, s60, 32768
    buffer_load_dwordx4 v[244:247], v18, s[16:19], s60 offen sc1
    s_waitcnt vmcnt(0)
    s_branch L_58
L_59:
    v_max_u32 v242, v244, v246
    s_nop 1
    v_max_u32_dpp v242, v242, v242 row_ror:8 row_mask:0xf bank_mask:0xf
    s_nop 1
    v_max_u32_dpp v242, v242, v242 row_ror:4 row_mask:0xf bank_mask:0xf
    s_nop 1
    v_max_u32_dpp v242, v242, v242 row_ror:2 row_mask:0xf bank_mask:0xf
    s_nop 1
    v_max_u32_dpp v242, v242, v242 row_ror:1 row_mask:0xf bank_mask:0xf
    s_nop 0
    v_readlane_b32 s42, v242, 0
    v_readlane_b32 s57, v242, 16
    v_readlane_b32 s58, v242, 32
    v_readlane_b32 s59, v242, 48
    s_max_u32 s42, s42, s57
    s_max_u32 s58, s58, s59
    s_max_u32 s42, s42, s58
    v_cmp_ne_u32 vcc, s42, v244
    s_nop 1
    v_cndmask_b32 v244, 0, v244, vcc
    v_cmp_ne_u32 vcc, s42, v246
    s_nop 1
    v_cndmask_b32 v246, 0, v246, vcc
    v_max_u32 v242, v244, v246
    s_nop 1
    v_max_u32_dpp v242, v242, v242 row_ror:8 row_mask:0xf bank_mask:0xf
    s_nop 1
    v_max_u32_dpp v242, v242, v242 row_ror:4 row_mask:0xf bank_mask:0xf
    s_nop 1
    v_max_u32_dpp v242, v242, v242 row_ror:2 row_mask:0xf bank_mask:0xf
    s_nop 1
    v_max_u32_dpp v242, v242, v242 row_ror:1 row_mask:0xf bank_mask:0xf
    s_nop 0
    v_readlane_b32 s43, v242, 0
    v_readlane_b32 s57, v242, 16
    v_readlane_b32 s58, v242, 32
    v_readlane_b32 s59, v242, 48
    s_max_u32 s43, s43, s57
    s_max_u32 s58, s58, s59
    s_max_u32 s43, s43, s58
    s_and_b32 s57, s42, 0x7ff
    s_and_b32 s58, s43, 0x7ff
    s_sub_u32 s57, 2047, s57
    s_sub_u32 s58, 2047, s58
    v_mov_b32 v244, s57
    v_mov_b32 v245, s58
    v_and_b32 v17, 3, v1
    v_bfe_u32 v12, v1, 2, 2
    v_cmp_eq_u32 vcc, v12, v3
    v_cmp_gt_u32 s[58:59], 2, v17
    s_nop 0
    s_and_b64 s[58:59], vcc, s[58:59]
    v_cmp_eq_u32 vcc, 0, v17
    s_mul_i32 s60, s48, 80
    s_nop 0
    v_cndmask_b32 v16, v245, v244, vcc
    v_mul_u32_u24 v16, 1280, v16
    v_cndmask_b32 v16, v31, v16, s[58:59]
    buffer_load_dwordx4 v[120:123], v16, s[4:7], s60 offen offset:0
    buffer_load_dwordx4 v[124:127], v16, s[4:7], s60 offen offset:16
    buffer_load_dwordx4 v[128:131], v16, s[4:7], s60 offen offset:32
    buffer_load_dwordx4 v[132:135], v16, s[4:7], s60 offen offset:48
    buffer_load_dwordx4 v[136:139], v16, s[4:7], s60 offen offset:64
L_57:
    v_mul_u32_u24 v12, 192, v12
    v_lshl_add_u32 v12, v17, 3, v12
    v_lshl_add_u32 v16, v3, 5, v12
    v_add_u32 v17, 128, v16
    v_add_u32 v18, 8128, v16
    v_cmp_gt_u32 vcc, 32, v1
    s_nop 1
    v_cndmask_b32 v17, v18, v17, vcc
    v_add_u32 v18, 8256, v16
    ds_read_b64_tr_b16 v[48:49], v16 offset:0
    ds_read_b64_tr_b16 v[50:51], v16 offset:768
    ds_read_b64_tr_b16 v[52:53], v17 offset:0
    ds_read_b64_tr_b16 v[54:55], v17 offset:768
    ds_read_b64_tr_b16 v[56:57], v18 offset:0
    ds_read_b64_tr_b16 v[58:59], v18 offset:768
    ds_read_b64_tr_b16 v[60:61], v16 offset:1536
    ds_read_b64_tr_b16 v[62:63], v16 offset:2304
    ds_read_b64_tr_b16 v[64:65], v17 offset:1536
    ds_read_b64_tr_b16 v[66:67], v17 offset:2304
    ds_read_b64_tr_b16 v[68:69], v18 offset:1536
    ds_read_b64_tr_b16 v[70:71], v18 offset:2304
    s_waitcnt lgkmcnt(6)
    ds_read_b64_tr_b16 v[72:73], v16 offset:3072
    ds_read_b64_tr_b16 v[74:75], v16 offset:3840
    ds_read_b64_tr_b16 v[76:77], v17 offset:3072
    ds_read_b64_tr_b16 v[78:79], v17 offset:3840
    ds_read_b64_tr_b16 v[80:81], v18 offset:3072
    ds_read_b64_tr_b16 v[82:83], v18 offset:3840
    s_waitcnt lgkmcnt(6)
    ds_read_b64_tr_b16 v[84:85], v16 offset:4608
    ds_read_b64_tr_b16 v[86:87], v16 offset:5376
    ds_read_b64_tr_b16 v[88:89], v17 offset:4608
    ds_read_b64_tr_b16 v[90:91], v17 offset:5376
    ds_read_b64_tr_b16 v[92:93], v18 offset:4608
    ds_read_b64_tr_b16 v[94:95], v18 offset:5376
    s_waitcnt lgkmcnt(6)
    ds_read_b64_tr_b16 v[96:97], v16 offset:6144
    ds_read_b64_tr_b16 v[98:99], v16 offset:6912
    ds_read_b64_tr_b16 v[100:101], v17 offset:6144
    ds_read_b64_tr_b16 v[102:103], v17 offset:6912
    ds_read_b64_tr_b16 v[104:105], v18 offset:6144
    ds_read_b64_tr_b16 v[106:107], v18 offset:6912
    v_mov_b32 v246, s42
    v_mov_b32 v247, s43
    v_ashrrev_i32 v242, 31, v246
    v_ashrrev_i32 v243, 31, v247
    v_lshrrev_b32 v242, 1, v242
    v_lshrrev_b32 v243, 1, v243
    v_xor_b32 v246, v246, v242
    v_xor_b32 v247, v247, v243
    v_not_b32 v246, v246
    v_not_b32 v247, v247
    v_and_b32 v246, 0xffff0000, v246
    v_and_b32 v247, 0xffff0000, v247
    v_mul_f32 v246, 0xbfb8aa3b, v246
    v_exp_f32 v246, v246
    s_nop 0
    v_add_f32 v246, 1.0, v246
    v_rcp_f32 v246, v246
    v_mul_f32 v247, 0xbfb8aa3b, v247
    v_exp_f32 v247, v247
    s_nop 0
    v_add_f32 v247, 1.0, v247
    v_rcp_f32 v247, v247
    s_nop 0
    v_cvt_pk_bf16_f32 v242, v246, v247
    v_mov_b32 v16, 161536
    v_lshlrev_b32 v246, 16, v242
    v_and_b32 v247, 0xffff0000, v242
    ds_write_b128 v16, v[244:247]
    v_lshrrev_b32 v16, 1, v1
    v_and_b32 v17, 1, v1
    v_lshlrev_b32 v16, 4, v16
    v_lshl_add_u32 v16, v17, 2, v16
    v_add_u32 v17, 512, v16
    v_subrev_u32 v18, 248, v16
    v_cmp_gt_u32 vcc, 32, v1
    s_nop 1
    v_cndmask_b32 v17, v18, v17, vcc
    v_add_u32 v18, 264, v16
    s_add_u32 s60, s64, 14080
    s_waitcnt vmcnt(0) lgkmcnt(0)
    v_mfma_f32_16x16x32_bf16 v[144:147], v[120:123], v[48:51], 0
    v_mfma_f32_16x16x32_bf16 v[148:151], v[120:123], v[52:55], 0
    v_mfma_f32_16x16x32_bf16 v[152:155], v[120:123], v[56:59], 0
    v_mfma_f32_16x16x32_bf16 v[144:147], v[124:127], v[60:63], v[144:147]
    v_mfma_f32_16x16x32_bf16 v[148:151], v[124:127], v[64:67], v[148:151]
    v_mfma_f32_16x16x32_bf16 v[152:155], v[124:127], v[68:71], v[152:155]
    v_mfma_f32_16x16x32_bf16 v[144:147], v[128:131], v[72:75], v[144:147]
    v_mfma_f32_16x16x32_bf16 v[148:151], v[128:131], v[76:79], v[148:151]
    v_mfma_f32_16x16x32_bf16 v[152:155], v[128:131], v[80:83], v[152:155]
    v_mfma_f32_16x16x32_bf16 v[144:147], v[132:135], v[84:87], v[144:147]
    v_mfma_f32_16x16x32_bf16 v[148:151], v[132:135], v[88:91], v[148:151]
    v_mfma_f32_16x16x32_bf16 v[152:155], v[132:135], v[92:95], v[152:155]
    v_mfma_f32_16x16x32_bf16 v[144:147], v[136:139], v[96:99], v[144:147]
    v_mfma_f32_16x16x32_bf16 v[148:151], v[136:139], v[100:103], v[148:151]
    v_mfma_f32_16x16x32_bf16 v[152:155], v[136:139], v[104:107], v[152:155]
    s_nop 5
    v_cvt_pk_bf16_f32 v144, v144, v145
    v_min_u32 v144, -2, v144
    buffer_store_dword v144, v16, s[16:19], s60 offen sc1
    v_cvt_pk_bf16_f32 v148, v148, v149
    v_min_u32 v148, -2, v148
    buffer_store_dword v148, v17, s[16:19], s60 offen sc1
    v_cvt_pk_bf16_f32 v152, v152, v153
    v_min_u32 v152, -2, v152
    buffer_store_dword v152, v18, s[16:19], s60 offen sc1
L_56:
    s_mov_b64 exec, 1
    ds_add_u32 v44, v45 offset:28
    s_mov_b64 exec, -1
    s_cmp_lt_u32 s50, 7
    s_cbranch_scc0 L_60
    s_mov_b64 exec, 1
    ds_add_u32 v44, v45 offset:140
    s_mov_b64 exec, -1
L_60:
    s_mov_b32 s57, 0x3f80
    s_mov_b32 s58, 0x3f800000
    s_mov_b32 s66, 0
    s_mov_b32 s68, 0
    s_cmp_eq_u32 s50, 4
    s_cbranch_scc0 L_61
    s_waitcnt vmcnt(2)
    v_cmp_ne_u32 vcc, s3, v27
    s_nop 0
    s_and_b64 vcc, vcc, s[14:15]
    s_cbranch_vccz L_64
    s_mov_b64 exec, s[14:15]
    v_mov_b32 v27, 0
    buffer_atomic_or v27, v8, s[16:19], s56 offen sc0 sc1
    s_mov_b64 exec, -1
    s_sleep 4
    s_mov_b64 exec, s[14:15]
    v_mov_b32 v28, 0
    buffer_atomic_or v28, v8, s[16:19], s56 offen sc0 sc1
    s_mov_b64 exec, -1
    s_sleep 4
L_63:
    s_mov_b64 exec, s[14:15]
    v_mov_b32 v29, 0
    buffer_atomic_or v29, v8, s[16:19], s56 offen sc0 sc1
    s_mov_b64 exec, -1
    s_waitcnt vmcnt(2)
    v_cmp_ne_u32 vcc, s3, v27
    s_nop 0
    s_and_b64 vcc, vcc, s[14:15]
    s_cbranch_vccz L_64
    s_sleep 4
    s_mov_b64 exec, s[14:15]
    v_mov_b32 v27, 0
    buffer_atomic_or v27, v8, s[16:19], s56 offen sc0 sc1
    s_mov_b64 exec, -1
    s_waitcnt vmcnt(2)
    v_cmp_ne_u32 vcc, s3, v28
    s_nop 0
    s_and_b64 vcc, vcc, s[14:15]
    s_cbranch_vccz L_64
    s_sleep 4
    s_mov_b64 exec, s[14:15]
    v_mov_b32 v28, 0
    buffer_atomic_or v28, v8, s[16:19], s56 offen sc0 sc1
    s_mov_b64 exec, -1
    s_waitcnt vmcnt(2)
    v_cmp_ne_u32 vcc, s3, v29
    s_nop 0
    s_and_b64 vcc, vcc, s[14:15]
    s_cbranch_vccz L_64
    s_add_u32 s69, s69, 1
    s_cmp_gt_u32 s69, 0x40000
    s_cbranch_scc1 L_64
    s_sleep 2
    s_branch L_63
L_64:
    s_mov_b64 exec, 1
    ds_add_u32 v44, v45 offset:12
    s_mov_b64 exec, -1
    s_add_u32 s60, s64, 0
    buffer_store_dwordx4 v[248:251], v10, s[16:19], s60 offen sc1
    s_branch L_62
L_61:
    s_add_u32 s60, s64, 0
    buffer_store_dwordx4 v[248:251], v10, s[16:19], s60 offen sc1
    s_cmp_eq_u32 s50, 7
    s_cbranch_scc1 L_65
L_66:
    ds_read_b32 v47, v44 offset:140
    s_waitcnt lgkmcnt(0)
    v_cmp_gt_u32 vcc, 3, v47
    s_cbranch_vccz L_66_d
    s_add_u32 s99, s99, 1
    s_cmp_gt_u32 s99, 0x1000000
    s_cbranch_scc1 L_66_d
    s_sleep 2
    s_branch L_66
L_66_d:
    ds_read_b32 v47, v44 offset:12
    s_waitcnt lgkmcnt(0)
    v_cmp_gt_u32 vcc, 1, v47
    s_cbranch_vccz L_62
    s_sub_u32 s59, s47, 1024
    s_mov_b32 s68, 1
    s_add_u32 m0, s45, 29696
    s_add_u32 s60, s59, 0
    buffer_load_dwordx4 v10, s[16:19], s60 offen sc1 lds
    s_add_u32 m0, s45, 31744
    s_add_u32 s60, s59, 2048
    buffer_load_dwordx4 v10, s[16:19], s60 offen sc1 lds
    s_add_u32 m0, s45, 33792
    s_add_u32 s60, s59, 4096
    buffer_load_dwordx4 v10, s[16:19], s60 offen sc1 lds
    s_add_u32 m0, s45, 35840
    s_add_u32 s60, s59, 6144
    buffer_load_dwordx4 v10, s[16:19], s60 offen sc1 lds
    s_add_u32 m0, s45, 37888
    s_add_u32 s60, s59, 8192
    buffer_load_dwordx4 v10, s[16:19], s60 offen sc1 lds
    s_add_u32 m0, s45, 39936
    s_add_u32 s60, s59, 10240
    buffer_load_dwordx4 v10, s[16:19], s60 offen sc1 lds
    s_add_u32 m0, s45, 41984
    s_add_u32 s60, s59, 12288
    buffer_load_dwordx4 v10, s[16:19], s60 offen sc1 lds
    s_add_u32 m0, s45, 44032
    s_add_u32 s60, s59, 14336
    buffer_load_dwordx4 v10, s[16:19], s60 offen sc1 lds
    s_add_u32 m0, s45, 46080
    s_add_u32 s60, s59, 16384
    buffer_load_dwordx4 v10, s[16:19], s60 offen sc1 lds
    s_add_u32 m0, s45, 48128
    s_add_u32 s60, s59, 18432
    buffer_load_dwordx4 v10, s[16:19], s60 offen sc1 lds
    s_add_u32 m0, s45, 50176
    s_add_u32 s60, s59, 20480
    buffer_load_dwordx4 v10, s[16:19], s60 offen sc1 lds
    s_add_u32 m0, s45, 52224
    s_add_u32 s60, s59, 22528
    buffer_load_dwordx4 v10, s[16:19], s60 offen sc1 lds
    s_add_u32 m0, s45, 54272
    s_add_u32 s60, s59, 24576
    buffer_load_dwordx4 v10, s[16:19], s60 offen sc1 lds
    s_add_u32 m0, s45, 56320
    s_add_u32 s60, s59, 26624
    buffer_load_dwordx4 v10, s[16:19], s60 offen sc1 lds
    s_add_u32 m0, s45, 58368
    s_add_u32 s60, s59, 28672
    buffer_load_dwordx4 v10, s[16:19], s60 offen sc1 lds
L_65:
L_67:
    ds_read_b32 v47, v44 offset:12
    s_waitcnt lgkmcnt(0)
    v_cmp_gt_u32 vcc, 1, v47
    s_cbranch_vccz L_67_d
    s_add_u32 s99, s99, 1
    s_cmp_gt_u32 s99, 0x1000000
    s_cbranch_scc1 L_67_d
    s_sleep 2
    s_branch L_67
L_67_d:
L_62:
    s_add_u32 s60, s64, 16640
    s_add_u32 s59, s65, 266240
    s_cmp_eq_u32 s60, s59
    s_cselect_b32 s60, s65, s60
    buffer_load_dwordx4 v[48:51], v39, s[16:19], s60 offen sc1
    s_add_u32 s60, s60, 16640
    s_cmp_eq_u32 s60, s59
    s_cselect_b32 s60, s65, s60
    buffer_load_dwordx4 v[52:55], v39, s[16:19], s60 offen sc1
    s_add_u32 s60, s60, 16640
    s_cmp_eq_u32 s60, s59
    s_cselect_b32 s60, s65, s60
    buffer_load_dwordx4 v[56:59], v39, s[16:19], s60 offen sc1
    s_add_u32 s60, s60, 16640
    s_cmp_eq_u32 s60, s59
    s_cselect_b32 s60, s65, s60
    buffer_load_dwordx4 v[60:63], v39, s[16:19], s60 offen sc1
    s_add_u32 s60, s60, 16640
    s_cmp_eq_u32 s60, s59
    s_cselect_b32 s60, s65, s60
    buffer_load_dwordx4 v[64:67], v39, s[16:19], s60 offen sc1
    s_add_u32 s60, s60, 16640
    s_cmp_eq_u32 s60, s59
    s_cselect_b32 s60, s65, s60
    buffer_load_dwordx4 v[68:71], v39, s[16:19], s60 offen sc1
    s_add_u32 s60, s60, 16640
    s_cmp_eq_u32 s60, s59
    s_cselect_b32 s60, s65, s60
    buffer_load_dwordx4 v[72:75], v39, s[16:19], s60 offen sc1
    s_add_u32 s60, s60, 16640
    s_cmp_eq_u32 s60, s59
    s_cselect_b32 s60, s65, s60
    buffer_load_dwordx4 v[76:79], v39, s[16:19], s60 offen sc1
    s_add_u32 s60, s60, 16640
    s_cmp_eq_u32 s60, s59
    s_cselect_b32 s60, s65, s60
    buffer_load_dwordx4 v[80:83], v39, s[16:19], s60 offen sc1
    s_add_u32 s60, s60, 16640
    s_cmp_eq_u32 s60, s59
    s_cselect_b32 s60, s65, s60
    buffer_load_dwordx4 v[84:87], v39, s[16:19], s60 offen sc1
    s_add_u32 s60, s60, 16640
    s_cmp_eq_u32 s60, s59
    s_cselect_b32 s60, s65, s60
    buffer_load_dwordx4 v[88:91], v39, s[16:19], s60 offen sc1
    s_add_u32 s60, s60, 16640
    s_cmp_eq_u32 s60, s59
    s_cselect_b32 s60, s65, s60
    buffer_load_dwordx4 v[92:95], v39, s[16:19], s60 offen sc1
    s_add_u32 s60, s60, 16640
    s_cmp_eq_u32 s60, s59
    s_cselect_b32 s60, s65, s60
    buffer_load_dwordx4 v[96:99], v39, s[16:19], s60 offen sc1
    s_add_u32 s60, s60, 16640
    s_cmp_eq_u32 s60, s59
    s_cselect_b32 s60, s65, s60
    buffer_load_dwordx4 v[100:103], v39, s[16:19], s60 offen sc1
    s_add_u32 s60, s60, 16640
    s_cmp_eq_u32 s60, s59
    s_cselect_b32 s60, s65, s60
    buffer_load_dwordx4 v[104:107], v39, s[16:19], s60 offen sc1
    s_add_u32 s60, s60, 16640
    s_cmp_eq_u32 s60, s59
    s_cselect_b32 s60, s65, s60
    buffer_load_dwordx4 v[108:111], v39, s[16:19], s60 offen sc1
    v_cmp_gt_u32 vcc, 48, v1
    s_nop 1
    v_cndmask_b32 v229, v31, v11, vcc
L_68:
    ds_read_b32 v47, v44 offset:28
    s_waitcnt lgkmcnt(0)
    v_cmp_gt_u32 vcc, 4, v47
    s_cbranch_vccz L_68_d
    s_add_u32 s99, s99, 1
    s_cmp_gt_u32 s99, 0x1000000
    s_cbranch_scc1 L_68_d
    s_sleep 2
    s_branch L_68
L_68_d:
    v_mov_b32 v112, 0
    v_mov_b32 v113, 0
    v_mov_b32 v114, 0
    v_mov_b32 v115, 0
    v_mov_b32 v116, 0
    v_mov_b32 v117, 0
    v_mov_b32 v118, 0
    v_mov_b32 v119, 0
    s_waitcnt vmcnt(15)
    v_dot2c_f32_bf16 v112, s57, v48
    v_dot2c_f32_bf16 v113, s58, v48
    v_dot2c_f32_bf16 v114, s57, v49
    v_dot2c_f32_bf16 v115, s58, v49
    v_dot2c_f32_bf16 v116, s57, v50
    v_dot2c_f32_bf16 v117, s58, v50
    v_dot2c_f32_bf16 v118, s57, v51
    v_dot2c_f32_bf16 v119, s58, v51
    s_waitcnt vmcnt(14)
    v_dot2c_f32_bf16 v112, s57, v52
    v_dot2c_f32_bf16 v113, s58, v52
    v_dot2c_f32_bf16 v114, s57, v53
    v_dot2c_f32_bf16 v115, s58, v53
    v_dot2c_f32_bf16 v116, s57, v54
    v_dot2c_f32_bf16 v117, s58, v54
    v_dot2c_f32_bf16 v118, s57, v55
    v_dot2c_f32_bf16 v119, s58, v55
    s_waitcnt vmcnt(13)
    v_dot2c_f32_bf16 v112, s57, v56
    v_dot2c_f32_bf16 v113, s58, v56
    v_dot2c_f32_bf16 v114, s57, v57
    v_dot2c_f32_bf16 v115, s58, v57
    v_dot2c_f32_bf16 v116, s57, v58
    v_dot2c_f32_bf16 v117, s58, v58
    v_dot2c_f32_bf16 v118, s57, v59
    v_dot2c_f32_bf16 v119, s58, v59
    s_waitcnt vmcnt(12)
    v_dot2c_f32_bf16 v112, s57, v60
    v_dot2c_f32_bf16 v113, s58, v60
    v_dot2c_f32_bf16 v114, s57, v61
    v_dot2c_f32_bf16 v115, s58, v61
    v_dot2c_f32_bf16 v116, s57, v62
    v_dot2c_f32_bf16 v117, s58, v62
    v_dot2c_f32_bf16 v118, s57, v63
    v_dot2c_f32_bf16 v119, s58, v63
    s_waitcnt vmcnt(11)
    v_dot2c_f32_bf16 v112, s57, v64
    v_dot2c_f32_bf16 v113, s58, v64
    v_dot2c_f32_bf16 v114, s57, v65
    v_dot2c_f32_bf16 v115, s58, v65
    v_dot2c_f32_bf16 v116, s57, v66
    v_dot2c_f32_bf16 v117, s58, v66
    v_dot2c_f32_bf16 v118, s57, v67
    v_dot2c_f32_bf16 v119, s58, v67
    s_waitcnt vmcnt(10)
    v_dot2c_f32_bf16 v112, s57, v68
    v_dot2c_f32_bf16 v113, s58, v68
    v_dot2c_f32_bf16 v114, s57, v69
    v_dot2c_f32_bf16 v115, s58, v69
    v_dot2c_f32_bf16 v116, s57, v70
    v_dot2c_f32_bf16 v117, s58, v70
    v_dot2c_f32_bf16 v118, s57, v71
    v_dot2c_f32_bf16 v119, s58, v71
    s_waitcnt vmcnt(9)
    v_dot2c_f32_bf16 v112, s57, v72
    v_dot2c_f32_bf16 v113, s58, v72
    v_dot2c_f32_bf16 v114, s57, v73
    v_dot2c_f32_bf16 v115, s58, v73
    v_dot2c_f32_bf16 v116, s57, v74
    v_dot2c_f32_bf16 v117, s58, v74
    v_dot2c_f32_bf16 v118, s57, v75
    v_dot2c_f32_bf16 v119, s58, v75
    s_waitcnt vmcnt(8)
    v_dot2c_f32_bf16 v112, s57, v76
    v_dot2c_f32_bf16 v113, s58, v76
    v_dot2c_f32_bf16 v114, s57, v77
    v_dot2c_f32_bf16 v115, s58, v77
    v_dot2c_f32_bf16 v116, s57, v78
    v_dot2c_f32_bf16 v117, s58, v78
    v_dot2c_f32_bf16 v118, s57, v79
    v_dot2c_f32_bf16 v119, s58, v79
    s_waitcnt vmcnt(7)
    v_dot2c_f32_bf16 v112, s57, v80
    v_dot2c_f32_bf16 v113, s58, v80
    v_dot2c_f32_bf16 v114, s57, v81
    v_dot2c_f32_bf16 v115, s58, v81
    v_dot2c_f32_bf16 v116, s57, v82
    v_dot2c_f32_bf16 v117, s58, v82
    v_dot2c_f32_bf16 v118, s57, v83
    v_dot2c_f32_bf16 v119, s58, v83
    s_waitcnt vmcnt(6)
    v_dot2c_f32_bf16 v112, s57, v84
    v_dot2c_f32_bf16 v113, s58, v84
    v_dot2c_f32_bf16 v114, s57, v85
    v_dot2c_f32_bf16 v115, s58, v85
    v_dot2c_f32_bf16 v116, s57, v86
    v_dot2c_f32_bf16 v117, s58, v86
    v_dot2c_f32_bf16 v118, s57, v87
    v_dot2c_f32_bf16 v119, s58, v87
    s_waitcnt vmcnt(5)
    v_dot2c_f32_bf16 v112, s57, v88
    v_dot2c_f32_bf16 v113, s58, v88
    v_dot2c_f32_bf16 v114, s57, v89
    v_dot2c_f32_bf16 v115, s58, v89
    v_dot2c_f32_bf16 v116, s57, v90
    v_dot2c_f32_bf16 v117, s58, v90
    v_dot2c_f32_bf16 v118, s57, v91
    v_dot2c_f32_bf16 v119, s58, v91
    s_waitcnt vmcnt(4)
    v_dot2c_f32_bf16 v112, s57, v92
    v_dot2c_f32_bf16 v113, s58, v92
    v_dot2c_f32_bf16 v114, s57, v93
    v_dot2c_f32_bf16 v115, s58, v93
    v_dot2c_f32_bf16 v116, s57, v94
    v_dot2c_f32_bf16 v117, s58, v94
    v_dot2c_f32_bf16 v118, s57, v95
    v_dot2c_f32_bf16 v119, s58, v95
    s_waitcnt vmcnt(3)
    v_dot2c_f32_bf16 v112, s57, v96
    v_dot2c_f32_bf16 v113, s58, v96
    v_dot2c_f32_bf16 v114, s57, v97
    v_dot2c_f32_bf16 v115, s58, v97
    v_dot2c_f32_bf16 v116, s57, v98
    v_dot2c_f32_bf16 v117, s58, v98
    v_dot2c_f32_bf16 v118, s57, v99
    v_dot2c_f32_bf16 v119, s58, v99
    s_waitcnt vmcnt(2)
    v_dot2c_f32_bf16 v112, s57, v100
    v_dot2c_f32_bf16 v113, s58, v100
    v_dot2c_f32_bf16 v114, s57, v101
    v_dot2c_f32_bf16 v115, s58, v101
    v_dot2c_f32_bf16 v116, s57, v102
    v_dot2c_f32_bf16 v117, s58, v102
    v_dot2c_f32_bf16 v118, s57, v103
    v_dot2c_f32_bf16 v119, s58, v103
    s_waitcnt vmcnt(1)
    v_dot2c_f32_bf16 v112, s57, v104
    v_dot2c_f32_bf16 v113, s58, v104
    v_dot2c_f32_bf16 v114, s57, v105
    v_dot2c_f32_bf16 v115, s58, v105
    v_dot2c_f32_bf16 v116, s57, v106
    v_dot2c_f32_bf16 v117, s58, v106
    v_dot2c_f32_bf16 v118, s57, v107
    v_dot2c_f32_bf16 v119, s58, v107
    s_waitcnt vmcnt(0)
    v_dot2c_f32_bf16 v112, s57, v108
    v_dot2c_f32_bf16 v113, s58, v108
    v_dot2c_f32_bf16 v114, s57, v109
    v_dot2c_f32_bf16 v115, s58, v109
    v_dot2c_f32_bf16 v116, s57, v110
    v_dot2c_f32_bf16 v117, s58, v110
    v_dot2c_f32_bf16 v118, s57, v111
    v_dot2c_f32_bf16 v119, s58, v111
    v_add_f32 v19, v112, v114
    s_nop 0
    v_add_f32 v20, v116, v118
    v_cmp_u_f32 vcc, v19, v20
    s_cbranch_vccz L_70
L_69:
    v_mov_b32 v19, 0
    v_max3_u32 v19, v19, v48, v49
    v_max3_u32 v19, v19, v50, v51
    v_max3_u32 v19, v19, v52, v53
    v_max3_u32 v19, v19, v54, v55
    v_max3_u32 v19, v19, v56, v57
    v_max3_u32 v19, v19, v58, v59
    v_max3_u32 v19, v19, v60, v61
    v_max3_u32 v19, v19, v62, v63
    v_max3_u32 v19, v19, v64, v65
    v_max3_u32 v19, v19, v66, v67
    v_max3_u32 v19, v19, v68, v69
    v_max3_u32 v19, v19, v70, v71
    v_max3_u32 v19, v19, v72, v73
    v_max3_u32 v19, v19, v74, v75
    v_max3_u32 v19, v19, v76, v77
    v_max3_u32 v19, v19, v78, v79
    v_max3_u32 v19, v19, v80, v81
    v_max3_u32 v19, v19, v82, v83
    v_max3_u32 v19, v19, v84, v85
    v_max3_u32 v19, v19, v86, v87
    v_max3_u32 v19, v19, v88, v89
    v_max3_u32 v19, v19, v90, v91
    v_max3_u32 v19, v19, v92, v93
    v_max3_u32 v19, v19, v94, v95
    v_max3_u32 v19, v19, v96, v97
    v_max3_u32 v19, v19, v98, v99
    v_max3_u32 v19, v19, v100, v101
    v_max3_u32 v19, v19, v102, v103
    v_max3_u32 v19, v19, v104, v105
    v_max3_u32 v19, v19, v106, v107
    v_max3_u32 v19, v19, v108, v109
    v_max3_u32 v19, v19, v110, v111
    v_cmp_eq_u32 vcc, -1, v19
    s_cbranch_vccz L_70
    s_add_u32 s69, s69, 1
    s_cmp_gt_u32 s69, 0x40000
    s_cbranch_scc1 L_70
    s_sleep 2
    s_add_u32 s60, s64, 16640
    s_add_u32 s59, s65, 266240
    s_cmp_eq_u32 s60, s59
    s_cselect_b32 s60, s65, s60
    buffer_load_dwordx4 v[48:51], v39, s[16:19], s60 offen sc1
    s_add_u32 s60, s60, 16640
    s_cmp_eq_u32 s60, s59
    s_cselect_b32 s60, s65, s60
    buffer_load_dwordx4 v[52:55], v39, s[16:19], s60 offen sc1
    s_add_u32 s60, s60, 16640
    s_cmp_eq_u32 s60, s59
    s_cselect_b32 s60, s65, s60
    buffer_load_dwordx4 v[56:59], v39, s[16:19], s60 offen sc1
    s_add_u32 s60, s60, 16640
    s_cmp_eq_u32 s60, s59
    s_cselect_b32 s60, s65, s60
    buffer_load_dwordx4 v[60:63], v39, s[16:19], s60 offen sc1
    s_add_u32 s60, s60, 16640
    s_cmp_eq_u32 s60, s59
    s_cselect_b32 s60, s65, s60
    buffer_load_dwordx4 v[64:67], v39, s[16:19], s60 offen sc1
    s_add_u32 s60, s60, 16640
    s_cmp_eq_u32 s60, s59
    s_cselect_b32 s60, s65, s60
    buffer_load_dwordx4 v[68:71], v39, s[16:19], s60 offen sc1
    s_add_u32 s60, s60, 16640
    s_cmp_eq_u32 s60, s59
    s_cselect_b32 s60, s65, s60
    buffer_load_dwordx4 v[72:75], v39, s[16:19], s60 offen sc1
    s_add_u32 s60, s60, 16640
    s_cmp_eq_u32 s60, s59
    s_cselect_b32 s60, s65, s60
    buffer_load_dwordx4 v[76:79], v39, s[16:19], s60 offen sc1
    s_add_u32 s60, s60, 16640
    s_cmp_eq_u32 s60, s59
    s_cselect_b32 s60, s65, s60
    buffer_load_dwordx4 v[80:83], v39, s[16:19], s60 offen sc1
    s_add_u32 s60, s60, 16640
    s_cmp_eq_u32 s60, s59
    s_cselect_b32 s60, s65, s60
    buffer_load_dwordx4 v[84:87], v39, s[16:19], s60 offen sc1
    s_add_u32 s60, s60, 16640
    s_cmp_eq_u32 s60, s59
    s_cselect_b32 s60, s65, s60
    buffer_load_dwordx4 v[88:91], v39, s[16:19], s60 offen sc1
    s_add_u32 s60, s60, 16640
    s_cmp_eq_u32 s60, s59
    s_cselect_b32 s60, s65, s60
    buffer_load_dwordx4 v[92:95], v39, s[16:19], s60 offen sc1
    s_add_u32 s60, s60, 16640
    s_cmp_eq_u32 s60, s59
    s_cselect_b32 s60, s65, s60
    buffer_load_dwordx4 v[96:99], v39, s[16:19], s60 offen sc1
    s_add_u32 s60, s60, 16640
    s_cmp_eq_u32 s60, s59
    s_cselect_b32 s60, s65, s60
    buffer_load_dwordx4 v[100:103], v39, s[16:19], s60 offen sc1
    s_add_u32 s60, s60, 16640
    s_cmp_eq_u32 s60, s59
    s_cselect_b32 s60, s65, s60
    buffer_load_dwordx4 v[104:107], v39, s[16:19], s60 offen sc1
    s_add_u32 s60, s60, 16640
    s_cmp_eq_u32 s60, s59
    s_cselect_b32 s60, s65, s60
    buffer_load_dwordx4 v[108:111], v39, s[16:19], s60 offen sc1
    v_mov_b32 v112, 0
    v_mov_b32 v113, 0
    v_mov_b32 v114, 0
    v_mov_b32 v115, 0
    v_mov_b32 v116, 0
    v_mov_b32 v117, 0
    v_mov_b32 v118, 0
    v_mov_b32 v119, 0
    s_waitcnt vmcnt(15)
    v_dot2c_f32_bf16 v112, s57, v48
    v_dot2c_f32_bf16 v113, s58, v48
    v_dot2c_f32_bf16 v114, s57, v49
    v_dot2c_f32_bf16 v115, s58, v49
    v_dot2c_f32_bf16 v116, s57, v50
    v_dot2c_f32_bf16 v117, s58, v50
    v_dot2c_f32_bf16 v118, s57, v51
    v_dot2c_f32_bf16 v119, s58, v51
    s_waitcnt vmcnt(14)
    v_dot2c_f32_bf16 v112, s57, v52
    v_dot2c_f32_bf16 v113, s58, v52
    v_dot2c_f32_bf16 v114, s57, v53
    v_dot2c_f32_bf16 v115, s58, v53
    v_dot2c_f32_bf16 v116, s57, v54
    v_dot2c_f32_bf16 v117, s58, v54
    v_dot2c_f32_bf16 v118, s57, v55
    v_dot2c_f32_bf16 v119, s58, v55
    s_waitcnt vmcnt(13)
    v_dot2c_f32_bf16 v112, s57, v56
    v_dot2c_f32_bf16 v113, s58, v56
    v_dot2c_f32_bf16 v114, s57, v57
    v_dot2c_f32_bf16 v115, s58, v57
    v_dot2c_f32_bf16 v116, s57, v58
    v_dot2c_f32_bf16 v117, s58, v58
    v_dot2c_f32_bf16 v118, s57, v59
    v_dot2c_f32_bf16 v119, s58, v59
    s_waitcnt vmcnt(12)
    v_dot2c_f32_bf16 v112, s57, v60
    v_dot2c_f32_bf16 v113, s58, v60
    v_dot2c_f32_bf16 v114, s57, v61
    v_dot2c_f32_bf16 v115, s58, v61
    v_dot2c_f32_bf16 v116, s57, v62
    v_dot2c_f32_bf16 v117, s58, v62
    v_dot2c_f32_bf16 v118, s57, v63
    v_dot2c_f32_bf16 v119, s58, v63
    s_waitcnt vmcnt(11)
    v_dot2c_f32_bf16 v112, s57, v64
    v_dot2c_f32_bf16 v113, s58, v64
    v_dot2c_f32_bf16 v114, s57, v65
    v_dot2c_f32_bf16 v115, s58, v65
    v_dot2c_f32_bf16 v116, s57, v66
    v_dot2c_f32_bf16 v117, s58, v66
    v_dot2c_f32_bf16 v118, s57, v67
    v_dot2c_f32_bf16 v119, s58, v67
    s_waitcnt vmcnt(10)
    v_dot2c_f32_bf16 v112, s57, v68
    v_dot2c_f32_bf16 v113, s58, v68
    v_dot2c_f32_bf16 v114, s57, v69
    v_dot2c_f32_bf16 v115, s58, v69
    v_dot2c_f32_bf16 v116, s57, v70
    v_dot2c_f32_bf16 v117, s58, v70
    v_dot2c_f32_bf16 v118, s57, v71
    v_dot2c_f32_bf16 v119, s58, v71
    s_waitcnt vmcnt(9)
    v_dot2c_f32_bf16 v112, s57, v72
    v_dot2c_f32_bf16 v113, s58, v72
    v_dot2c_f32_bf16 v114, s57, v73
    v_dot2c_f32_bf16 v115, s58, v73
    v_dot2c_f32_bf16 v116, s57, v74
    v_dot2c_f32_bf16 v117, s58, v74
    v_dot2c_f32_bf16 v118, s57, v75
    v_dot2c_f32_bf16 v119, s58, v75
    s_waitcnt vmcnt(8)
    v_dot2c_f32_bf16 v112, s57, v76
    v_dot2c_f32_bf16 v113, s58, v76
    v_dot2c_f32_bf16 v114, s57, v77
    v_dot2c_f32_bf16 v115, s58, v77
    v_dot2c_f32_bf16 v116, s57, v78
    v_dot2c_f32_bf16 v117, s58, v78
    v_dot2c_f32_bf16 v118, s57, v79
    v_dot2c_f32_bf16 v119, s58, v79
    s_waitcnt vmcnt(7)
    v_dot2c_f32_bf16 v112, s57, v80
    v_dot2c_f32_bf16 v113, s58, v80
    v_dot2c_f32_bf16 v114, s57, v81
    v_dot2c_f32_bf16 v115, s58, v81
    v_dot2c_f32_bf16 v116, s57, v82
    v_dot2c_f32_bf16 v117, s58, v82
    v_dot2c_f32_bf16 v118, s57, v83
    v_dot2c_f32_bf16 v119, s58, v83
    s_waitcnt vmcnt(6)
    v_dot2c_f32_bf16 v112, s57, v84
    v_dot2c_f32_bf16 v113, s58, v84
    v_dot2c_f32_bf16 v114, s57, v85
    v_dot2c_f32_bf16 v115, s58, v85
    v_dot2c_f32_bf16 v116, s57, v86
    v_dot2c_f32_bf16 v117, s58, v86
    v_dot2c_f32_bf16 v118, s57, v87
    v_dot2c_f32_bf16 v119, s58, v87
    s_waitcnt vmcnt(5)
    v_dot2c_f32_bf16 v112, s57, v88
    v_dot2c_f32_bf16 v113, s58, v88
    v_dot2c_f32_bf16 v114, s57, v89
    v_dot2c_f32_bf16 v115, s58, v89
    v_dot2c_f32_bf16 v116, s57, v90
    v_dot2c_f32_bf16 v117, s58, v90
    v_dot2c_f32_bf16 v118, s57, v91
    v_dot2c_f32_bf16 v119, s58, v91
    s_waitcnt vmcnt(4)
    v_dot2c_f32_bf16 v112, s57, v92
    v_dot2c_f32_bf16 v113, s58, v92
    v_dot2c_f32_bf16 v114, s57, v93
    v_dot2c_f32_bf16 v115, s58, v93
    v_dot2c_f32_bf16 v116, s57, v94
    v_dot2c_f32_bf16 v117, s58, v94
    v_dot2c_f32_bf16 v118, s57, v95
    v_dot2c_f32_bf16 v119, s58, v95
    s_waitcnt vmcnt(3)
    v_dot2c_f32_bf16 v112, s57, v96
    v_dot2c_f32_bf16 v113, s58, v96
    v_dot2c_f32_bf16 v114, s57, v97
    v_dot2c_f32_bf16 v115, s58, v97
    v_dot2c_f32_bf16 v116, s57, v98
    v_dot2c_f32_bf16 v117, s58, v98
    v_dot2c_f32_bf16 v118, s57, v99
    v_dot2c_f32_bf16 v119, s58, v99
    s_waitcnt vmcnt(2)
    v_dot2c_f32_bf16 v112, s57, v100
    v_dot2c_f32_bf16 v113, s58, v100
    v_dot2c_f32_bf16 v114, s57, v101
    v_dot2c_f32_bf16 v115, s58, v101
    v_dot2c_f32_bf16 v116, s57, v102
    v_dot2c_f32_bf16 v117, s58, v102
    v_dot2c_f32_bf16 v118, s57, v103
    v_dot2c_f32_bf16 v119, s58, v103
    s_waitcnt vmcnt(1)
    v_dot2c_f32_bf16 v112, s57, v104
    v_dot2c_f32_bf16 v113, s58, v104
    v_dot2c_f32_bf16 v114, s57, v105
    v_dot2c_f32_bf16 v115, s58, v105
    v_dot2c_f32_bf16 v116, s57, v106
    v_dot2c_f32_bf16 v117, s58, v106
    v_dot2c_f32_bf16 v118, s57, v107
    v_dot2c_f32_bf16 v119, s58, v107
    s_waitcnt vmcnt(0)
    v_dot2c_f32_bf16 v112, s57, v108
    v_dot2c_f32_bf16 v113, s58, v108
    v_dot2c_f32_bf16 v114, s57, v109
    v_dot2c_f32_bf16 v115, s58, v109
    v_dot2c_f32_bf16 v116, s57, v110
    v_dot2c_f32_bf16 v117, s58, v110
    v_dot2c_f32_bf16 v118, s57, v111
    v_dot2c_f32_bf16 v119, s58, v111
    s_branch L_69
L_70:
    v_cvt_pk_bf16_f32 v120, v112, v113
    v_cvt_pk_bf16_f32 v121, v114, v115
    v_cvt_pk_bf16_f32 v122, v116, v117
    v_cvt_pk_bf16_f32 v123, v118, v119
    v_cmp_gt_u32 vcc, 240, v9
    s_nop 0
    s_mov_b64 exec, vcc
    ds_write_b64 v38, v[120:121]
    ds_write_b64 v38, v[122:123] offset:1152
    s_mov_b64 exec, -1
    s_waitcnt lgkmcnt(0)
    s_mov_b64 exec, 1
    ds_add_u32 v44, v45 offset:148
    s_mov_b64 exec, -1
    s_setprio 0
    s_cmp_eq_u32 s50, 7
    s_cbranch_scc1 L_71
    s_cmp_eq_u32 s50, 4
    s_cbranch_scc1 L_72
    s_cmp_eq_u32 s68, 0
    s_cbranch_scc0 L_72
L_73:
    ds_read_b32 v47, v44 offset:28
    s_waitcnt lgkmcnt(0)
    v_cmp_gt_u32 vcc, 4, v47
    s_cbranch_vccz L_73_d
    s_add_u32 s99, s99, 1
    s_cmp_gt_u32 s99, 0x1000000
    s_cbranch_scc1 L_73_d
    s_sleep 2
    s_branch L_73
L_73_d:
    s_sub_u32 s59, s47, 1024
    s_mov_b32 s68, 1
    s_add_u32 m0, s45, 29696
    s_add_u32 s60, s59, 0
    buffer_load_dwordx4 v10, s[16:19], s60 offen sc1 lds
    s_add_u32 m0, s45, 31744
    s_add_u32 s60, s59, 2048
    buffer_load_dwordx4 v10, s[16:19], s60 offen sc1 lds
    s_add_u32 m0, s45, 33792
    s_add_u32 s60, s59, 4096
    buffer_load_dwordx4 v10, s[16:19], s60 offen sc1 lds
    s_add_u32 m0, s45, 35840
    s_add_u32 s60, s59, 6144
    buffer_load_dwordx4 v10, s[16:19], s60 offen sc1 lds
    s_add_u32 m0, s45, 37888
    s_add_u32 s60, s59, 8192
    buffer_load_dwordx4 v10, s[16:19], s60 offen sc1 lds
    s_add_u32 m0, s45, 39936
    s_add_u32 s60, s59, 10240
    buffer_load_dwordx4 v10, s[16:19], s60 offen sc1 lds
    s_add_u32 m0, s45, 41984
    s_add_u32 s60, s59, 12288
    buffer_load_dwordx4 v10, s[16:19], s60 offen sc1 lds
    s_add_u32 m0, s45, 44032
    s_add_u32 s60, s59, 14336
    buffer_load_dwordx4 v10, s[16:19], s60 offen sc1 lds
    s_add_u32 m0, s45, 46080
    s_add_u32 s60, s59, 16384
    buffer_load_dwordx4 v10, s[16:19], s60 offen sc1 lds
    s_add_u32 m0, s45, 48128
    s_add_u32 s60, s59, 18432
    buffer_load_dwordx4 v10, s[16:19], s60 offen sc1 lds
    s_add_u32 m0, s45, 50176
    s_add_u32 s60, s59, 20480
    buffer_load_dwordx4 v10, s[16:19], s60 offen sc1 lds
    s_add_u32 m0, s45, 52224
    s_add_u32 s60, s59, 22528
    buffer_load_dwordx4 v10, s[16:19], s60 offen sc1 lds
    s_add_u32 m0, s45, 54272
    s_add_u32 s60, s59, 24576
    buffer_load_dwordx4 v10, s[16:19], s60 offen sc1 lds
    s_add_u32 m0, s45, 56320
    s_add_u32 s60, s59, 26624
    buffer_load_dwordx4 v10, s[16:19], s60 offen sc1 lds
    s_add_u32 m0, s45, 58368
    s_add_u32 s60, s59, 28672
    buffer_load_dwordx4 v10, s[16:19], s60 offen sc1 lds
L_72:
L_74:
    ds_read_b32 v47, v44 offset:8
    s_waitcnt lgkmcnt(0)
    v_cmp_gt_u32 vcc, 4, v47
    s_cbranch_vccz L_74_d
    s_add_u32 s99, s99, 1
    s_cmp_gt_u32 s99, 0x1000000
    s_cbranch_scc1 L_74_d
    s_sleep 2
    s_branch L_74
L_74_d:
    s_add_u32 m0, s45, 102400
    s_add_u32 s60, s47, 71680
    buffer_load_dwordx4 v10, s[16:19], s60 offen sc1 lds
    s_add_u32 m0, s45, 105472
    s_add_u32 s60, s47, 74752
    buffer_load_dwordx4 v10, s[16:19], s60 offen sc1 lds
    s_add_u32 m0, s45, 108544
    s_add_u32 s60, s47, 77824
    buffer_load_dwordx4 v10, s[16:19], s60 offen sc1 lds
    s_add_u32 m0, s45, 111616
    s_add_u32 s60, s47, 80896
    buffer_load_dwordx4 v10, s[16:19], s60 offen sc1 lds
    s_add_u32 m0, s45, 114688
    s_add_u32 s60, s47, 83968
    buffer_load_dwordx4 v10, s[16:19], s60 offen sc1 lds
    s_add_u32 m0, s45, 117760
    s_add_u32 s60, s47, 87040
    buffer_load_dwordx4 v10, s[16:19], s60 offen sc1 lds
    s_add_u32 m0, s45, 120832
    s_add_u32 s60, s47, 90112
    buffer_load_dwordx4 v10, s[16:19], s60 offen sc1 lds
    s_add_u32 m0, s45, 123904
    s_add_u32 s60, s47, 93184
    buffer_load_dwordx4 v10, s[16:19], s60 offen sc1 lds
    s_add_u32 m0, s45, 126976
    s_add_u32 s60, s47, 96256
    buffer_load_dwordx4 v10, s[16:19], s60 offen sc1 lds
    s_add_u32 m0, s45, 130048
    s_add_u32 s60, s47, 99328
    buffer_load_dwordx4 v10, s[16:19], s60 offen sc1 lds
    s_waitcnt vmcnt(10)
    s_mov_b64 exec, 1
    ds_add_u32 v44, v45 offset:16
    s_mov_b64 exec, -1
    s_branch L_fin_2
L_71:
    s_add_u32 s60, s65, 14080
    buffer_load_dwordx4 v[128:131], v229, s[16:19], s60 offen sc1
    s_add_u32 s60, s65, 30720
    buffer_load_dwordx4 v[132:135], v229, s[16:19], s60 offen sc1
    s_add_u32 s60, s65, 47360
    buffer_load_dwordx4 v[136:139], v229, s[16:19], s60 offen sc1
    s_add_u32 s60, s65, 64000
    buffer_load_dwordx4 v[140:143], v229, s[16:19], s60 offen sc1
    s_add_u32 s60, s65, 80640
    buffer_load_dwordx4 v[144:147], v229, s[16:19], s60 offen sc1
    s_add_u32 s60, s65, 97280
    buffer_load_dwordx4 v[148:151], v229, s[16:19], s60 offen sc1
    s_add_u32 s60, s65, 113920
    buffer_load_dwordx4 v[152:155], v229, s[16:19], s60 offen sc1
    s_add_u32 s60, s65, 130560
    buffer_load_dwordx4 v[156:159], v229, s[16:19], s60 offen sc1
    s_add_u32 s60, s65, 147200
    buffer_load_dwordx4 v[160:163], v229, s[16:19], s60 offen sc1
    s_add_u32 s60, s65, 163840
    buffer_load_dwordx4 v[164:167], v229, s[16:19], s60 offen sc1
    s_add_u32 s60, s65, 180480
    buffer_load_dwordx4 v[168:171], v229, s[16:19], s60 offen sc1
    s_add_u32 s60, s65, 197120
    buffer_load_dwordx4 v[172:175], v229, s[16:19], s60 offen sc1
    s_add_u32 s60, s65, 213760
    buffer_load_dwordx4 v[176:179], v229, s[16:19], s60 offen sc1
    s_add_u32 s60, s65, 230400
    buffer_load_dwordx4 v[180:183], v229, s[16:19], s60 offen sc1
    s_add_u32 s60, s65, 247040
    buffer_load_dwordx4 v[184:187], v229, s[16:19], s60 offen sc1
    s_add_u32 s60, s65, 263680
    buffer_load_dwordx4 v[188:191], v229, s[16:19], s60 offen sc1
    v_mov_b32 v228, v26
    s_mov_b32 s36, s57
    s_mov_b32 s37, s58
    s_lshr_b32 s57, s54, 1
    s_mul_i32 s56, s57, 282880
    s_and_b32 s58, s54, 1
    s_lshl_b32 s58, s58, 8
    s_add_u32 s56, s56, s58
    s_add_u32 s56, s56, 3358464
    s_mul_i32 s61, s54, 81920
    s_mul_i32 s58, s55, 160
    s_add_u32 s61, s61, s58
    v_add_u32 v16, 0, v0
    v_mul_u32_u24 v17, 6554, v16
    v_lshrrev_b32 v242, 16, v17
    v_mul_u32_u24 v18, 10, v242
    v_sub_u32 v244, v16, v18
    v_mul_u32_u24 v27, 1280, v242
    v_lshl_add_u32 v27, v244, 4, v27
    v_mul_u32_u24 v29, 336, v242
    v_lshl_add_u32 v29, v244, 5, v29
    v_lshlrev_b32 v246, 2, v242
    v_add_u32 v16, 512, v0
    v_mul_u32_u24 v17, 6554, v16
    v_lshrrev_b32 v243, 16, v17
    v_mul_u32_u24 v18, 10, v243
    v_sub_u32 v245, v16, v18
    v_mul_u32_u24 v28, 1280, v243
    v_lshl_add_u32 v28, v245, 4, v28
    v_mul_u32_u24 v30, 336, v243
    v_lshl_add_u32 v30, v245, 5, v30
    v_lshlrev_b32 v247, 2, v243
    v_mov_b32 v241, 0
    v_lshlrev_b32 v24, 2, v1
    v_cmp_gt_u32 vcc, 128, v0
    s_nop 1
    v_cndmask_b32 v247, v31, v247, vcc
    v_bfe_u32 v14, v1, 2, 2
    v_and_b32 v15, 3, v1
    v_and_b32 v16, 1, v3
    v_lshl_add_u32 v14, v3, 3, v14
    v_lshl_add_u32 v17, v16, 2, v14
    v_mul_u32_u24 v15, 40, v15
    s_mul_i32 s58, s52, 15360
    s_add_u32 s58, s58, 30720
    v_add_u32 v15, s58, v15
    v_mul_u32_u24 v18, 160, v17
    v_add_u32 v8, v18, v15
    v_xor_b32 v17, 4, v17
    v_mul_u32_u24 v19, 160, v17
    v_add_u32 v9, v19, v15
    s_mul_i32 s58, s52, 5120
    s_add_u32 s58, s58, 30720
    v_add_u32 v12, 71680, v8
    v_add_u32 v13, 71680, v9
    v_add_u32 v6, s58, v8
    v_add_u32 v7, s58, v9
    s_mul_i32 s62, s52, 2129920
    s_mul_i32 s58, s57, 16640
    s_add_u32 s62, s62, s58
    s_and_b32 s58, s54, 1
    s_lshl_b32 s58, s58, 2
    s_add_u32 s58, s58, s51
    s_mul_i32 s58, s58, 1280
    s_add_u32 s62, s62, s58
    s_add_u32 s62, s62, 3342336
    s_add_u32 s67, s62, 2129920
    s_add_u32 s68, s62, 1064960
    s_mov_b32 s60, 266240
    v_mul_lo_u32 v26, s60, v3
    v_lshl_add_u32 v26, v2, 4, v26
    s_mul_i32 s66, s55, 266240
    s_add_u32 s66, s66, s62
    s_lshl_b32 s60, s51, 4
    v_add_u32 v25, s60, v2
    v_mul_u32_u24 v25, 336, v25
    v_mul_u32_u24 v17, 80, v3
    s_mul_i32 s60, s52, 133120
    v_add3_u32 v25, v25, v17, s60
    v_add_u32 v248, 133120, v29
    v_add_u32 v249, 133120, v30
    v_mov_b32 v250, 159424
    v_mov_b32 v251, 1
    s_lshl_b32 s60, s52, 4
    v_add_u32 v252, s60, v250
    v_mov_b32 v16, 161536
    ds_read_b128 v[20:23], v16
    s_cmp_lt_u32 s50, 2
    s_cbranch_scc0 L_77
    buffer_load_dwordx4 v[236:239], v28, s[4:7], s61 offen
L_77:
    buffer_load_dwordx4 v[232:235], v27, s[4:7], s61 offen
    v_bfe_u32 v225, v1, 2, 2
    v_lshl_add_u32 v225, v3, 3, v225
    v_mul_u32_u24 v225, 80, v225
    v_add_u32 v225, 16384, v225
    v_and_b32 v226, 3, v1
    v_lshl_add_u32 v225, v226, 3, v225
L_78:
    ds_read_b32 v47, v44 offset:148
    s_waitcnt lgkmcnt(0)
    v_cmp_gt_u32 vcc, 4, v47
    s_cbranch_vccz L_78_d
    s_add_u32 s99, s99, 1
    s_cmp_gt_u32 s99, 0x1000000
    s_cbranch_scc1 L_78_d
    s_sleep 2
    s_branch L_78
L_78_d:
    ds_read_b64_tr_b16 v[48:49], v225 offset:0
    ds_read_b64_tr_b16 v[50:51], v225 offset:320
    ds_read_b64_tr_b16 v[52:53], v225 offset:2560
    ds_read_b64_tr_b16 v[54:55], v225 offset:2880
    ds_read_b64_tr_b16 v[56:57], v225 offset:5120
    ds_read_b64_tr_b16 v[58:59], v225 offset:5440
    ds_read_b64_tr_b16 v[60:61], v225 offset:32
    ds_read_b64_tr_b16 v[62:63], v225 offset:352
    ds_read_b64_tr_b16 v[64:65], v225 offset:2592
    ds_read_b64_tr_b16 v[66:67], v225 offset:2912
    ds_read_b64_tr_b16 v[68:69], v225 offset:5152
    ds_read_b64_tr_b16 v[70:71], v225 offset:5472
    ds_read_b64_tr_b16 v[72:73], v225 offset:64
    ds_read_b64_tr_b16 v[74:75], v225 offset:384
    s_waitcnt lgkmcnt(8)
    ds_read_b64_tr_b16 v[76:77], v225 offset:2624
    ds_read_b64_tr_b16 v[78:79], v225 offset:2944
    ds_read_b64_tr_b16 v[80:81], v225 offset:5184
    ds_read_b64_tr_b16 v[82:83], v225 offset:5504
L_75:
    v_mov_b32 v112, 0
    v_mov_b32 v113, 0
    v_mov_b32 v114, 0
    v_mov_b32 v115, 0
    v_mov_b32 v116, 0
    v_mov_b32 v117, 0
    v_mov_b32 v118, 0
    v_mov_b32 v119, 0
    s_waitcnt vmcnt(15)
    v_dot2c_f32_bf16 v112, s36, v128
    v_dot2c_f32_bf16 v113, s37, v128
    v_dot2c_f32_bf16 v114, s36, v129
    v_dot2c_f32_bf16 v115, s37, v129
    v_dot2c_f32_bf16 v116, s36, v130
    v_dot2c_f32_bf16 v117, s37, v130
    v_dot2c_f32_bf16 v118, s36, v131
    v_dot2c_f32_bf16 v119, s37, v131
    s_waitcnt vmcnt(14)
    v_dot2c_f32_bf16 v112, s36, v132
    v_dot2c_f32_bf16 v113, s37, v132
    v_dot2c_f32_bf16 v114, s36, v133
    v_dot2c_f32_bf16 v115, s37, v133
    v_dot2c_f32_bf16 v116, s36, v134
    v_dot2c_f32_bf16 v117, s37, v134
    v_dot2c_f32_bf16 v118, s36, v135
    v_dot2c_f32_bf16 v119, s37, v135
    s_waitcnt vmcnt(13)
    v_dot2c_f32_bf16 v112, s36, v136
    v_dot2c_f32_bf16 v113, s37, v136
    v_dot2c_f32_bf16 v114, s36, v137
    v_dot2c_f32_bf16 v115, s37, v137
    v_dot2c_f32_bf16 v116, s36, v138
    v_dot2c_f32_bf16 v117, s37, v138
    v_dot2c_f32_bf16 v118, s36, v139
    v_dot2c_f32_bf16 v119, s37, v139
    s_waitcnt vmcnt(12)
    v_dot2c_f32_bf16 v112, s36, v140
    v_dot2c_f32_bf16 v113, s37, v140
    v_dot2c_f32_bf16 v114, s36, v141
    v_dot2c_f32_bf16 v115, s37, v141
    v_dot2c_f32_bf16 v116, s36, v142
    v_dot2c_f32_bf16 v117, s37, v142
    v_dot2c_f32_bf16 v118, s36, v143
    v_dot2c_f32_bf16 v119, s37, v143
    s_waitcnt vmcnt(11)
    v_dot2c_f32_bf16 v112, s36, v144
    v_dot2c_f32_bf16 v113, s37, v144
    v_dot2c_f32_bf16 v114, s36, v145
    v_dot2c_f32_bf16 v115, s37, v145
    v_dot2c_f32_bf16 v116, s36, v146
    v_dot2c_f32_bf16 v117, s37, v146
    v_dot2c_f32_bf16 v118, s36, v147
    v_dot2c_f32_bf16 v119, s37, v147
    s_waitcnt vmcnt(10)
    v_dot2c_f32_bf16 v112, s36, v148
    v_dot2c_f32_bf16 v113, s37, v148
    v_dot2c_f32_bf16 v114, s36, v149
    v_dot2c_f32_bf16 v115, s37, v149
    v_dot2c_f32_bf16 v116, s36, v150
    v_dot2c_f32_bf16 v117, s37, v150
    v_dot2c_f32_bf16 v118, s36, v151
    v_dot2c_f32_bf16 v119, s37, v151
    s_waitcnt vmcnt(9)
    v_dot2c_f32_bf16 v112, s36, v152
    v_dot2c_f32_bf16 v113, s37, v152
    v_dot2c_f32_bf16 v114, s36, v153
    v_dot2c_f32_bf16 v115, s37, v153
    v_dot2c_f32_bf16 v116, s36, v154
    v_dot2c_f32_bf16 v117, s37, v154
    v_dot2c_f32_bf16 v118, s36, v155
    v_dot2c_f32_bf16 v119, s37, v155
    s_waitcnt vmcnt(8)
    v_dot2c_f32_bf16 v112, s36, v156
    v_dot2c_f32_bf16 v113, s37, v156
    v_dot2c_f32_bf16 v114, s36, v157
    v_dot2c_f32_bf16 v115, s37, v157
    v_dot2c_f32_bf16 v116, s36, v158
    v_dot2c_f32_bf16 v117, s37, v158
    v_dot2c_f32_bf16 v118, s36, v159
    v_dot2c_f32_bf16 v119, s37, v159
    s_waitcnt vmcnt(7)
    v_dot2c_f32_bf16 v112, s36, v160
    v_dot2c_f32_bf16 v113, s37, v160
    v_dot2c_f32_bf16 v114, s36, v161
    v_dot2c_f32_bf16 v115, s37, v161
    v_dot2c_f32_bf16 v116, s36, v162
    v_dot2c_f32_bf16 v117, s37, v162
    v_dot2c_f32_bf16 v118, s36, v163
    v_dot2c_f32_bf16 v119, s37, v163
    s_waitcnt vmcnt(6)
    v_dot2c_f32_bf16 v112, s36, v164
    v_dot2c_f32_bf16 v113, s37, v164
    v_dot2c_f32_bf16 v114, s36, v165
    v_dot2c_f32_bf16 v115, s37, v165
    v_dot2c_f32_bf16 v116, s36, v166
    v_dot2c_f32_bf16 v117, s37, v166
    v_dot2c_f32_bf16 v118, s36, v167
    v_dot2c_f32_bf16 v119, s37, v167
    s_waitcnt vmcnt(5)
    v_dot2c_f32_bf16 v112, s36, v168
    v_dot2c_f32_bf16 v113, s37, v168
    v_dot2c_f32_bf16 v114, s36, v169
    v_dot2c_f32_bf16 v115, s37, v169
    v_dot2c_f32_bf16 v116, s36, v170
    v_dot2c_f32_bf16 v117, s37, v170
    v_dot2c_f32_bf16 v118, s36, v171
    v_dot2c_f32_bf16 v119, s37, v171
    s_waitcnt vmcnt(4)
    v_dot2c_f32_bf16 v112, s36, v172
    v_dot2c_f32_bf16 v113, s37, v172
    v_dot2c_f32_bf16 v114, s36, v173
    v_dot2c_f32_bf16 v115, s37, v173
    v_dot2c_f32_bf16 v116, s36, v174
    v_dot2c_f32_bf16 v117, s37, v174
    v_dot2c_f32_bf16 v118, s36, v175
    v_dot2c_f32_bf16 v119, s37, v175
    s_waitcnt vmcnt(3)
    v_dot2c_f32_bf16 v112, s36, v176
    v_dot2c_f32_bf16 v113, s37, v176
    v_dot2c_f32_bf16 v114, s36, v177
    v_dot2c_f32_bf16 v115, s37, v177
    v_dot2c_f32_bf16 v116, s36, v178
    v_dot2c_f32_bf16 v117, s37, v178
    v_dot2c_f32_bf16 v118, s36, v179
    v_dot2c_f32_bf16 v119, s37, v179
    s_waitcnt vmcnt(2)
    v_dot2c_f32_bf16 v112, s36, v180
    v_dot2c_f32_bf16 v113, s37, v180
    v_dot2c_f32_bf16 v114, s36, v181
    v_dot2c_f32_bf16 v115, s37, v181
    v_dot2c_f32_bf16 v116, s36, v182
    v_dot2c_f32_bf16 v117, s37, v182
    v_dot2c_f32_bf16 v118, s36, v183
    v_dot2c_f32_bf16 v119, s37, v183
    s_waitcnt vmcnt(1)
    v_dot2c_f32_bf16 v112, s36, v184
    v_dot2c_f32_bf16 v113, s37, v184
    v_dot2c_f32_bf16 v114, s36, v185
    v_dot2c_f32_bf16 v115, s37, v185
    v_dot2c_f32_bf16 v116, s36, v186
    v_dot2c_f32_bf16 v117, s37, v186
    v_dot2c_f32_bf16 v118, s36, v187
    v_dot2c_f32_bf16 v119, s37, v187
    s_waitcnt vmcnt(0)
    v_dot2c_f32_bf16 v112, s36, v188
    v_dot2c_f32_bf16 v113, s37, v188
    v_dot2c_f32_bf16 v114, s36, v189
    v_dot2c_f32_bf16 v115, s37, v189
    v_dot2c_f32_bf16 v116, s36, v190
    v_dot2c_f32_bf16 v117, s37, v190
    v_dot2c_f32_bf16 v118, s36, v191
    v_dot2c_f32_bf16 v119, s37, v191
    v_add_f32 v226, v112, v114
    s_nop 0
    v_add_f32 v227, v116, v118
    v_cmp_u_f32 vcc, v226, v227
    s_cbranch_vccz L_76
    v_mov_b32 v226, 0
    v_max3_u32 v226, v226, v128, v129
    v_max3_u32 v226, v226, v130, v131
    v_max3_u32 v226, v226, v132, v133
    v_max3_u32 v226, v226, v134, v135
    v_max3_u32 v226, v226, v136, v137
    v_max3_u32 v226, v226, v138, v139
    v_max3_u32 v226, v226, v140, v141
    v_max3_u32 v226, v226, v142, v143
    v_max3_u32 v226, v226, v144, v145
    v_max3_u32 v226, v226, v146, v147
    v_max3_u32 v226, v226, v148, v149
    v_max3_u32 v226, v226, v150, v151
    v_max3_u32 v226, v226, v152, v153
    v_max3_u32 v226, v226, v154, v155
    v_max3_u32 v226, v226, v156, v157
    v_max3_u32 v226, v226, v158, v159
    v_max3_u32 v226, v226, v160, v161
    v_max3_u32 v226, v226, v162, v163
    v_max3_u32 v226, v226, v164, v165
    v_max3_u32 v226, v226, v166, v167
    v_max3_u32 v226, v226, v168, v169
    v_max3_u32 v226, v226, v170, v171
    v_max3_u32 v226, v226, v172, v173
    v_max3_u32 v226, v226, v174, v175
    v_max3_u32 v226, v226, v176, v177
    v_max3_u32 v226, v226, v178, v179
    v_max3_u32 v226, v226, v180, v181
    v_max3_u32 v226, v226, v182, v183
    v_max3_u32 v226, v226, v184, v185
    v_max3_u32 v226, v226, v186, v187
    v_max3_u32 v226, v226, v188, v189
    v_max3_u32 v226, v226, v190, v191
    v_cmp_eq_u32 vcc, -1, v226
    s_cbranch_vccz L_76
    s_add_u32 s69, s69, 1
    s_cmp_gt_u32 s69, 0x40000
    s_cbranch_scc1 L_76
    s_sleep 2
    s_add_u32 s60, s65, 14080
    buffer_load_dwordx4 v[128:131], v229, s[16:19], s60 offen sc1
    s_add_u32 s60, s65, 30720
    buffer_load_dwordx4 v[132:135], v229, s[16:19], s60 offen sc1
    s_add_u32 s60, s65, 47360
    buffer_load_dwordx4 v[136:139], v229, s[16:19], s60 offen sc1
    s_add_u32 s60, s65, 64000
    buffer_load_dwordx4 v[140:143], v229, s[16:19], s60 offen sc1
    s_add_u32 s60, s65, 80640
    buffer_load_dwordx4 v[144:147], v229, s[16:19], s60 offen sc1
    s_add_u32 s60, s65, 97280
    buffer_load_dwordx4 v[148:151], v229, s[16:19], s60 offen sc1
    s_add_u32 s60, s65, 113920
    buffer_load_dwordx4 v[152:155], v229, s[16:19], s60 offen sc1
    s_add_u32 s60, s65, 130560
    buffer_load_dwordx4 v[156:159], v229, s[16:19], s60 offen sc1
    s_add_u32 s60, s65, 147200
    buffer_load_dwordx4 v[160:163], v229, s[16:19], s60 offen sc1
    s_add_u32 s60, s65, 163840
    buffer_load_dwordx4 v[164:167], v229, s[16:19], s60 offen sc1
    s_add_u32 s60, s65, 180480
    buffer_load_dwordx4 v[168:171], v229, s[16:19], s60 offen sc1
    s_add_u32 s60, s65, 197120
    buffer_load_dwordx4 v[172:175], v229, s[16:19], s60 offen sc1
    s_add_u32 s60, s65, 213760
    buffer_load_dwordx4 v[176:179], v229, s[16:19], s60 offen sc1
    s_add_u32 s60, s65, 230400
    buffer_load_dwordx4 v[180:183], v229, s[16:19], s60 offen sc1
    s_add_u32 s60, s65, 247040
    buffer_load_dwordx4 v[184:187], v229, s[16:19], s60 offen sc1
    s_add_u32 s60, s65, 263680
    buffer_load_dwordx4 v[188:191], v229, s[16:19], s60 offen sc1
    s_branch L_75
L_76:
    v_mul_f32 v200, 0xbfb8aa3b, v112
    v_mul_f32 v201, 0xbfb8aa3b, v113
    v_mul_f32 v202, 0xbfb8aa3b, v114
    v_mul_f32 v203, 0xbfb8aa3b, v115
    v_exp_f32 v200, v200
    v_exp_f32 v201, v201
    v_exp_f32 v202, v202
    v_exp_f32 v203, v203
    v_add_f32 v200, 1.0, v200
    v_mul_f32 v112, v112, v116
    v_add_f32 v201, 1.0, v201
    v_mul_f32 v113, v113, v117
    v_add_f32 v202, 1.0, v202
    v_mul_f32 v114, v114, v118
    v_add_f32 v203, 1.0, v203
    v_mul_f32 v115, v115, v119
    v_rcp_f32 v200, v200
    v_rcp_f32 v201, v201
    v_rcp_f32 v202, v202
    v_rcp_f32 v203, v203
    v_mul_f32 v112, v112, v200
    v_mul_f32 v113, v113, v201
    v_mul_f32 v114, v114, v202
    v_mul_f32 v115, v115, v203
    v_cvt_pk_bf16_f32 v200, v112, v114
    v_cvt_pk_bf16_f32 v201, v113, v115
    v_add_u32 v224, 161664, v228
    v_cmp_gt_u32 vcc, 48, v1
    s_waitcnt lgkmcnt(8)
    s_mov_b64 exec, vcc
    ds_write_b32 v224, v200
    ds_write_b32 v224, v201 offset:192
    s_mov_b64 exec, -1
    v_and_b32 v224, 1, v1
    v_mul_u32_u24 v224, 192, v224
    v_lshl_add_u32 v224, v3, 4, v224
    v_add_u32 v224, 161664, v224
    ds_read_b128 v[208:211], v224 offset:0
    ds_read_b128 v[212:215], v224 offset:64
    ds_read_b128 v[216:219], v224 offset:128
    v_mul_u32_u24 v224, 160, v2
    v_lshl_add_u32 v224, v3, 4, v224
    v_cmp_gt_u32 vcc, 2, v2
    s_nop 1
    v_cndmask_b32 v224, v31, v224, vcc
    v_cmp_gt_u32 vcc, 32, v1
    s_nop 1
    v_cndmask_b32 v225, v31, v224, vcc
    s_add_u32 s60, s64, 15616
    s_waitcnt lgkmcnt(0)
    s_mov_b64 exec, 1
    ds_add_u32 v44, v45 offset:156
    s_mov_b64 exec, -1
    v_mfma_f32_16x16x32_bf16 v[32:35], v[48:51], v[208:211], 0
    v_mfma_f32_16x16x32_bf16 v[36:39], v[60:63], v[208:211], 0
    v_mfma_f32_16x16x32_bf16 v[40:43], v[72:75], v[208:211], 0
    v_mfma_f32_16x16x32_bf16 v[32:35], v[52:55], v[212:215], v[32:35]
    v_mfma_f32_16x16x32_bf16 v[36:39], v[64:67], v[212:215], v[36:39]
    v_mfma_f32_16x16x32_bf16 v[40:43], v[76:79], v[212:215], v[40:43]
    v_mfma_f32_16x16x32_bf16 v[32:35], v[56:59], v[216:219], v[32:35]
    v_mfma_f32_16x16x32_bf16 v[36:39], v[68:71], v[216:219], v[36:39]
    v_mfma_f32_16x16x32_bf16 v[40:43], v[80:83], v[216:219], v[40:43]
    s_nop 5
    v_min_u32 v160, -2, v32
    v_min_u32 v161, -2, v33
    v_min_u32 v162, -2, v34
    v_min_u32 v163, -2, v35
    v_min_u32 v164, -2, v36
    v_min_u32 v165, -2, v37
    v_min_u32 v166, -2, v38
    v_min_u32 v167, -2, v39
    v_min_u32 v168, -2, v40
    v_min_u32 v169, -2, v41
    v_min_u32 v170, -2, v42
    v_min_u32 v171, -2, v43
    buffer_store_dwordx4 v[160:163], v224, s[16:19], s60 offen offset:0 sc1
    buffer_store_dwordx4 v[164:167], v224, s[16:19], s60 offen offset:64 sc1
    buffer_store_dwordx4 v[168:171], v225, s[16:19], s60 offen offset:128 sc1
    s_branch L_79
L_fin_2:
    s_lshr_b32 s57, s54, 1
    s_mul_i32 s56, s57, 282880
    s_and_b32 s58, s54, 1
    s_lshl_b32 s58, s58, 8
    s_add_u32 s56, s56, s58
    s_add_u32 s56, s56, 3358464
    s_mul_i32 s61, s54, 81920
    s_mul_i32 s58, s55, 160
    s_add_u32 s61, s61, s58
    v_add_u32 v16, 0, v0
    v_mul_u32_u24 v17, 6554, v16
    v_lshrrev_b32 v242, 16, v17
    v_mul_u32_u24 v18, 10, v242
    v_sub_u32 v244, v16, v18
    v_mul_u32_u24 v27, 1280, v242
    v_lshl_add_u32 v27, v244, 4, v27
    v_mul_u32_u24 v29, 336, v242
    v_lshl_add_u32 v29, v244, 5, v29
    v_lshlrev_b32 v246, 2, v242
    v_add_u32 v16, 512, v0
    v_mul_u32_u24 v17, 6554, v16
    v_lshrrev_b32 v243, 16, v17
    v_mul_u32_u24 v18, 10, v243
    v_sub_u32 v245, v16, v18
    v_mul_u32_u24 v28, 1280, v243
    v_lshl_add_u32 v28, v245, 4, v28
    v_mul_u32_u24 v30, 336, v243
    v_lshl_add_u32 v30, v245, 5, v30
    v_lshlrev_b32 v247, 2, v243
    v_mov_b32 v241, 0
    v_lshlrev_b32 v24, 2, v1
    v_cmp_gt_u32 vcc, 128, v0
    s_nop 1
    v_cndmask_b32 v247, v31, v247, vcc
    v_bfe_u32 v14, v1, 2, 2
    v_and_b32 v15, 3, v1
    v_and_b32 v16, 1, v3
    v_lshl_add_u32 v14, v3, 3, v14
    v_lshl_add_u32 v17, v16, 2, v14
    v_mul_u32_u24 v15, 40, v15
    s_mul_i32 s58, s52, 15360
    s_add_u32 s58, s58, 30720
    v_add_u32 v15, s58, v15
    v_mul_u32_u24 v18, 160, v17
    v_add_u32 v8, v18, v15
    v_xor_b32 v17, 4, v17
    v_mul_u32_u24 v19, 160, v17
    v_add_u32 v9, v19, v15
    s_mul_i32 s58, s52, 5120
    s_add_u32 s58, s58, 30720
    v_add_u32 v12, 71680, v8
    v_add_u32 v13, 71680, v9
    v_add_u32 v6, s58, v8
    v_add_u32 v7, s58, v9
    s_mul_i32 s62, s52, 2129920
    s_mul_i32 s58, s57, 16640
    s_add_u32 s62, s62, s58
    s_and_b32 s58, s54, 1
    s_lshl_b32 s58, s58, 2
    s_add_u32 s58, s58, s51
    s_mul_i32 s58, s58, 1280
    s_add_u32 s62, s62, s58
    s_add_u32 s62, s62, 3342336
    s_add_u32 s67, s62, 2129920
    s_add_u32 s68, s62, 1064960
    s_mov_b32 s60, 266240
    v_mul_lo_u32 v26, s60, v3
    v_lshl_add_u32 v26, v2, 4, v26
    s_mul_i32 s66, s55, 266240
    s_add_u32 s66, s66, s62
    s_lshl_b32 s60, s51, 4
    v_add_u32 v25, s60, v2
    v_mul_u32_u24 v25, 336, v25
    v_mul_u32_u24 v17, 80, v3
    s_mul_i32 s60, s52, 133120
    v_add3_u32 v25, v25, v17, s60
    v_add_u32 v248, 133120, v29
    v_add_u32 v249, 133120, v30
    v_mov_b32 v250, 159424
    v_mov_b32 v251, 1
    s_lshl_b32 s60, s52, 4
    v_add_u32 v252, s60, v250
    v_mov_b32 v16, 161536
    ds_read_b128 v[20:23], v16
    s_cmp_lt_u32 s50, 2
    s_cbranch_scc0 L_80
    buffer_load_dwordx4 v[236:239], v28, s[4:7], s61 offen
L_80:
    buffer_load_dwordx4 v[232:235], v27, s[4:7], s61 offen
L_79:
L_81:
    ds_read_b32 v19, v250 offset:148
    s_waitcnt lgkmcnt(0)
    v_cmp_gt_u32 vcc, 4, v19
    s_cbranch_vccz L_81_d
    s_add_u32 s99, s99, 1
    s_cmp_gt_u32 s99, 0x1000000
    s_cbranch_scc1 L_81_d
    s_sleep 1
    s_branch L_81
L_81_d:
    s_lshr_b32 s42, s54, 1
    s_lshl_b32 s14, 1, s42
    s_lshl_b32 s42, s42, 8
    s_add_u32 s42, s42, 28672
    s_lshl_b32 s60, s52, 3
    s_lshl_b32 s60, 0xff, s60
    s_or_b32 s14, s14, s60
    s_mov_b32 s15, 0
L_82:
    s_mov_b32 s43, 0
    s_cmp_eq_u32 s50, 7
    s_cbranch_scc0 L_86
    s_setprio 0
    ds_read_b32 v19, v250 offset:4
    s_waitcnt lgkmcnt(0)
    v_cmp_gt_u32 vcc, 3, v19
    s_cbranch_vccnz L_86
    s_mov_b32 s43, 1
    s_mov_b32 s60, s66
    buffer_load_dwordx4 v[32:35], v11, s[16:19], s60 offen sc1
    s_add_u32 s60, s60, 266240
    s_cmp_eq_u32 s60, s67
    s_cselect_b32 s60, s62, s60
    buffer_load_dwordx4 v[36:39], v11, s[16:19], s60 offen sc1
    buffer_load_dwordx4 v[64:67], v26, s[16:19], s62 offen offset:1024 sc1
    s_add_u32 s60, s60, 266240
    s_cmp_eq_u32 s60, s67
    s_cselect_b32 s60, s62, s60
    buffer_load_dwordx4 v[40:43], v11, s[16:19], s60 offen sc1
    s_add_u32 s60, s60, 266240
    s_cmp_eq_u32 s60, s67
    s_cselect_b32 s60, s62, s60
    buffer_load_dwordx4 v[44:47], v11, s[16:19], s60 offen sc1
    buffer_load_dwordx4 v[68:71], v26, s[16:19], s68 offen offset:1024 sc1
    s_add_u32 s60, s60, 266240
    s_cmp_eq_u32 s60, s67
    s_cselect_b32 s60, s62, s60
    buffer_load_dwordx4 v[48:51], v11, s[16:19], s60 offen sc1
    s_add_u32 s60, s60, 266240
    s_cmp_eq_u32 s60, s67
    s_cselect_b32 s60, s62, s60
    buffer_load_dwordx4 v[52:55], v11, s[16:19], s60 offen sc1
    s_add_u32 s60, s60, 266240
    s_cmp_eq_u32 s60, s67
    s_cselect_b32 s60, s62, s60
    buffer_load_dwordx4 v[56:59], v11, s[16:19], s60 offen sc1
    s_add_u32 s60, s60, 266240
    s_cmp_eq_u32 s60, s67
    s_cselect_b32 s60, s62, s60
    buffer_load_dwordx4 v[60:63], v11, s[16:19], s60 offen sc1
    s_cmp_lt_u32 s50, 2
    s_cbranch_scc0 L_87
    buffer_load_dword v241, v247, s[16:19], s56 offen sc1
L_87:
    buffer_load_dword v240, v246, s[16:19], s56 offen sc1
L_86:
    ds_read_b64_tr_b16 v[92:93], v6 offset:0
    ds_read_b64_tr_b16 v[94:95], v7 offset:0
    ds_read_b64_tr_b16 v[96:97], v6 offset:8
    ds_read_b64_tr_b16 v[98:99], v7 offset:8
    ds_read_b64_tr_b16 v[100:101], v6 offset:16
    ds_read_b64_tr_b16 v[102:103], v7 offset:16
    ds_read_b64_tr_b16 v[104:105], v6 offset:24
    ds_read_b64_tr_b16 v[106:107], v7 offset:24
    ds_read_b64_tr_b16 v[108:109], v6 offset:32
    ds_read_b64_tr_b16 v[110:111], v7 offset:32
    ds_read_b64_tr_b16 v[112:113], v6 offset:5120
    ds_read_b64_tr_b16 v[114:115], v7 offset:5120
    ds_read_b64_tr_b16 v[116:117], v6 offset:5128
    ds_read_b64_tr_b16 v[118:119], v7 offset:5128
    s_waitcnt lgkmcnt(8)
    ds_read_b64_tr_b16 v[120:121], v6 offset:5136
    ds_read_b64_tr_b16 v[122:123], v7 offset:5136
    ds_read_b64_tr_b16 v[124:125], v6 offset:5144
    ds_read_b64_tr_b16 v[126:127], v7 offset:5144
    ds_read_b64_tr_b16 v[128:129], v6 offset:5152
    ds_read_b64_tr_b16 v[130:131], v7 offset:5152
    s_waitcnt lgkmcnt(8)
    ds_read_b64_tr_b16 v[132:133], v6 offset:10240
    ds_read_b64_tr_b16 v[134:135], v7 offset:10240
    ds_read_b64_tr_b16 v[136:137], v6 offset:10248
    ds_read_b64_tr_b16 v[138:139], v7 offset:10248
    ds_read_b64_tr_b16 v[140:141], v6 offset:10256
    ds_read_b64_tr_b16 v[142:143], v7 offset:10256
    s_waitcnt lgkmcnt(8)
    ds_read_b64_tr_b16 v[144:145], v6 offset:10264
    ds_read_b64_tr_b16 v[146:147], v7 offset:10264
    ds_read_b64_tr_b16 v[148:149], v6 offset:10272
    ds_read_b64_tr_b16 v[150:151], v7 offset:10272
    s_cmp_eq_u32 s50, 4
    s_cbranch_scc0 L_88
    s_mov_b64 exec, 0xffff
    v_mov_b32 v4, 0
    buffer_atomic_or v4, v24, s[16:19], s42 offen sc0 sc1
    s_mov_b64 exec, -1
L_88:
    ds_read_b64_tr_b16 v[152:153], v6 offset:15360
    ds_read_b64_tr_b16 v[154:155], v7 offset:15360
    s_waitcnt lgkmcnt(8)
    ds_read_b64_tr_b16 v[156:157], v6 offset:15368
    ds_read_b64_tr_b16 v[158:159], v7 offset:15368
    ds_read_b64_tr_b16 v[160:161], v6 offset:15376
    ds_read_b64_tr_b16 v[162:163], v7 offset:15376
    ds_read_b64_tr_b16 v[164:165], v6 offset:15384
    ds_read_b64_tr_b16 v[166:167], v7 offset:15384
    s_waitcnt lgkmcnt(8)
    ds_read_b64_tr_b16 v[168:169], v6 offset:15392
    ds_read_b64_tr_b16 v[170:171], v7 offset:15392
L_89:
    ds_read_b32 v19, v250 offset:16
    s_waitcnt lgkmcnt(0)
    v_cmp_gt_u32 vcc, 7, v19
    s_cbranch_vccz L_89_d
    s_add_u32 s99, s99, 1
    s_cmp_gt_u32 s99, 0x1000000
    s_cbranch_scc1 L_89_d
    s_sleep 1
    s_branch L_89
L_89_d:
    ds_read_b64_tr_b16 v[172:173], v8 offset:0
    ds_read_b64_tr_b16 v[174:175], v9 offset:0
    ds_read_b64_tr_b16 v[176:177], v8 offset:8
    ds_read_b64_tr_b16 v[178:179], v9 offset:8
    ds_read_b64_tr_b16 v[180:181], v8 offset:16
    ds_read_b64_tr_b16 v[182:183], v9 offset:16
    ds_read_b64_tr_b16 v[184:185], v8 offset:24
    ds_read_b64_tr_b16 v[186:187], v9 offset:24
    ds_read_b64_tr_b16 v[188:189], v8 offset:32
    ds_read_b64_tr_b16 v[190:191], v9 offset:32
    ds_read_b64_tr_b16 v[192:193], v8 offset:5120
    ds_read_b64_tr_b16 v[194:195], v9 offset:5120
    ds_read_b64_tr_b16 v[196:197], v8 offset:5128
    ds_read_b64_tr_b16 v[198:199], v9 offset:5128
    s_waitcnt lgkmcnt(8)
    ds_read_b64_tr_b16 v[200:201], v8 offset:5136
    ds_read_b64_tr_b16 v[202:203], v9 offset:5136
    ds_read_b64_tr_b16 v[204:205], v8 offset:5144
    ds_read_b64_tr_b16 v[206:207], v9 offset:5144
    ds_read_b64_tr_b16 v[208:209], v8 offset:5152
    ds_read_b64_tr_b16 v[210:211], v9 offset:5152
    s_waitcnt lgkmcnt(0)
    s_cmp_eq_u32 s43, 1
    s_cbranch_scc1 L_85
    s_sub_u32 s60, s50, 4
    s_cmp_lt_u32 s60, 3
    s_cbranch_scc0 L_90
    s_waitcnt vmcnt(1)
    s_cmp_eq_u32 s50, 4
    s_cbranch_scc0 L_84
    s_waitcnt vmcnt(0)
    v_cmp_ne_u32 vcc, s3, v4
    s_nop 0
    s_and_b64 vcc, vcc, 0xffff
    s_cbranch_vccz L_92
    s_mov_b64 exec, 0xffff
    v_mov_b32 v4, 0
    buffer_atomic_or v4, v24, s[16:19], s42 offen sc0 sc1
    s_mov_b64 exec, -1
    s_sleep 4
    s_mov_b64 exec, 0xffff
    v_mov_b32 v5, 0
    buffer_atomic_or v5, v24, s[16:19], s42 offen sc0 sc1
    s_mov_b64 exec, -1
    s_sleep 4
L_91:
    s_mov_b64 exec, 0xffff
    v_mov_b32 v10, 0
    buffer_atomic_or v10, v24, s[16:19], s42 offen sc0 sc1
    s_mov_b64 exec, -1
    s_waitcnt vmcnt(2)
    v_cmp_ne_u32 vcc, s3, v4
    s_nop 0
    s_and_b64 vcc, vcc, 0xffff
    s_cbranch_vccz L_92
    s_sleep 4
    s_mov_b64 exec, 0xffff
    v_mov_b32 v4, 0
    buffer_atomic_or v4, v24, s[16:19], s42 offen sc0 sc1
    s_mov_b64 exec, -1
    s_waitcnt vmcnt(2)
    v_cmp_ne_u32 vcc, s3, v5
    s_nop 0
    s_and_b64 vcc, vcc, 0xffff
    s_cbranch_vccz L_92
    s_sleep 4
    s_mov_b64 exec, 0xffff
    v_mov_b32 v5, 0
    buffer_atomic_or v5, v24, s[16:19], s42 offen sc0 sc1
    s_mov_b64 exec, -1
    s_waitcnt vmcnt(2)
    v_cmp_ne_u32 vcc, s3, v10
    s_nop 0
    s_and_b64 vcc, vcc, 0xffff
    s_cbranch_vccz L_92
    s_add_u32 s69, s69, 1
    s_cmp_gt_u32 s69, 0x40000
    s_cbranch_scc1 L_92
    s_sleep 2
    s_branch L_91
L_92:
L_84:
    s_mov_b64 exec, 1
    ds_add_u32 v250, v251 offset:4
    s_mov_b64 exec, -1
    s_cmp_eq_u32 s50, 6
    s_cbranch_scc0 L_90
    v_lshrrev_b32 v18, 6, v20
    v_lshrrev_b32 v19, 6, v21
    v_cmp_eq_u32 vcc, s54, v18
    v_cmp_eq_u32 s[58:59], s54, v19
    s_nop 0
    s_or_b64 vcc, vcc, s[58:59]
    s_cbranch_vccnz L_93
    s_cmp_eq_u32 s2, 0
    s_cbranch_scc0 L_90
L_93:
    v_and_b32 v76, 15, v1
    v_lshrrev_b32 v72, 4, v1
    v_lshlrev_b32 v76, 2, v76
    v_lshl_add_u32 v76, v72, 8, v76
L_94:
    v_mov_b32 v72, 0
    s_mov_b32 s60, 24576
    buffer_atomic_or v72, v76, s[16:19], s60 offen sc0 sc1
    v_mov_b32 v73, 0
    s_mov_b32 s60, 25600
    buffer_atomic_or v73, v76, s[16:19], s60 offen sc0 sc1
    v_mov_b32 v74, 0
    s_mov_b32 s60, 26624
    buffer_atomic_or v74, v76, s[16:19], s60 offen sc0 sc1
    v_mov_b32 v75, 0
    s_mov_b32 s60, 27648
    buffer_atomic_or v75, v76, s[16:19], s60 offen sc0 sc1
    s_waitcnt vmcnt(0)
    v_xor_b32 v72, s3, v72
    v_xor_b32 v73, s3, v73
    v_xor_b32 v74, s3, v74
    v_xor_b32 v75, s3, v75
    v_or3_b32 v72, v72, v73, v74
    v_or_b32 v72, v72, v75
    v_cmp_ne_u32 vcc, 0, v72
    s_cbranch_vccz L_95
    s_add_u32 s69, s69, 1
    s_cmp_gt_u32 s69, 0x40000
    s_cbranch_scc1 L_95
    s_sleep 2
    s_branch L_94
L_95:
    s_mov_b64 exec, 1
    ds_add_u32 v250, v251 offset:152
    s_mov_b64 exec, -1
    s_cmp_eq_u32 s2, 0
    s_cbranch_scc0 L_90
    v_mov_b32 v16, s3
    s_mov_b64 exec, 1
    buffer_store_dword v16, off, s[16:19], 0 sc1
    s_mov_b64 exec, -1
L_90:
L_96:
    ds_read_b32 v19, v250 offset:4
    s_waitcnt lgkmcnt(0)
    v_cmp_gt_u32 vcc, 3, v19
    s_cbranch_vccz L_96_d
    s_add_u32 s99, s99, 1
    s_cmp_gt_u32 s99, 0x1000000
    s_cbranch_scc1 L_96_d
    s_sleep 1
    s_branch L_96
L_96_d:
    s_mov_b32 s60, s66
    buffer_load_dwordx4 v[32:35], v11, s[16:19], s60 offen sc1
    s_add_u32 s60, s60, 266240
    s_cmp_eq_u32 s60, s67
    s_cselect_b32 s60, s62, s60
    buffer_load_dwordx4 v[36:39], v11, s[16:19], s60 offen sc1
    buffer_load_dwordx4 v[64:67], v26, s[16:19], s62 offen offset:1024 sc1
    s_add_u32 s60, s60, 266240
    s_cmp_eq_u32 s60, s67
    s_cselect_b32 s60, s62, s60
    buffer_load_dwordx4 v[40:43], v11, s[16:19], s60 offen sc1
    s_add_u32 s60, s60, 266240
    s_cmp_eq_u32 s60, s67
    s_cselect_b32 s60, s62, s60
    buffer_load_dwordx4 v[44:47], v11, s[16:19], s60 offen sc1
    buffer_load_dwordx4 v[68:71], v26, s[16:19], s68 offen offset:1024 sc1
    s_add_u32 s60, s60, 266240
    s_cmp_eq_u32 s60, s67
    s_cselect_b32 s60, s62, s60
    buffer_load_dwordx4 v[48:51], v11, s[16:19], s60 offen sc1
    s_add_u32 s60, s60, 266240
    s_cmp_eq_u32 s60, s67
    s_cselect_b32 s60, s62, s60
    buffer_load_dwordx4 v[52:55], v11, s[16:19], s60 offen sc1
    s_add_u32 s60, s60, 266240
    s_cmp_eq_u32 s60, s67
    s_cselect_b32 s60, s62, s60
    buffer_load_dwordx4 v[56:59], v11, s[16:19], s60 offen sc1
    s_add_u32 s60, s60, 266240
    s_cmp_eq_u32 s60, s67
    s_cselect_b32 s60, s62, s60
    buffer_load_dwordx4 v[60:63], v11, s[16:19], s60 offen sc1
    s_cmp_lt_u32 s50, 2
    s_cbranch_scc0 L_97
    buffer_load_dword v241, v247, s[16:19], s56 offen sc1
L_97:
    buffer_load_dword v240, v246, s[16:19], s56 offen sc1
L_85:
    v_readfirstlane_b32 s70, v20
    v_readfirstlane_b32 s71, v21
    v_mov_b32 v19, 0
    s_lshr_b32 s58, s70, 6
    s_lshr_b32 s59, s71, 6
    s_cmp_eq_u32 s58, s54
    s_cselect_b32 s58, 1, 0
    s_cmp_eq_u32 s59, s54
    s_cselect_b32 s63, 1, s58
    s_waitcnt vmcnt(10)
    v_mfma_f32_16x16x32_bf16 v[72:75], v[92:95], v[32:35], 0
    ds_read_b64_tr_b16 v[92:93], v8 offset:10240
    v_mfma_f32_16x16x32_bf16 v[76:79], v[96:99], v[32:35], 0
    ds_read_b64_tr_b16 v[94:95], v9 offset:10240
    v_mfma_f32_16x16x32_bf16 v[80:83], v[100:103], v[32:35], 0
    ds_read_b64_tr_b16 v[96:97], v8 offset:10248
    v_mfma_f32_16x16x32_bf16 v[84:87], v[104:107], v[32:35], 0
    ds_read_b64_tr_b16 v[98:99], v9 offset:10248
    v_mfma_f32_16x16x32_bf16 v[88:91], v[108:111], v[32:35], 0
    ds_read_b64_tr_b16 v[100:101], v8 offset:10256
    s_waitcnt vmcnt(9)
    v_mfma_f32_16x16x32_bf16 v[72:75], v[112:115], v[36:39], v[72:75]
    ds_read_b64_tr_b16 v[102:103], v9 offset:10256
    v_mfma_f32_16x16x32_bf16 v[76:79], v[116:119], v[36:39], v[76:79]
    ds_read_b64_tr_b16 v[104:105], v8 offset:10264
    v_mfma_f32_16x16x32_bf16 v[80:83], v[120:123], v[36:39], v[80:83]
    ds_read_b64_tr_b16 v[106:107], v9 offset:10264
    v_mfma_f32_16x16x32_bf16 v[84:87], v[124:127], v[36:39], v[84:87]
    ds_read_b64_tr_b16 v[108:109], v8 offset:10272
    v_mfma_f32_16x16x32_bf16 v[88:91], v[128:131], v[36:39], v[88:91]
    ds_read_b64_tr_b16 v[110:111], v9 offset:10272
    s_waitcnt vmcnt(7)
    v_mfma_f32_16x16x32_bf16 v[72:75], v[132:135], v[40:43], v[72:75]
    ds_read_b64_tr_b16 v[112:113], v12 offset:0
    v_mfma_f32_16x16x32_bf16 v[76:79], v[136:139], v[40:43], v[76:79]
    ds_read_b64_tr_b16 v[114:115], v13 offset:0
    v_mfma_f32_16x16x32_bf16 v[80:83], v[140:143], v[40:43], v[80:83]
    ds_read_b64_tr_b16 v[116:117], v12 offset:8
    v_mfma_f32_16x16x32_bf16 v[84:87], v[144:147], v[40:43], v[84:87]
    ds_read_b64_tr_b16 v[118:119], v13 offset:8
    v_mfma_f32_16x16x32_bf16 v[88:91], v[148:151], v[40:43], v[88:91]
    ds_read_b64_tr_b16 v[120:121], v12 offset:16
    s_waitcnt vmcnt(6)
    v_mfma_f32_16x16x32_bf16 v[72:75], v[152:155], v[44:47], v[72:75]
    s_waitcnt lgkmcnt(12)
    ds_read_b64_tr_b16 v[122:123], v13 offset:16
    v_mfma_f32_16x16x32_bf16 v[76:79], v[156:159], v[44:47], v[76:79]
    ds_read_b64_tr_b16 v[124:125], v12 offset:24
    v_mfma_f32_16x16x32_bf16 v[80:83], v[160:163], v[44:47], v[80:83]
    ds_read_b64_tr_b16 v[126:127], v13 offset:24
    v_mfma_f32_16x16x32_bf16 v[84:87], v[164:167], v[44:47], v[84:87]
    s_waitcnt lgkmcnt(12)
    ds_read_b64_tr_b16 v[128:129], v12 offset:32
    v_mfma_f32_16x16x32_bf16 v[88:91], v[168:171], v[44:47], v[88:91]
    ds_read_b64_tr_b16 v[130:131], v13 offset:32
    s_waitcnt vmcnt(4)
    v_mfma_f32_16x16x32_bf16 v[72:75], v[172:175], v[48:51], v[72:75]
    ds_read_b64_tr_b16 v[132:133], v12 offset:5120
    v_mfma_f32_16x16x32_bf16 v[76:79], v[176:179], v[48:51], v[76:79]
    s_waitcnt lgkmcnt(12)
    ds_read_b64_tr_b16 v[134:135], v13 offset:5120
    v_mfma_f32_16x16x32_bf16 v[80:83], v[180:183], v[48:51], v[80:83]
    ds_read_b64_tr_b16 v[136:137], v12 offset:5128
    v_mfma_f32_16x16x32_bf16 v[84:87], v[184:187], v[48:51], v[84:87]
    ds_read_b64_tr_b16 v[138:139], v13 offset:5128
    v_mfma_f32_16x16x32_bf16 v[88:91], v[188:191], v[48:51], v[88:91]
    s_waitcnt lgkmcnt(12)
    ds_read_b64_tr_b16 v[140:141], v12 offset:5136
    s_waitcnt vmcnt(3)
    v_mfma_f32_16x16x32_bf16 v[72:75], v[192:195], v[52:55], v[72:75]
    ds_read_b64_tr_b16 v[142:143], v13 offset:5136
    v_mfma_f32_16x16x32_bf16 v[76:79], v[196:199], v[52:55], v[76:79]
    ds_read_b64_tr_b16 v[144:145], v12 offset:5144
    v_mfma_f32_16x16x32_bf16 v[80:83], v[200:203], v[52:55], v[80:83]
    s_waitcnt lgkmcnt(12)
    ds_read_b64_tr_b16 v[146:147], v13 offset:5144
    v_mfma_f32_16x16x32_bf16 v[84:87], v[204:207], v[52:55], v[84:87]
    ds_read_b64_tr_b16 v[148:149], v12 offset:5152
    v_mfma_f32_16x16x32_bf16 v[88:91], v[208:211], v[52:55], v[88:91]
    ds_read_b64_tr_b16 v[150:151], v13 offset:5152
    s_waitcnt vmcnt(2)
    v_mfma_f32_16x16x32_bf16 v[72:75], v[92:95], v[56:59], v[72:75]
    s_waitcnt lgkmcnt(12)
    ds_read_b64_tr_b16 v[152:153], v12 offset:10240
    v_mfma_f32_16x16x32_bf16 v[76:79], v[96:99], v[56:59], v[76:79]
    ds_read_b64_tr_b16 v[154:155], v13 offset:10240
    v_mfma_f32_16x16x32_bf16 v[80:83], v[100:103], v[56:59], v[80:83]
    ds_read_b64_tr_b16 v[156:157], v12 offset:10248
    v_mfma_f32_16x16x32_bf16 v[84:87], v[104:107], v[56:59], v[84:87]
    s_waitcnt lgkmcnt(12)
    ds_read_b64_tr_b16 v[158:159], v13 offset:10248
    v_mfma_f32_16x16x32_bf16 v[88:91], v[108:111], v[56:59], v[88:91]
    ds_read_b64_tr_b16 v[160:161], v12 offset:10256
    s_waitcnt vmcnt(1)
    v_mfma_f32_16x16x32_bf16 v[72:75], v[112:115], v[60:63], v[72:75]
    ds_read_b64_tr_b16 v[162:163], v13 offset:10256
    v_mfma_f32_16x16x32_bf16 v[76:79], v[116:119], v[60:63], v[76:79]
    s_waitcnt lgkmcnt(12)
    ds_read_b64_tr_b16 v[164:165], v12 offset:10264
    v_mfma_f32_16x16x32_bf16 v[80:83], v[120:123], v[60:63], v[80:83]
    ds_read_b64_tr_b16 v[166:167], v13 offset:10264
    v_mfma_f32_16x16x32_bf16 v[84:87], v[124:127], v[60:63], v[84:87]
    ds_read_b64_tr_b16 v[168:169], v12 offset:10272
    v_mfma_f32_16x16x32_bf16 v[88:91], v[128:131], v[60:63], v[88:91]
    s_waitcnt lgkmcnt(12)
    ds_read_b64_tr_b16 v[170:171], v13 offset:10272
    v_mfma_f32_16x16x32_bf16 v[72:75], v[132:135], v[64:67], v[72:75]
    v_mfma_f32_16x16x32_bf16 v[76:79], v[136:139], v[64:67], v[76:79]
    v_mfma_f32_16x16x32_bf16 v[80:83], v[140:143], v[64:67], v[80:83]
    s_waitcnt lgkmcnt(12)
    v_mfma_f32_16x16x32_bf16 v[84:87], v[144:147], v[64:67], v[84:87]
    s_waitcnt lgkmcnt(10)
    v_mfma_f32_16x16x32_bf16 v[88:91], v[148:151], v[64:67], v[88:91]
    s_waitcnt lgkmcnt(8)
    v_mfma_f32_16x16x32_bf16 v[72:75], v[152:155], v[68:71], v[72:75]
    s_waitcnt lgkmcnt(6)
    v_mfma_f32_16x16x32_bf16 v[76:79], v[156:159], v[68:71], v[76:79]
    s_waitcnt lgkmcnt(4)
    v_mfma_f32_16x16x32_bf16 v[80:83], v[160:163], v[68:71], v[80:83]
    s_waitcnt lgkmcnt(2)
    v_mfma_f32_16x16x32_bf16 v[84:87], v[164:167], v[68:71], v[84:87]
    s_waitcnt lgkmcnt(0)
    v_mfma_f32_16x16x32_bf16 v[88:91], v[168:171], v[68:71], v[88:91]
    v_cmp_u_f32 vcc, v72, v72
    s_cbranch_vccz L_83
    v_max3_u32 v19, v19, v32, v33
    v_max3_u32 v19, v19, v34, v35
    v_max3_u32 v19, v19, v36, v37
    v_max3_u32 v19, v19, v38, v39
    v_max3_u32 v19, v19, v40, v41
    v_max3_u32 v19, v19, v42, v43
    v_max3_u32 v19, v19, v44, v45
    v_max3_u32 v19, v19, v46, v47
    v_max3_u32 v19, v19, v48, v49
    v_max3_u32 v19, v19, v50, v51
    v_max3_u32 v19, v19, v52, v53
    v_max3_u32 v19, v19, v54, v55
    v_max3_u32 v19, v19, v56, v57
    v_max3_u32 v19, v19, v58, v59
    v_max3_u32 v19, v19, v60, v61
    v_max3_u32 v19, v19, v62, v63
    v_max3_u32 v19, v19, v64, v65
    v_max3_u32 v19, v19, v66, v67
    v_max3_u32 v19, v19, v68, v69
    v_max3_u32 v19, v19, v70, v71
    v_cmp_eq_u32 vcc, -1, v19
    s_cbranch_vccz L_83
    s_add_u32 s69, s69, 1
    s_cmp_gt_u32 s69, 0x40000
    s_cbranch_scc1 L_83
    s_sleep 2
    s_branch L_82
L_83:
    s_cmp_lt_u32 s50, 4
    s_cbranch_scc0 L_98
L_99:
    ds_read_b32 v19, v250 offset:156
    s_waitcnt lgkmcnt(0)
    v_cmp_gt_u32 vcc, 1, v19
    s_cbranch_vccz L_99_d
    s_add_u32 s99, s99, 1
    s_cmp_gt_u32 s99, 0x1000000
    s_cbranch_scc1 L_99_d
    s_sleep 1
    s_branch L_99
L_99_d:
L_98:
    ds_write_b128 v25, v[72:75] offset:0
    ds_write_b128 v25, v[76:79] offset:16
    ds_write_b128 v25, v[80:83] offset:32
    ds_write_b128 v25, v[84:87] offset:48
    ds_write_b128 v25, v[88:91] offset:64
    s_cmp_eq_u32 s63, 0
    s_cbranch_scc1 L_100
    s_cmp_eq_u32 s50, 3
    s_cbranch_scc0 L_100
    v_and_b32 v14, 31, v1
    v_lshrrev_b32 v15, 5, v1
    v_mul_u32_u24 v17, 160, v15
    v_lshl_add_u32 v17, v14, 4, v17
    v_add_u32 v18, 16480, v17
    v_cmp_gt_u32 vcc, 10, v14
    s_nop 1
    v_cndmask_b32 v17, v18, v17, vcc
    v_cmp_gt_u32 vcc, 20, v14
    s_nop 1
    v_cndmask_b32 v17, v31, v17, vcc
    v_cmp_eq_u32 vcc, 0, v15
    s_nop 1
    v_cndmask_b32 v24, v23, v22, vcc
    v_mul_u32_u24 v18, 320, v15
    v_lshl_add_u32 v18, v14, 4, v18
    v_add_u32 v18, 162048, v18
L_101:
    ds_read_b32 v19, v250 offset:152
    s_waitcnt lgkmcnt(0)
    v_cmp_gt_u32 vcc, 1, v19
    s_cbranch_vccz L_101_d
    s_add_u32 s99, s99, 1
    s_cmp_gt_u32 s99, 0x1000000
    s_cbranch_scc1 L_101_d
    s_sleep 1
    s_branch L_101
L_101_d:
L_102:
    s_mul_i32 s60, s55, 33280
    s_add_u32 s60, s60, 3357952
    buffer_load_dwordx4 v[92:95], v17, s[16:19], s60 offen sc1
    s_add_u32 s60, s60, 266240
    buffer_load_dwordx4 v[96:99], v17, s[16:19], s60 offen sc1
    s_add_u32 s60, s60, 266240
    buffer_load_dwordx4 v[100:103], v17, s[16:19], s60 offen sc1
    s_add_u32 s60, s60, 266240
    buffer_load_dwordx4 v[104:107], v17, s[16:19], s60 offen sc1
    s_add_u32 s60, s60, 266240
    buffer_load_dwordx4 v[108:111], v17, s[16:19], s60 offen sc1
    s_add_u32 s60, s60, 266240
    buffer_load_dwordx4 v[112:115], v17, s[16:19], s60 offen sc1
    s_add_u32 s60, s60, 266240
    buffer_load_dwordx4 v[116:119], v17, s[16:19], s60 offen sc1
    s_add_u32 s60, s60, 266240
    buffer_load_dwordx4 v[120:123], v17, s[16:19], s60 offen sc1
    s_add_u32 s60, s60, 266240
    buffer_load_dwordx4 v[124:127], v17, s[16:19], s60 offen sc1
    s_add_u32 s60, s60, 266240
    buffer_load_dwordx4 v[128:131], v17, s[16:19], s60 offen sc1
    s_add_u32 s60, s60, 266240
    buffer_load_dwordx4 v[132:135], v17, s[16:19], s60 offen sc1
    s_add_u32 s60, s60, 266240
    buffer_load_dwordx4 v[136:139], v17, s[16:19], s60 offen sc1
    s_add_u32 s60, s60, 266240
    buffer_load_dwordx4 v[140:143], v17, s[16:19], s60 offen sc1
    s_add_u32 s60, s60, 266240
    buffer_load_dwordx4 v[144:147], v17, s[16:19], s60 offen sc1
    s_add_u32 s60, s60, 266240
    buffer_load_dwordx4 v[148:151], v17, s[16:19], s60 offen sc1
    s_add_u32 s60, s60, 266240
    buffer_load_dwordx4 v[152:155], v17, s[16:19], s60 offen sc1
    s_waitcnt vmcnt(0)
    v_mov_b32 v19, 0
    v_max3_u32 v19, v19, v92, v93
    v_max3_u32 v19, v19, v94, v95
    v_max3_u32 v19, v19, v96, v97
    v_max3_u32 v19, v19, v98, v99
    v_pk_add_f32 v[92:93], v[92:93], v[96:97]
    v_pk_add_f32 v[94:95], v[94:95], v[98:99]
    v_max3_u32 v19, v19, v100, v101
    v_max3_u32 v19, v19, v102, v103
    v_pk_add_f32 v[92:93], v[92:93], v[100:101]
    v_pk_add_f32 v[94:95], v[94:95], v[102:103]
    v_max3_u32 v19, v19, v104, v105
    v_max3_u32 v19, v19, v106, v107
    v_pk_add_f32 v[92:93], v[92:93], v[104:105]
    v_pk_add_f32 v[94:95], v[94:95], v[106:107]
    v_max3_u32 v19, v19, v108, v109
    v_max3_u32 v19, v19, v110, v111
    v_pk_add_f32 v[92:93], v[92:93], v[108:109]
    v_pk_add_f32 v[94:95], v[94:95], v[110:111]
    v_max3_u32 v19, v19, v112, v113
    v_max3_u32 v19, v19, v114, v115
    v_pk_add_f32 v[92:93], v[92:93], v[112:113]
    v_pk_add_f32 v[94:95], v[94:95], v[114:115]
    v_max3_u32 v19, v19, v116, v117
    v_max3_u32 v19, v19, v118, v119
    v_pk_add_f32 v[92:93], v[92:93], v[116:117]
    v_pk_add_f32 v[94:95], v[94:95], v[118:119]
    v_max3_u32 v19, v19, v120, v121
    v_max3_u32 v19, v19, v122, v123
    v_pk_add_f32 v[92:93], v[92:93], v[120:121]
    v_pk_add_f32 v[94:95], v[94:95], v[122:123]
    v_max3_u32 v19, v19, v124, v125
    v_max3_u32 v19, v19, v126, v127
    v_pk_add_f32 v[92:93], v[92:93], v[124:125]
    v_pk_add_f32 v[94:95], v[94:95], v[126:127]
    v_max3_u32 v19, v19, v128, v129
    v_max3_u32 v19, v19, v130, v131
    v_pk_add_f32 v[92:93], v[92:93], v[128:129]
    v_pk_add_f32 v[94:95], v[94:95], v[130:131]
    v_max3_u32 v19, v19, v132, v133
    v_max3_u32 v19, v19, v134, v135
    v_pk_add_f32 v[92:93], v[92:93], v[132:133]
    v_pk_add_f32 v[94:95], v[94:95], v[134:135]
    v_max3_u32 v19, v19, v136, v137
    v_max3_u32 v19, v19, v138, v139
    v_pk_add_f32 v[92:93], v[92:93], v[136:137]
    v_pk_add_f32 v[94:95], v[94:95], v[138:139]
    v_max3_u32 v19, v19, v140, v141
    v_max3_u32 v19, v19, v142, v143
    v_pk_add_f32 v[92:93], v[92:93], v[140:141]
    v_pk_add_f32 v[94:95], v[94:95], v[142:143]
    v_max3_u32 v19, v19, v144, v145
    v_max3_u32 v19, v19, v146, v147
    v_pk_add_f32 v[92:93], v[92:93], v[144:145]
    v_pk_add_f32 v[94:95], v[94:95], v[146:147]
    v_max3_u32 v19, v19, v148, v149
    v_max3_u32 v19, v19, v150, v151
    v_pk_add_f32 v[92:93], v[92:93], v[148:149]
    v_pk_add_f32 v[94:95], v[94:95], v[150:151]
    v_max3_u32 v19, v19, v152, v153
    v_max3_u32 v19, v19, v154, v155
    v_pk_add_f32 v[92:93], v[92:93], v[152:153]
    v_pk_add_f32 v[94:95], v[94:95], v[154:155]
    v_cmp_eq_u32 vcc, -1, v19
    s_cbranch_vccz L_103
    s_add_u32 s69, s69, 1
    s_cmp_gt_u32 s69, 0x40000
    s_cbranch_scc1 L_103
    s_sleep 2
    s_branch L_102
L_103:
    v_mul_f32 v92, v92, v24
    v_mul_f32 v93, v93, v24
    v_mul_f32 v94, v94, v24
    v_mul_f32 v95, v95, v24
    v_cmp_gt_u32 vcc, 20, v14
    s_nop 0
    s_mov_b64 exec, vcc
    ds_write_b128 v18, v[92:95]
    s_mov_b64 exec, -1
L_100:
    s_waitcnt vmcnt(0)
    v_lshlrev_b32 v48, 16, v232
    v_and_b32 v49, 0xffff0000, v232
    v_lshlrev_b32 v50, 16, v233
    v_and_b32 v51, 0xffff0000, v233
    v_lshlrev_b32 v52, 16, v234
    v_and_b32 v53, 0xffff0000, v234
    v_lshlrev_b32 v54, 16, v235
    v_and_b32 v55, 0xffff0000, v235
    v_sub_f32 v18, 1.0, v240
    v_cvt_pk_bf16_f32 v18, v18, v18
    v_and_b32 v18, 0xffff0000, v18
    v_mov_b32 v20, v240
    s_waitcnt lgkmcnt(0)
    s_barrier
    ds_read_b128 v[32:35], v29
    ds_read_b128 v[36:39], v29 offset:16
    ds_read_b128 v[40:43], v248
    ds_read_b128 v[44:47], v248 offset:16
    s_cmp_lt_u32 s50, 2
    s_cbranch_scc0 L_105
    ds_read_b128 v[96:99], v30
    ds_read_b128 v[100:103], v30 offset:16
    ds_read_b128 v[104:107], v249
    ds_read_b128 v[108:111], v249 offset:16
L_105:
    s_cmp_eq_u32 s63, 0
    s_cbranch_scc1 L_106
    s_lshl_b32 s60, s54, 6
    v_add_u32 v16, s60, v242
    v_lshlrev_b32 v17, 5, v244
    v_add_u32 v17, 162048, v17
    v_cmp_eq_u32 vcc, s70, v16
    s_nop 0
    s_and_saveexec_b64 s[58:59], vcc
    s_cbranch_execz L_107
    ds_read_b128 v[56:59], v17 offset:0
    ds_read_b128 v[60:63], v17 offset:16
    s_waitcnt lgkmcnt(0)
    v_add_f32 v48, v48, v56
    v_add_f32 v49, v49, v57
    v_add_f32 v50, v50, v58
    v_add_f32 v51, v51, v59
    v_add_f32 v52, v52, v60
    v_add_f32 v53, v53, v61
    v_add_f32 v54, v54, v62
    v_add_f32 v55, v55, v63
L_107:
    s_mov_b64 exec, -1
    v_cmp_eq_u32 vcc, s71, v16
    s_nop 0
    s_and_saveexec_b64 s[58:59], vcc
    s_cbranch_execz L_108
    ds_read_b128 v[56:59], v17 offset:320
    ds_read_b128 v[60:63], v17 offset:336
    s_waitcnt lgkmcnt(0)
    v_add_f32 v48, v48, v56
    v_add_f32 v49, v49, v57
    v_add_f32 v50, v50, v58
    v_add_f32 v51, v51, v59
    v_add_f32 v52, v52, v60
    v_add_f32 v53, v53, v61
    v_add_f32 v54, v54, v62
    v_add_f32 v55, v55, v63
L_108:
    s_mov_b64 exec, -1
L_106:
    v_pk_mul_f32 v[48:49], v[48:49], v[18:19] op_sel_hi:[1,0]
    v_pk_mul_f32 v[50:51], v[50:51], v[18:19] op_sel_hi:[1,0]
    v_pk_mul_f32 v[52:53], v[52:53], v[18:19] op_sel_hi:[1,0]
    v_pk_mul_f32 v[54:55], v[54:55], v[18:19] op_sel_hi:[1,0]
    s_waitcnt lgkmcnt(0)
    v_pk_add_f32 v[32:33], v[32:33], v[40:41]
    v_pk_add_f32 v[34:35], v[34:35], v[42:43]
    v_pk_add_f32 v[36:37], v[36:37], v[44:45]
    v_pk_add_f32 v[38:39], v[38:39], v[46:47]
    v_pk_fma_f32 v[32:33], v[32:33], v[20:21], v[48:49] op_sel_hi:[1,0,1]
    v_pk_fma_f32 v[34:35], v[34:35], v[20:21], v[50:51] op_sel_hi:[1,0,1]
    v_pk_fma_f32 v[36:37], v[36:37], v[20:21], v[52:53] op_sel_hi:[1,0,1]
    v_pk_fma_f32 v[38:39], v[38:39], v[20:21], v[54:55] op_sel_hi:[1,0,1]
    v_cvt_pk_bf16_f32 v64, v32, v33
    v_cvt_pk_bf16_f32 v65, v34, v35
    v_cvt_pk_bf16_f32 v66, v36, v37
    v_cvt_pk_bf16_f32 v67, v38, v39
    buffer_store_dwordx4 v[64:67], v27, s[20:23], s61 offen
    s_cmp_lt_u32 s50, 2
    s_cbranch_scc0 L_104
    v_lshlrev_b32 v48, 16, v236
    v_and_b32 v49, 0xffff0000, v236
    v_lshlrev_b32 v50, 16, v237
    v_and_b32 v51, 0xffff0000, v237
    v_lshlrev_b32 v52, 16, v238
    v_and_b32 v53, 0xffff0000, v238
    v_lshlrev_b32 v54, 16, v239
    v_and_b32 v55, 0xffff0000, v239
    v_sub_f32 v18, 1.0, v241
    v_cvt_pk_bf16_f32 v18, v18, v18
    v_and_b32 v18, 0xffff0000, v18
    v_mov_b32 v20, v241
    s_cmp_eq_u32 s63, 0
    s_cbranch_scc1 L_109
    s_lshl_b32 s60, s54, 6
    v_add_u32 v16, s60, v243
    v_lshlrev_b32 v17, 5, v245
    v_add_u32 v17, 162048, v17
    v_cmp_eq_u32 vcc, s70, v16
    s_nop 0
    s_and_saveexec_b64 s[58:59], vcc
    s_cbranch_execz L_110
    ds_read_b128 v[56:59], v17 offset:0
    ds_read_b128 v[60:63], v17 offset:16
    s_waitcnt lgkmcnt(0)
    v_add_f32 v48, v48, v56
    v_add_f32 v49, v49, v57
    v_add_f32 v50, v50, v58
    v_add_f32 v51, v51, v59
    v_add_f32 v52, v52, v60
    v_add_f32 v53, v53, v61
    v_add_f32 v54, v54, v62
    v_add_f32 v55, v55, v63
L_110:
    s_mov_b64 exec, -1
    v_cmp_eq_u32 vcc, s71, v16
    s_nop 0
    s_and_saveexec_b64 s[58:59], vcc
    s_cbranch_execz L_111
    ds_read_b128 v[56:59], v17 offset:320
    ds_read_b128 v[60:63], v17 offset:336
    s_waitcnt lgkmcnt(0)
    v_add_f32 v48, v48, v56
    v_add_f32 v49, v49, v57
    v_add_f32 v50, v50, v58
    v_add_f32 v51, v51, v59
    v_add_f32 v52, v52, v60
    v_add_f32 v53, v53, v61
    v_add_f32 v54, v54, v62
    v_add_f32 v55, v55, v63
L_111:
    s_mov_b64 exec, -1
L_109:
    v_pk_mul_f32 v[48:49], v[48:49], v[18:19] op_sel_hi:[1,0]
    v_pk_mul_f32 v[50:51], v[50:51], v[18:19] op_sel_hi:[1,0]
    v_pk_mul_f32 v[52:53], v[52:53], v[18:19] op_sel_hi:[1,0]
    v_pk_mul_f32 v[54:55], v[54:55], v[18:19] op_sel_hi:[1,0]
    s_waitcnt lgkmcnt(0)
    v_pk_add_f32 v[96:97], v[96:97], v[104:105]
    v_pk_add_f32 v[98:99], v[98:99], v[106:107]
    v_pk_add_f32 v[100:101], v[100:101], v[108:109]
    v_pk_add_f32 v[102:103], v[102:103], v[110:111]
    v_pk_fma_f32 v[96:97], v[96:97], v[20:21], v[48:49] op_sel_hi:[1,0,1]
    v_pk_fma_f32 v[98:99], v[98:99], v[20:21], v[50:51] op_sel_hi:[1,0,1]
    v_pk_fma_f32 v[100:101], v[100:101], v[20:21], v[52:53] op_sel_hi:[1,0,1]
    v_pk_fma_f32 v[102:103], v[102:103], v[20:21], v[54:55] op_sel_hi:[1,0,1]
    v_cvt_pk_bf16_f32 v68, v96, v97
    v_cvt_pk_bf16_f32 v69, v98, v99
    v_cvt_pk_bf16_f32 v70, v100, v101
    v_cvt_pk_bf16_f32 v71, v102, v103
    buffer_store_dwordx4 v[68:71], v28, s[20:23], s61 offen
L_104:
L_end:
    s_endpgm
.p2align 8
.type L_tab,@object
L_tab:
.long 0x0, 0x280, 0x19000, 0x19000, 0x8, 0x288, 0x19008, 0x19008
.long 0x10, 0x290, 0x19010, 0x19000, 0x18, 0x298, 0x19018, 0x19008
.long 0xa0, 0x320, 0x190a0, 0x190a0, 0xa8, 0x328, 0x190a8, 0x190a8
.long 0xb0, 0x330, 0x190b0, 0x190a0, 0xb8, 0x338, 0x190b8, 0x190a8
.long 0x140, 0x3c0, 0x19140, 0x19140, 0x148, 0x3c8, 0x19148, 0x19148
.long 0x150, 0x3d0, 0x19150, 0x19140, 0x158, 0x3d8, 0x19158, 0x19148
.long 0x1e0, 0x460, 0x191e0, 0x191e0, 0x1e8, 0x468, 0x191e8, 0x191e8
.long 0x1f0, 0x470, 0x191f0, 0x191e0, 0x1f8, 0x478, 0x191f8, 0x191e8
.long 0x780, 0x500, 0x19280, 0x19280, 0x788, 0x508, 0x19288, 0x19288
.long 0x790, 0x510, 0x19290, 0x19280, 0x798, 0x518, 0x19298, 0x19288
.long 0x820, 0x5a0, 0x19320, 0x19320, 0x828, 0x5a8, 0x19328, 0x19328
.long 0x830, 0x5b0, 0x19330, 0x19320, 0x838, 0x5b8, 0x19338, 0x19328
.long 0x8c0, 0x640, 0x193c0, 0x193c0, 0x8c8, 0x648, 0x193c8, 0x193c8
.long 0x8d0, 0x650, 0x193d0, 0x193c0, 0x8d8, 0x658, 0x193d8, 0x193c8
.long 0x960, 0x6e0, 0x19460, 0x19460, 0x968, 0x6e8, 0x19468, 0x19468
.long 0x970, 0x6f0, 0x19470, 0x19460, 0x978, 0x6f8, 0x19478, 0x19468
.long 0xa00, 0xc80, 0x19500, 0x19500, 0xa08, 0xc88, 0x19508, 0x19508
.long 0xa10, 0xc90, 0x19510, 0x19500, 0xa18, 0xc98, 0x19518, 0x19508
.long 0xaa0, 0xd20, 0x195a0, 0x195a0, 0xaa8, 0xd28, 0x195a8, 0x195a8
.long 0xab0, 0xd30, 0x195b0, 0x195a0, 0xab8, 0xd38, 0x195b8, 0x195a8
.long 0xb40, 0xdc0, 0x19640, 0x19640, 0xb48, 0xdc8, 0x19648, 0x19648
.long 0xb50, 0xdd0, 0x19650, 0x19640, 0xb58, 0xdd8, 0x19658, 0x19648
.long 0xbe0, 0xe60, 0x196e0, 0x196e0, 0xbe8, 0xe68, 0x196e8, 0x196e8
.long 0xbf0, 0xe70, 0x196f0, 0x196e0, 0xbf8, 0xe78, 0x196f8, 0x196e8
.long 0x1180, 0xf00, 0x19780, 0x19780, 0x1188, 0xf08, 0x19788, 0x19788
.long 0x1190, 0xf10, 0x19790, 0x19780, 0x1198, 0xf18, 0x19798, 0x19788
.long 0x1220, 0xfa0, 0x19820, 0x19820, 0x1228, 0xfa8, 0x19828, 0x19828
.long 0x1230, 0xfb0, 0x19830, 0x19820, 0x1238, 0xfb8, 0x19838, 0x19828
.long 0x12c0, 0x1040, 0x198c0, 0x198c0, 0x12c8, 0x1048, 0x198c8, 0x198c8
.long 0x12d0, 0x1050, 0x198d0, 0x198c0, 0x12d8, 0x1058, 0x198d8, 0x198c8
.long 0x1360, 0x10e0, 0x19960, 0x19960, 0x1368, 0x10e8, 0x19968, 0x19968
.long 0x1370, 0x10f0, 0x19970, 0x19960, 0x1378, 0x10f8, 0x19978, 0x19968
.long 0x26200, 0x26480, 0xb800, 0x6400, 0x26840, 0x26ac0, 0xb868, 0x64a8
.long 0x26e80, 0x26e80, 0xb8d0, 0x6550, 0x26e80, 0x26e80, 0xb938, 0x65f8
.long 0x26228, 0x264a8, 0xb9a0, 0x66a0, 0x26868, 0x26ae8, 0xba08, 0x6748
.long 0x26e80, 0x26e80, 0xba70, 0x67f0, 0x26e80, 0x26e80, 0xbad8, 0x6898
.long 0x26250, 0x264d0, 0xbb40, 0x6940, 0x26890, 0x26b10, 0xbba8, 0x69e8
.long 0x26e80, 0x26e80, 0xbc10, 0x6a90, 0x26e80, 0x26e80, 0xbc78, 0x6b38
.long 0x26278, 0x264f8, 0xbce0, 0x6be0, 0x268b8, 0x26b38, 0xbd48, 0x6c88
.long 0x26e80, 0x26e80, 0xbdb0, 0x6d30, 0x26e80, 0x26e80, 0xbe18, 0x6dd8
.long 0x262a0, 0x26e80, 0xb808, 0x6428, 0x268e0, 0x26e80, 0xb870, 0x64d0
.long 0x26e80, 0x26520, 0xb8d8, 0x6578, 0x26e80, 0x26b60, 0xb940, 0x6620
.long 0x262c8, 0x26e80, 0xb9a8, 0x66c8, 0x26908, 0x26e80, 0xba10, 0x6770
.long 0x26e80, 0x26548, 0xba78, 0x6818, 0x26e80, 0x26b88, 0xbae0, 0x68c0
.long 0x262f0, 0x26e80, 0xbb48, 0x6968, 0x26930, 0x26e80, 0xbbb0, 0x6a10
.long 0x26e80, 0x26570, 0xbc18, 0x6ab8, 0x26e80, 0x26bb0, 0xbc80, 0x6b60
.long 0x26318, 0x26e80, 0xbce8, 0x6c08, 0x26958, 0x26e80, 0xbd50, 0x6cb0
.long 0x26e80, 0x26598, 0xbdb8, 0x6d58, 0x26e80, 0x26bd8, 0xbe20, 0x6e00
.long 0x26340, 0x26e80, 0xb810, 0x6450, 0x26980, 0x26e80, 0xb878, 0x64f8
.long 0x26e80, 0x265c0, 0xb8e0, 0x65a0, 0x26e80, 0x26c00, 0xb948, 0x6648
.long 0x26368, 0x26e80, 0xb9b0, 0x66f0, 0x269a8, 0x26e80, 0xba18, 0x6798
.long 0x26e80, 0x265e8, 0xba80, 0x6840, 0x26e80, 0x26c28, 0xbae8, 0x68e8
.long 0x26390, 0x26e80, 0xbb50, 0x6990, 0x269d0, 0x26e80, 0xbbb8, 0x6a38
.long 0x26e80, 0x26610, 0xbc20, 0x6ae0, 0x26e80, 0x26c50, 0xbc88, 0x6b88
.long 0x263b8, 0x26e80, 0xbcf0, 0x6c30, 0x269f8, 0x26e80, 0xbd58, 0x6cd8
.long 0x26e80, 0x26638, 0xbdc0, 0x6d80, 0x26e80, 0x26c78, 0xbe28, 0x6e28
.long 0x263e0, 0x26e80, 0xb818, 0x6478, 0x26a20, 0x26e80, 0xb880, 0x6520
.long 0x26e80, 0x26660, 0xb8e8, 0x65c8, 0x26e80, 0x26ca0, 0xb950, 0x6670
.long 0x26408, 0x26e80, 0xb9b8, 0x6718, 0x26a48, 0x26e80, 0xba20, 0x67c0
.long 0x26e80, 0x26688, 0xba88, 0x6868, 0x26e80, 0x26cc8, 0xbaf0, 0x6910
.long 0x26430, 0x26e80, 0xbb58, 0x69b8, 0x26a70, 0x26e80, 0xbbc0, 0x6a60
.long 0x26e80, 0x266b0, 0xbc28, 0x6b08, 0x26e80, 0x26cf0, 0xbc90, 0x6bb0
.long 0x26458, 0x26e80, 0xbcf8, 0x6c58, 0x26a98, 0x26e80, 0xbd60, 0x6d00
.long 0x26e80, 0x266d8, 0xbdc8, 0x6da8, 0x26e80, 0x26d18, 0xbe30, 0x6e50
.long 0x6400, 0x6580, 0x6700, 0x0, 0x6460, 0x65e0, 0x6760, 0x10
.long 0x64c0, 0x6640, 0x6b80, 0x20, 0x6520, 0x66a0, 0x6b80, 0x30
.long 0x67c0, 0x6940, 0x6ac0, 0x40, 0x6820, 0x69a0, 0x6b20, 0x50
.long 0x6880, 0x6a00, 0x6b80, 0x60, 0x68e0, 0x6a60, 0x6b80, 0x70
.long 0x26e80, 0x26e80, 0x26e80, 0x80, 0x26e80, 0x26e80, 0x26e80, 0x90
.long 0x26e80, 0x26e80, 0x26e80, 0xa0, 0x26e80, 0x26e80, 0x26e80, 0xb0
.long 0x26e80, 0x26e80, 0x26e80, 0xc0, 0x26e80, 0x26e80, 0x26e80, 0xd0
.long 0x26e80, 0x26e80, 0x26e80, 0xe0, 0x26e80, 0x26e80, 0x26e80, 0xf0
.long 0x6430, 0x65b0, 0x6730, 0x100, 0x6490, 0x6610, 0x6790, 0x110
.long 0x64f0, 0x6670, 0x6bb0, 0x120, 0x6550, 0x66d0, 0x6bb0, 0x130
.long 0x67f0, 0x6970, 0x6af0, 0x140, 0x6850, 0x69d0, 0x6b50, 0x150
.long 0x68b0, 0x6a30, 0x6bb0, 0x160, 0x6910, 0x6a90, 0x6bb0, 0x170
.long 0x26e80, 0x26e80, 0x26e80, 0x180, 0x26e80, 0x26e80, 0x26e80, 0x190
.long 0x26e80, 0x26e80, 0x26e80, 0x1a0, 0x26e80, 0x26e80, 0x26e80, 0x1b0
.long 0x26e80, 0x26e80, 0x26e80, 0x1c0, 0x26e80, 0x26e80, 0x26e80, 0x1d0
.long 0x26e80, 0x26e80, 0x26e80, 0x1e0, 0x26e80, 0x26e80, 0x26e80, 0x1f0
.long 0x26e80, 0x26e80, 0x26e80, 0x200, 0x26e80, 0x26e80, 0x26e80, 0x210
.long 0x26e80, 0x26e80, 0x26e80, 0x220, 0x26e80, 0x26e80, 0x26e80, 0x230
.long 0x26e80, 0x26e80, 0x26e80, 0x240, 0x26e80, 0x26e80, 0x26e80, 0x250
.long 0x26e80, 0x26e80, 0x26e80, 0x260, 0x26e80, 0x26e80, 0x26e80, 0x270
.long 0x6d00, 0x6e80, 0x7000, 0x280, 0x6d60, 0x6ee0, 0x7060, 0x290
.long 0x6dc0, 0x6f40, 0x7480, 0x2a0, 0x6e20, 0x6fa0, 0x7480, 0x2b0
.long 0x70c0, 0x7240, 0x73c0, 0x2c0, 0x7120, 0x72a0, 0x7420, 0x2d0
.long 0x7180, 0x7300, 0x7480, 0x2e0, 0x71e0, 0x7360, 0x7480, 0x2f0
.long 0x26e80, 0x26e80, 0x26e80, 0x300, 0x26e80, 0x26e80, 0x26e80, 0x310
.long 0x26e80, 0x26e80, 0x26e80, 0x320, 0x26e80, 0x26e80, 0x26e80, 0x330
.long 0x26e80, 0x26e80, 0x26e80, 0x340, 0x26e80, 0x26e80, 0x26e80, 0x350
.long 0x26e80, 0x26e80, 0x26e80, 0x360, 0x26e80, 0x26e80, 0x26e80, 0x370
.long 0x6d30, 0x6eb0, 0x7030, 0x380, 0x6d90, 0x6f10, 0x7090, 0x390
.long 0x6df0, 0x6f70, 0x74b0, 0x3a0, 0x6e50, 0x6fd0, 0x74b0, 0x3b0
.long 0x70f0, 0x7270, 0x73f0, 0x3c0, 0x7150, 0x72d0, 0x7450, 0x3d0
.long 0x71b0, 0x7330, 0x74b0, 0x3e0, 0x7210, 0x7390, 0x74b0, 0x3f0
.long 0x5000, 0x25800, 0x27000, 0x26e80, 0x5080, 0x25d00, 0x27008, 0x26e80
.long 0x5110, 0x25800, 0x27010, 0x26700, 0x5190, 0x25d00, 0x27018, 0x26d40
.long 0x5220, 0x25800, 0x27020, 0x26e80, 0x52a0, 0x25d00, 0x27028, 0x26e80
.long 0x5330, 0x25800, 0x27030, 0x26728, 0x53b0, 0x25d00, 0x27038, 0x26d68
.long 0x5440, 0x25800, 0x27040, 0x26e80, 0x54c0, 0x25d00, 0x27048, 0x26e80
.long 0x5550, 0x25800, 0x27050, 0x26750, 0x55d0, 0x25d00, 0x27058, 0x26d90
.long 0x5660, 0x25800, 0x27060, 0x26e80, 0x56e0, 0x25d00, 0x27068, 0x26e80
.long 0x5770, 0x25800, 0x27070, 0x26778, 0x57f0, 0x25d00, 0x27078, 0x26db8
.long 0x5010, 0x25810, 0x27000, 0x26e80, 0x5090, 0x25d10, 0x27008, 0x26e80
.long 0x5100, 0x25810, 0x27010, 0x267a0, 0x5180, 0x25d10, 0x27018, 0x26de0
.long 0x5230, 0x25810, 0x27020, 0x26e80, 0x52b0, 0x25d10, 0x27028, 0x26e80
.long 0x5320, 0x25810, 0x27030, 0x267c8, 0x53a0, 0x25d10, 0x27038, 0x26e08
.long 0x5450, 0x25810, 0x27040, 0x26e80, 0x54d0, 0x25d10, 0x27048, 0x26e80
.long 0x5540, 0x25810, 0x27050, 0x267f0, 0x55c0, 0x25d10, 0x27058, 0x26e30
.long 0x5670, 0x25810, 0x27060, 0x26e80, 0x56f0, 0x25d10, 0x27068, 0x26e80
.long 0x5760, 0x25810, 0x27070, 0x26818, 0x57e0, 0x25d10, 0x27078, 0x26e58
.long 0x5020, 0x25820, 0x27000, 0x26e80, 0x50a0, 0x25d20, 0x27008, 0x26e80
.long 0x5130, 0x25820, 0x27010, 0x26e80, 0x51b0, 0x25d20, 0x27018, 0x26e80
.long 0x5200, 0x25820, 0x27020, 0x26e80, 0x5280, 0x25d20, 0x27028, 0x26e80
.long 0x5310, 0x25820, 0x27030, 0x26e80, 0x5390, 0x25d20, 0x27038, 0x26e80
.long 0x5460, 0x25820, 0x27040, 0x26e80, 0x54e0, 0x25d20, 0x27048, 0x26e80
.long 0x5570, 0x25820, 0x27050, 0x26e80, 0x55f0, 0x25d20, 0x27058, 0x26e80
.long 0x5640, 0x25820, 0x27060, 0x26e80, 0x56c0, 0x25d20, 0x27068, 0x26e80
.long 0x5750, 0x25820, 0x27070, 0x26e80, 0x57d0, 0x25d20, 0x27078, 0x26e80
.long 0x5030, 0x25830, 0x27000, 0x26e80, 0x50b0, 0x25d30, 0x27008, 0x26e80
.long 0x5120, 0x25830, 0x27010, 0x26e80, 0x51a0, 0x25d30, 0x27018, 0x26e80
.long 0x5210, 0x25830, 0x27020, 0x26e80, 0x5290, 0x25d30, 0x27028, 0x26e80
.long 0x5300, 0x25830, 0x27030, 0x26e80, 0x5380, 0x25d30, 0x27038, 0x26e80
.long 0x5470, 0x25830, 0x27040, 0x26e80, 0x54f0, 0x25d30, 0x27048, 0x26e80
.long 0x5560, 0x25830, 0x27050, 0x26e80, 0x55e0, 0x25d30, 0x27058, 0x26e80
.long 0x5650, 0x25830, 0x27060, 0x26e80, 0x56d0, 0x25d30, 0x27068, 0x26e80
.long 0x5740, 0x25830, 0x27070, 0x26e80, 0x57c0, 0x25d30, 0x27078, 0x26e80
.long 0x0, 0x10, 0x20, 0x30, 0x40, 0x3c00, 0x3c10, 0x3c20
.long 0x3c30, 0x3c40, 0xf00, 0xf10, 0xf20, 0xf30, 0xf40, 0x4b00
.long 0x4b10, 0x4b20, 0x4b30, 0x4b40, 0x1e00, 0x1e10, 0x1e20, 0x1e30
.long 0x1e40, 0x5a00, 0x5a10, 0x5a20, 0x5a30, 0x5a40, 0x2d00, 0x2d10
.long 0x2d20, 0x2d30, 0x2d40, 0x6900, 0x6910, 0x6920, 0x6930, 0x6940
.long 0x7800, 0x7810, 0x7820, 0x7830, 0x7840, 0xb400, 0xb410, 0xb420
.long 0xb430, 0xb440, 0x8700, 0x8710, 0x8720, 0x8730, 0x8740, 0xc300
.long 0xc310, 0xc320, 0xc330, 0xc340, 0x9600, 0x9610, 0x9620, 0x9630
.long 0x9640, 0xd200, 0xd210, 0xd220, 0xd230, 0xd240, 0xa500, 0xa510
.long 0xa520, 0xa530, 0xa540, 0xe100, 0xe110, 0xe120, 0xe130, 0xe140
.long 0xf000, 0xf010, 0xf020, 0xf030, 0xf040, 0x12c00, 0x12c10, 0x12c20
.long 0x12c30, 0x12c40, 0xff00, 0xff10, 0xff20, 0xff30, 0xff40, 0x13b00
.long 0x13b10, 0x13b20, 0x13b30, 0x13b40, 0x10e00, 0x10e10, 0x10e20, 0x10e30
.long 0x10e40, 0x14a00, 0x14a10, 0x14a20, 0x14a30, 0x14a40, 0x11d00, 0x11d10
.long 0x11d20, 0x11d30, 0x11d40, 0x15900, 0x15910, 0x15920, 0x15930, 0x15940
.long 0x16800, 0x16810, 0x16820, 0x16830, 0x16840, 0x1a400, 0x1a410, 0x1a420
.long 0x1a430, 0x1a440, 0x17700, 0x17710, 0x17720, 0x17730, 0x17740, 0x1b300
.long 0x1b310, 0x1b320, 0x1b330, 0x1b340, 0x18600, 0x18610, 0x18620, 0x18630
.long 0x18640, 0x1c200, 0x1c210, 0x1c220, 0x1c230, 0x1c240, 0x19500, 0x19510
.long 0x19520, 0x19530, 0x19540, 0x1d100, 0x1d110, 0x1d120, 0x1d130, 0x1d140
.long 0x1e000, 0x1e010, 0x1e020, 0x1e030, 0x1e040, 0x21c00, 0x21c10, 0x21c20
.long 0x21c30, 0x21c40, 0x1ef00, 0x1ef10, 0x1ef20, 0x1ef30, 0x1ef40, 0x22b00
.long 0x22b10, 0x22b20, 0x22b30, 0x22b40, 0x1fe00, 0x1fe10, 0x1fe20, 0x1fe30
.long 0x1fe40, 0x23a00, 0x23a10, 0x23a20, 0x23a30, 0x23a40, 0x20d00, 0x20d10
.long 0x20d20, 0x20d30, 0x20d40, 0x24900, 0x24910, 0x24920, 0x24930, 0x24940
.long 0x7ff00000, 0x7ff00000, 0x7ff00000, 0x7ff00000, 0x7ff00000, 0x7ff00000, 0x7ff00000, 0x7ff00000
.long 0x7ff00000, 0x7ff00000, 0x7ff00000, 0x7ff00000, 0x7ff00000, 0x7ff00000, 0x7ff00000, 0x7ff00000
.long 0x7ff00000, 0x7ff00000, 0x7ff00000, 0x7ff00000, 0x7ff00000, 0x7ff00000, 0x7ff00000, 0x7ff00000
.long 0x7ff00000, 0x7ff00000, 0x7ff00000, 0x7ff00000, 0x7ff00000, 0x7ff00000, 0x7ff00000, 0x7ff00000
.long 0x7ff00000, 0x7ff00000, 0x7ff00000, 0x7ff00000, 0x7ff00000, 0x7ff00000, 0x7ff00000, 0x7ff00000
.long 0x7ff00000, 0x7ff00000, 0x7ff00000, 0x7ff00000, 0x7ff00000, 0x7ff00000, 0x7ff00000, 0x7ff00000
.long 0x7ff00000, 0x7ff00000, 0x7ff00000, 0x7ff00000, 0x7ff00000, 0x7ff00000, 0x7ff00000, 0x7ff00000
.long 0xb850, 0x6400, 0xb810, 0xb828, 0xb858, 0x6408, 0xb818, 0xb830
.long 0xb800, 0x6410, 0xb820, 0xb800, 0xb800, 0x6418, 0xb828, 0xb800
.long 0xb8b8, 0x64a8, 0xb878, 0xb890, 0xb8c0, 0x64b0, 0xb880, 0xb898
.long 0xb868, 0x64b8, 0xb888, 0xb868, 0xb868, 0x64c0, 0xb890, 0xb868
.long 0xb920, 0x6550, 0xb8e0, 0xb8f8, 0xb928, 0x6558, 0xb8e8, 0xb900
.long 0xb8d0, 0x6560, 0xb8f0, 0xb8d0, 0xb8d0, 0x6568, 0xb8f8, 0xb8d0
.long 0xb988, 0x65f8, 0xb948, 0xb960, 0xb990, 0x6600, 0xb950, 0xb968
.long 0xb938, 0x6608, 0xb958, 0xb938, 0xb938, 0x6610, 0xb960, 0xb938
.long 0xb9f0, 0x66a0, 0xb9b0, 0xb9c8, 0xb9f8, 0x66a8, 0xb9b8, 0xb9d0
.long 0xb9a0, 0x66b0, 0xb9c0, 0xb9a0, 0xb9a0, 0x66b8, 0xb9c8, 0xb9a0
.long 0xba58, 0x6748, 0xba18, 0xba30, 0xba60, 0x6750, 0xba20, 0xba38
.long 0xba08, 0x6758, 0xba28, 0xba08, 0xba08, 0x6760, 0xba30, 0xba08
.long 0xbac0, 0x67f0, 0xba80, 0xba98, 0xbac8, 0x67f8, 0xba88, 0xbaa0
.long 0xba70, 0x6800, 0xba90, 0xba70, 0xba70, 0x6808, 0xba98, 0xba70
.long 0xbb28, 0x6898, 0xbae8, 0xbb00, 0xbb30, 0x68a0, 0xbaf0, 0xbb08
.long 0xbad8, 0x68a8, 0xbaf8, 0xbad8, 0xbad8, 0x68b0, 0xbb00, 0xbad8
.long 0xbb90, 0x6940, 0xbb50, 0xbb68, 0xbb98, 0x6948, 0xbb58, 0xbb70
.long 0xbb40, 0x6950, 0xbb60, 0xbb40, 0xbb40, 0x6958, 0xbb68, 0xbb40
.long 0xbbf8, 0x69e8, 0xbbb8, 0xbbd0, 0xbc00, 0x69f0, 0xbbc0, 0xbbd8
.long 0xbba8, 0x69f8, 0xbbc8, 0xbba8, 0xbba8, 0x6a00, 0xbbd0, 0xbba8
.long 0xbc60, 0x6a90, 0xbc20, 0xbc38, 0xbc68, 0x6a98, 0xbc28, 0xbc40
.long 0xbc10, 0x6aa0, 0xbc30, 0xbc10, 0xbc10, 0x6aa8, 0xbc38, 0xbc10
.long 0xbcc8, 0x6b38, 0xbc88, 0xbca0, 0xbcd0, 0x6b40, 0xbc90, 0xbca8
.long 0xbc78, 0x6b48, 0xbc98, 0xbc78, 0xbc78, 0x6b50, 0xbca0, 0xbc78
.long 0xbd30, 0x6be0, 0xbcf0, 0xbd08, 0xbd38, 0x6be8, 0xbcf8, 0xbd10
.long 0xbce0, 0x6bf0, 0xbd00, 0xbce0, 0xbce0, 0x6bf8, 0xbd08, 0xbce0
.long 0xbd98, 0x6c88, 0xbd58, 0xbd70, 0xbda0, 0x6c90, 0xbd60, 0xbd78
.long 0xbd48, 0x6c98, 0xbd68, 0xbd48, 0xbd48, 0x6ca0, 0xbd70, 0xbd48
.long 0xbe00, 0x6d30, 0xbdc0, 0xbdd8, 0xbe08, 0x6d38, 0xbdc8, 0xbde0
.long 0xbdb0, 0x6d40, 0xbdd0, 0xbdb0, 0xbdb0, 0x6d48, 0xbdd8, 0xbdb0
.long 0xbe68, 0x6dd8, 0xbe28, 0xbe40, 0xbe70, 0x6de0, 0xbe30, 0xbe48
.long 0xbe18, 0x6de8, 0xbe38, 0xbe18, 0xbe18, 0x6df0, 0xbe40, 0xbe18
.long 0xb878, 0x6450, 0xb838, 0xb850, 0xb880, 0x6458, 0xb840, 0xb858
.long 0xb800, 0x6460, 0xb848, 0xb800, 0xb800, 0x6468, 0xb850, 0xb800
.long 0xb8e0, 0x64f8, 0xb8a0, 0xb8b8, 0xb8e8, 0x6500, 0xb8a8, 0xb8c0
.long 0xb868, 0x6508, 0xb8b0, 0xb868, 0xb868, 0x6510, 0xb8b8, 0xb868
.long 0xb948, 0x65a0, 0xb908, 0xb920, 0xb950, 0x65a8, 0xb910, 0xb928
.long 0xb8d0, 0x65b0, 0xb918, 0xb8d0, 0xb8d0, 0x65b8, 0xb920, 0xb8d0
.long 0xb9b0, 0x6648, 0xb970, 0xb988, 0xb9b8, 0x6650, 0xb978, 0xb990
.long 0xb938, 0x6658, 0xb980, 0xb938, 0xb938, 0x6660, 0xb988, 0xb938
.long 0xba18, 0x66f0, 0xb9d8, 0xb9f0, 0xba20, 0x66f8, 0xb9e0, 0xb9f8
.long 0xb9a0, 0x6700, 0xb9e8, 0xb9a0, 0xb9a0, 0x6708, 0xb9f0, 0xb9a0
.long 0xba80, 0x6798, 0xba40, 0xba58, 0xba88, 0x67a0, 0xba48, 0xba60
.long 0xba08, 0x67a8, 0xba50, 0xba08, 0xba08, 0x67b0, 0xba58, 0xba08
.long 0xbae8, 0x6840, 0xbaa8, 0xbac0, 0xbaf0, 0x6848, 0xbab0, 0xbac8
.long 0xba70, 0x6850, 0xbab8, 0xba70, 0xba70, 0x6858, 0xbac0, 0xba70
.long 0xbb50, 0x68e8, 0xbb10, 0xbb28, 0xbb58, 0x68f0, 0xbb18, 0xbb30
.long 0xbad8, 0x68f8, 0xbb20, 0xbad8, 0xbad8, 0x6900, 0xbb28, 0xbad8
.long 0xbbb8, 0x6990, 0xbb78, 0xbb90, 0xbbc0, 0x6998, 0xbb80, 0xbb98
.long 0xbb40, 0x69a0, 0xbb88, 0xbb40, 0xbb40, 0x69a8, 0xbb90, 0xbb40
.long 0xbc20, 0x6a38, 0xbbe0, 0xbbf8, 0xbc28, 0x6a40, 0xbbe8, 0xbc00
.long 0xbba8, 0x6a48, 0xbbf0, 0xbba8, 0xbba8, 0x6a50, 0xbbf8, 0xbba8
.long 0xbc88, 0x6ae0, 0xbc48, 0xbc60, 0xbc90, 0x6ae8, 0xbc50, 0xbc68
.long 0xbc10, 0x6af0, 0xbc58, 0xbc10, 0xbc10, 0x6af8, 0xbc60, 0xbc10
.long 0xbcf0, 0x6b88, 0xbcb0, 0xbcc8, 0xbcf8, 0x6b90, 0xbcb8, 0xbcd0
.long 0xbc78, 0x6b98, 0xbcc0, 0xbc78, 0xbc78, 0x6ba0, 0xbcc8, 0xbc78
.long 0xbd58, 0x6c30, 0xbd18, 0xbd30, 0xbd60, 0x6c38, 0xbd20, 0xbd38
.long 0xbce0, 0x6c40, 0xbd28, 0xbce0, 0xbce0, 0x6c48, 0xbd30, 0xbce0
.long 0xbdc0, 0x6cd8, 0xbd80, 0xbd98, 0xbdc8, 0x6ce0, 0xbd88, 0xbda0
.long 0xbd48, 0x6ce8, 0xbd90, 0xbd48, 0xbd48, 0x6cf0, 0xbd98, 0xbd48
.long 0xbe28, 0x6d80, 0xbde8, 0xbe00, 0xbe30, 0x6d88, 0xbdf0, 0xbe08
.long 0xbdb0, 0x6d90, 0xbdf8, 0xbdb0, 0xbdb0, 0x6d98, 0xbe00, 0xbdb0
.long 0xbe90, 0x6e28, 0xbe50, 0xbe68, 0xbe98, 0x6e30, 0xbe58, 0xbe70
.long 0xbe18, 0x6e38, 0xbe60, 0xbe18, 0xbe18, 0x6e40, 0xbe68, 0xbe18
.long 0xb850, 0x6420, 0xb810, 0xb828, 0xb858, 0x6428, 0xb818, 0xb830
.long 0xb800, 0x6430, 0xb820, 0xb800, 0xb800, 0x6438, 0xb828, 0xb800
.long 0xb8b8, 0x64c8, 0xb878, 0xb890, 0xb8c0, 0x64d0, 0xb880, 0xb898
.long 0xb868, 0x64d8, 0xb888, 0xb868, 0xb868, 0x64e0, 0xb890, 0xb868
.long 0xb920, 0x6570, 0xb8e0, 0xb8f8, 0xb928, 0x6578, 0xb8e8, 0xb900
.long 0xb8d0, 0x6580, 0xb8f0, 0xb8d0, 0xb8d0, 0x6588, 0xb8f8, 0xb8d0
.long 0xb988, 0x6618, 0xb948, 0xb960, 0xb990, 0x6620, 0xb950, 0xb968
.long 0xb938, 0x6628, 0xb958, 0xb938, 0xb938, 0x6630, 0xb960, 0xb938
.long 0xb9f0, 0x66c0, 0xb9b0, 0xb9c8, 0xb9f8, 0x66c8, 0xb9b8, 0xb9d0
.long 0xb9a0, 0x66d0, 0xb9c0, 0xb9a0, 0xb9a0, 0x66d8, 0xb9c8, 0xb9a0
.long 0xba58, 0x6768, 0xba18, 0xba30, 0xba60, 0x6770, 0xba20, 0xba38
.long 0xba08, 0x6778, 0xba28, 0xba08, 0xba08, 0x6780, 0xba30, 0xba08
.long 0xbac0, 0x6810, 0xba80, 0xba98, 0xbac8, 0x6818, 0xba88, 0xbaa0
.long 0xba70, 0x6820, 0xba90, 0xba70, 0xba70, 0x6828, 0xba98, 0xba70
.long 0xbb28, 0x68b8, 0xbae8, 0xbb00, 0xbb30, 0x68c0, 0xbaf0, 0xbb08
.long 0xbad8, 0x68c8, 0xbaf8, 0xbad8, 0xbad8, 0x68d0, 0xbb00, 0xbad8
.long 0xbb90, 0x6960, 0xbb50, 0xbb68, 0xbb98, 0x6968, 0xbb58, 0xbb70
.long 0xbb40, 0x6970, 0xbb60, 0xbb40, 0xbb40, 0x6978, 0xbb68, 0xbb40
.long 0xbbf8, 0x6a08, 0xbbb8, 0xbbd0, 0xbc00, 0x6a10, 0xbbc0, 0xbbd8
.long 0xbba8, 0x6a18, 0xbbc8, 0xbba8, 0xbba8, 0x6a20, 0xbbd0, 0xbba8
.long 0xbc60, 0x6ab0, 0xbc20, 0xbc38, 0xbc68, 0x6ab8, 0xbc28, 0xbc40
.long 0xbc10, 0x6ac0, 0xbc30, 0xbc10, 0xbc10, 0x6ac8, 0xbc38, 0xbc10
.long 0xbcc8, 0x6b58, 0xbc88, 0xbca0, 0xbcd0, 0x6b60, 0xbc90, 0xbca8
.long 0xbc78, 0x6b68, 0xbc98, 0xbc78, 0xbc78, 0x6b70, 0xbca0, 0xbc78
.long 0xbd30, 0x6c00, 0xbcf0, 0xbd08, 0xbd38, 0x6c08, 0xbcf8, 0xbd10
.long 0xbce0, 0x6c10, 0xbd00, 0xbce0, 0xbce0, 0x6c18, 0xbd08, 0xbce0
.long 0xbd98, 0x6ca8, 0xbd58, 0xbd70, 0xbda0, 0x6cb0, 0xbd60, 0xbd78
.long 0xbd48, 0x6cb8, 0xbd68, 0xbd48, 0xbd48, 0x6cc0, 0xbd70, 0xbd48
.long 0xbe00, 0x6d50, 0xbdc0, 0xbdd8, 0xbe08, 0x6d58, 0xbdc8, 0xbde0
.long 0xbdb0, 0x6d60, 0xbdd0, 0xbdb0, 0xbdb0, 0x6d68, 0xbdd8, 0xbdb0
.long 0xbe68, 0x6df8, 0xbe28, 0xbe40, 0xbe70, 0x6e00, 0xbe30, 0xbe48
.long 0xbe18, 0x6e08, 0xbe38, 0xbe18, 0xbe18, 0x6e10, 0xbe40, 0xbe18
.long 0xb878, 0x6470, 0xb838, 0xb850, 0xb880, 0x6478, 0xb840, 0xb858
.long 0xb800, 0x6480, 0xb848, 0xb800, 0xb800, 0x6488, 0xb850, 0xb800
.long 0xb8e0, 0x6518, 0xb8a0, 0xb8b8, 0xb8e8, 0x6520, 0xb8a8, 0xb8c0
.long 0xb868, 0x6528, 0xb8b0, 0xb868, 0xb868, 0x6530, 0xb8b8, 0xb868
.long 0xb948, 0x65c0, 0xb908, 0xb920, 0xb950, 0x65c8, 0xb910, 0xb928
.long 0xb8d0, 0x65d0, 0xb918, 0xb8d0, 0xb8d0, 0x65d8, 0xb920, 0xb8d0
.long 0xb9b0, 0x6668, 0xb970, 0xb988, 0xb9b8, 0x6670, 0xb978, 0xb990
.long 0xb938, 0x6678, 0xb980, 0xb938, 0xb938, 0x6680, 0xb988, 0xb938
.long 0xba18, 0x6710, 0xb9d8, 0xb9f0, 0xba20, 0x6718, 0xb9e0, 0xb9f8
.long 0xb9a0, 0x6720, 0xb9e8, 0xb9a0, 0xb9a0, 0x6728, 0xb9f0, 0xb9a0
.long 0xba80, 0x67b8, 0xba40, 0xba58, 0xba88, 0x67c0, 0xba48, 0xba60
.long 0xba08, 0x67c8, 0xba50, 0xba08, 0xba08, 0x67d0, 0xba58, 0xba08
.long 0xbae8, 0x6860, 0xbaa8, 0xbac0, 0xbaf0, 0x6868, 0xbab0, 0xbac8
.long 0xba70, 0x6870, 0xbab8, 0xba70, 0xba70, 0x6878, 0xbac0, 0xba70
.long 0xbb50, 0x6908, 0xbb10, 0xbb28, 0xbb58, 0x6910, 0xbb18, 0xbb30
.long 0xbad8, 0x6918, 0xbb20, 0xbad8, 0xbad8, 0x6920, 0xbb28, 0xbad8
.long 0xbbb8, 0x69b0, 0xbb78, 0xbb90, 0xbbc0, 0x69b8, 0xbb80, 0xbb98
.long 0xbb40, 0x69c0, 0xbb88, 0xbb40, 0xbb40, 0x69c8, 0xbb90, 0xbb40
.long 0xbc20, 0x6a58, 0xbbe0, 0xbbf8, 0xbc28, 0x6a60, 0xbbe8, 0xbc00
.long 0xbba8, 0x6a68, 0xbbf0, 0xbba8, 0xbba8, 0x6a70, 0xbbf8, 0xbba8
.long 0xbc88, 0x6b00, 0xbc48, 0xbc60, 0xbc90, 0x6b08, 0xbc50, 0xbc68
.long 0xbc10, 0x6b10, 0xbc58, 0xbc10, 0xbc10, 0x6b18, 0xbc60, 0xbc10
.long 0xbcf0, 0x6ba8, 0xbcb0, 0xbcc8, 0xbcf8, 0x6bb0, 0xbcb8, 0xbcd0
.long 0xbc78, 0x6bb8, 0xbcc0, 0xbc78, 0xbc78, 0x6bc0, 0xbcc8, 0xbc78
.long 0xbd58, 0x6c50, 0xbd18, 0xbd30, 0xbd60, 0x6c58, 0xbd20, 0xbd38
.long 0xbce0, 0x6c60, 0xbd28, 0xbce0, 0xbce0, 0x6c68, 0xbd30, 0xbce0
.long 0xbdc0, 0x6cf8, 0xbd80, 0xbd98, 0xbdc8, 0x6d00, 0xbd88, 0xbda0
.long 0xbd48, 0x6d08, 0xbd90, 0xbd48, 0xbd48, 0x6d10, 0xbd98, 0xbd48
.long 0xbe28, 0x6da0, 0xbde8, 0xbe00, 0xbe30, 0x6da8, 0xbdf0, 0xbe08
.long 0xbdb0, 0x6db0, 0xbdf8, 0xbdb0, 0xbdb0, 0x6db8, 0xbe00, 0xbdb0
.long 0xbe90, 0x6e48, 0xbe50, 0xbe68, 0xbe98, 0x6e50, 0xbe58, 0xbe70
.long 0xbe18, 0x6e58, 0xbe60, 0xbe18, 0xbe18, 0x6e60, 0xbe68, 0xbe18
.long 0x2800, 0x2800, 0x6400, 0x2800, 0x2810, 0x2810, 0x6460, 0x2810
.long 0x2820, 0x2820, 0x64c0, 0x2820, 0x2830, 0x2830, 0x6520, 0x2830
.long 0x2840, 0x2840, 0x6580, 0x2840, 0x2850, 0x2850, 0x65e0, 0x2850
.long 0x2860, 0x2860, 0x6640, 0x2860, 0x2870, 0x2870, 0x66a0, 0x2870
.long 0x2880, 0x2880, 0x6700, 0x2880, 0x2890, 0x2890, 0x6760, 0x2890
.long 0x28a0, 0x28a0, 0x67c0, 0x28a0, 0x28b0, 0x28b0, 0x6820, 0x28b0
.long 0x7ff00000, 0x7ff00000, 0x6408, 0x28c0, 0x7ff00000, 0x7ff00000, 0x6468, 0x28d0
.long 0x7ff00000, 0x7ff00000, 0x64c8, 0x28e0, 0x7ff00000, 0x7ff00000, 0x6528, 0x28f0
.long 0x28c0, 0x28c0, 0x6588, 0x2900, 0x28d0, 0x28d0, 0x65e8, 0x2910
.long 0x28e0, 0x28e0, 0x6648, 0x2920, 0x28f0, 0x28f0, 0x66a8, 0x2930
.long 0x2900, 0x2900, 0x6708, 0x2940, 0x2910, 0x2910, 0x6768, 0x2950
.long 0x2920, 0x2920, 0x67c8, 0x2960, 0x2930, 0x2930, 0x6828, 0x2970
.long 0x2940, 0x2940, 0x6410, 0x2980, 0x2950, 0x2950, 0x6470, 0x2990
.long 0x2960, 0x2960, 0x64d0, 0x29a0, 0x2970, 0x2970, 0x6530, 0x29b0
.long 0x7ff00000, 0x7ff00000, 0x6590, 0x29c0, 0x7ff00000, 0x7ff00000, 0x65f0, 0x29d0
.long 0x7ff00000, 0x7ff00000, 0x6650, 0x29e0, 0x7ff00000, 0x7ff00000, 0x66b0, 0x29f0
.long 0x2980, 0x7ff00000, 0x6710, 0x2a00, 0x2990, 0x7ff00000, 0x6770, 0x2a10
.long 0x29a0, 0x7ff00000, 0x67d0, 0x2a20, 0x29b0, 0x7ff00000, 0x6830, 0x2a30
.long 0x29c0, 0x7ff00000, 0x6418, 0x2a40, 0x29d0, 0x7ff00000, 0x6478, 0x2a50
.long 0x29e0, 0x7ff00000, 0x64d8, 0x2a60, 0x29f0, 0x7ff00000, 0x6538, 0x2a70
.long 0x2a00, 0x7ff00000, 0x6598, 0x2a80, 0x2a10, 0x7ff00000, 0x65f8, 0x2a90
.long 0x2a20, 0x7ff00000, 0x6658, 0x2aa0, 0x2a30, 0x7ff00000, 0x66b8, 0x2ab0
.long 0x7ff00000, 0x7ff00000, 0x6718, 0x2ac0, 0x7ff00000, 0x7ff00000, 0x6778, 0x2ad0
.long 0x7ff00000, 0x7ff00000, 0x67d8, 0x2ae0, 0x7ff00000, 0x7ff00000, 0x6838, 0x2af0
.long 0x2a40, 0x7ff00000, 0x6420, 0x2b00, 0x2a50, 0x7ff00000, 0x6480, 0x2b10
.long 0x2a60, 0x7ff00000, 0x64e0, 0x2b20, 0x2a70, 0x7ff00000, 0x6540, 0x2b30
.long 0x2a80, 0x7ff00000, 0x65a0, 0x2b40, 0x2a90, 0x7ff00000, 0x6600, 0x2b50
.long 0x2aa0, 0x7ff00000, 0x6660, 0x2b60, 0x2ab0, 0x7ff00000, 0x66c0, 0x2b70
.long 0x2ac0, 0x7ff00000, 0x6720, 0x2b80, 0x2ad0, 0x7ff00000, 0x6780, 0x2b90
.long 0x2ae0, 0x7ff00000, 0x67e0, 0x2ba0, 0x2af0, 0x7ff00000, 0x6840, 0x2bb0
.long 0x7ff00000, 0x7ff00000, 0x6430, 0x2bc0, 0x7ff00000, 0x7ff00000, 0x6490, 0x2bd0
.long 0x7ff00000, 0x7ff00000, 0x64f0, 0x2be0, 0x7ff00000, 0x7ff00000, 0x6550, 0x2bf0
.long 0x2f80, 0x2f80, 0x65b0, 0x2c00, 0x2f90, 0x2f90, 0x6610, 0x2c10
.long 0x2fa0, 0x2fa0, 0x6670, 0x2c20, 0x2fb0, 0x2fb0, 0x66d0, 0x2c30
.long 0x2fc0, 0x2fc0, 0x6730, 0x2c40, 0x2fd0, 0x2fd0, 0x6790, 0x2c50
.long 0x2fe0, 0x2fe0, 0x67f0, 0x2c60, 0x2ff0, 0x2ff0, 0x6850, 0x2c70
.long 0x3000, 0x3000, 0x6438, 0x2c80, 0x3010, 0x3010, 0x6498, 0x2c90
.long 0x3020, 0x3020, 0x64f8, 0x2ca0, 0x3030, 0x3030, 0x6558, 0x2cb0
.long 0x7ff00000, 0x7ff00000, 0x65b8, 0x2cc0, 0x7ff00000, 0x7ff00000, 0x6618, 0x2cd0
.long 0x7ff00000, 0x7ff00000, 0x6678, 0x2ce0, 0x7ff00000, 0x7ff00000, 0x66d8, 0x2cf0
.long 0x3040, 0x3040, 0x6738, 0x2d00, 0x3050, 0x3050, 0x6798, 0x2d10
.long 0x3060, 0x3060, 0x67f8, 0x2d20, 0x3070, 0x3070, 0x6858, 0x2d30
.long 0x3080, 0x3080, 0x6440, 0x2d40, 0x3090, 0x3090, 0x64a0, 0x2d50
.long 0x30a0, 0x30a0, 0x6500, 0x2d60, 0x30b0, 0x30b0, 0x6560, 0x2d70
.long 0x30c0, 0x30c0, 0x65c0, 0x2d80, 0x30d0, 0x30d0, 0x6620, 0x2d90
.long 0x30e0, 0x30e0, 0x6680, 0x2da0, 0x30f0, 0x30f0, 0x66e0, 0x2db0
.long 0x7ff00000, 0x7ff00000, 0x6740, 0x2dc0, 0x7ff00000, 0x7ff00000, 0x67a0, 0x2dd0
.long 0x7ff00000, 0x7ff00000, 0x6800, 0x2de0, 0x7ff00000, 0x7ff00000, 0x6860, 0x2df0
.long 0x3100, 0x7ff00000, 0x6448, 0x2e00, 0x3110, 0x7ff00000, 0x64a8, 0x2e10
.long 0x3120, 0x7ff00000, 0x6508, 0x2e20, 0x3130, 0x7ff00000, 0x6568, 0x2e30
.long 0x3140, 0x7ff00000, 0x65c8, 0x2e40, 0x3150, 0x7ff00000, 0x6628, 0x2e50
.long 0x3160, 0x7ff00000, 0x6688, 0x2e60, 0x3170, 0x7ff00000, 0x66e8, 0x2e70
.long 0x3180, 0x7ff00000, 0x6748, 0x2e80, 0x3190, 0x7ff00000, 0x67a8, 0x2e90
.long 0x31a0, 0x7ff00000, 0x6808, 0x2ea0, 0x31b0, 0x7ff00000, 0x6868, 0x2eb0
.long 0x7ff00000, 0x7ff00000, 0x6450, 0x2ec0, 0x7ff00000, 0x7ff00000, 0x64b0, 0x2ed0
.long 0x7ff00000, 0x7ff00000, 0x6510, 0x2ee0, 0x7ff00000, 0x7ff00000, 0x6570, 0x2ef0
.long 0x31c0, 0x7ff00000, 0x65d0, 0x2f00, 0x31d0, 0x7ff00000, 0x6630, 0x2f10
.long 0x31e0, 0x7ff00000, 0x6690, 0x2f20, 0x31f0, 0x7ff00000, 0x66f0, 0x2f30
.long 0x3200, 0x7ff00000, 0x6750, 0x2f40, 0x3210, 0x7ff00000, 0x67b0, 0x2f50
.long 0x3220, 0x7ff00000, 0x6810, 0x2f60, 0x3230, 0x7ff00000, 0x6870, 0x2f70
.long 0x3240, 0x7ff00000, 0x6d00, 0x2f80, 0x3250, 0x7ff00000, 0x6d60, 0x2f90
.long 0x3260, 0x7ff00000, 0x6dc0, 0x2fa0, 0x3270, 0x7ff00000, 0x6e20, 0x2fb0
.long 0x7ff00000, 0x7ff00000, 0x6e80, 0x2fc0, 0x7ff00000, 0x7ff00000, 0x6ee0, 0x2fd0
.long 0x7ff00000, 0x7ff00000, 0x6f40, 0x2fe0, 0x7ff00000, 0x7ff00000, 0x6fa0, 0x2ff0
.long 0x2b00, 0x2b00, 0x7000, 0x3000, 0x2b10, 0x2b10, 0x7060, 0x3010
.long 0x2b20, 0x2b20, 0x70c0, 0x3020, 0x2b30, 0x2b30, 0x7120, 0x3030
.long 0x2b40, 0x2b40, 0x6d08, 0x3040, 0x2b50, 0x2b50, 0x6d68, 0x3050
.long 0x2b60, 0x2b60, 0x6dc8, 0x3060, 0x2b70, 0x2b70, 0x6e28, 0x3070
.long 0x2b80, 0x2b80, 0x6e88, 0x3080, 0x2b90, 0x2b90, 0x6ee8, 0x3090
.long 0x2ba0, 0x2ba0, 0x6f48, 0x30a0, 0x2bb0, 0x2bb0, 0x6fa8, 0x30b0
.long 0x7ff00000, 0x7ff00000, 0x7008, 0x30c0, 0x7ff00000, 0x7ff00000, 0x7068, 0x30d0
.long 0x7ff00000, 0x7ff00000, 0x70c8, 0x30e0, 0x7ff00000, 0x7ff00000, 0x7128, 0x30f0
.long 0x2bc0, 0x2bc0, 0x6d10, 0x3100, 0x2bd0, 0x2bd0, 0x6d70, 0x3110
.long 0x2be0, 0x2be0, 0x6dd0, 0x3120, 0x2bf0, 0x2bf0, 0x6e30, 0x3130
.long 0x2c00, 0x2c00, 0x6e90, 0x3140, 0x2c10, 0x2c10, 0x6ef0, 0x3150
.long 0x2c20, 0x2c20, 0x6f50, 0x3160, 0x2c30, 0x2c30, 0x6fb0, 0x3170
.long 0x2c40, 0x2c40, 0x7010, 0x3180, 0x2c50, 0x2c50, 0x7070, 0x3190
.long 0x2c60, 0x2c60, 0x70d0, 0x31a0, 0x2c70, 0x2c70, 0x7130, 0x31b0
.long 0x7ff00000, 0x7ff00000, 0x6d18, 0x31c0, 0x7ff00000, 0x7ff00000, 0x6d78, 0x31d0
.long 0x7ff00000, 0x7ff00000, 0x6dd8, 0x31e0, 0x7ff00000, 0x7ff00000, 0x6e38, 0x31f0
.long 0x2c80, 0x7ff00000, 0x6e98, 0x3200, 0x2c90, 0x7ff00000, 0x6ef8, 0x3210
.long 0x2ca0, 0x7ff00000, 0x6f58, 0x3220, 0x2cb0, 0x7ff00000, 0x6fb8, 0x3230
.long 0x2cc0, 0x7ff00000, 0x7018, 0x3240, 0x2cd0, 0x7ff00000, 0x7078, 0x3250
.long 0x2ce0, 0x7ff00000, 0x70d8, 0x3260, 0x2cf0, 0x7ff00000, 0x7138, 0x3270
.long 0x2d00, 0x7ff00000, 0x6d20, 0x3280, 0x2d10, 0x7ff00000, 0x6d80, 0x3290
.long 0x2d20, 0x7ff00000, 0x6de0, 0x32a0, 0x2d30, 0x7ff00000, 0x6e40, 0x32b0
.long 0x7ff00000, 0x7ff00000, 0x6ea0, 0x32c0, 0x7ff00000, 0x7ff00000, 0x6f00, 0x32d0
.long 0x7ff00000, 0x7ff00000, 0x6f60, 0x32e0, 0x7ff00000, 0x7ff00000, 0x6fc0, 0x32f0
.long 0x2d40, 0x7ff00000, 0x7020, 0x3300, 0x2d50, 0x7ff00000, 0x7080, 0x3310
.long 0x2d60, 0x7ff00000, 0x70e0, 0x3320, 0x2d70, 0x7ff00000, 0x7140, 0x3330
.long 0x2d80, 0x7ff00000, 0x6d30, 0x3340, 0x2d90, 0x7ff00000, 0x6d90, 0x3350
.long 0x2da0, 0x7ff00000, 0x6df0, 0x3360, 0x2db0, 0x7ff00000, 0x6e50, 0x3370
.long 0x2dc0, 0x7ff00000, 0x6eb0, 0x3380, 0x2dd0, 0x7ff00000, 0x6f10, 0x3390
.long 0x2de0, 0x7ff00000, 0x6f70, 0x33a0, 0x2df0, 0x7ff00000, 0x6fd0, 0x33b0
.long 0x7ff00000, 0x7ff00000, 0x7030, 0x33c0, 0x7ff00000, 0x7ff00000, 0x7090, 0x33d0
.long 0x7ff00000, 0x7ff00000, 0x70f0, 0x33e0, 0x7ff00000, 0x7ff00000, 0x7150, 0x33f0
.long 0x3280, 0x3280, 0x6d38, 0x3400, 0x3290, 0x3290, 0x6d98, 0x3410
.long 0x32a0, 0x32a0, 0x6df8, 0x3420, 0x32b0, 0x32b0, 0x6e58, 0x3430
.long 0x32c0, 0x32c0, 0x6eb8, 0x3440, 0x32d0, 0x32d0, 0x6f18, 0x3450
.long 0x32e0, 0x32e0, 0x6f78, 0x3460, 0x32f0, 0x32f0, 0x6fd8, 0x3470
.long 0x3300, 0x3300, 0x7038, 0x3480, 0x3310, 0x3310, 0x7098, 0x3490
.long 0x3320, 0x3320, 0x70f8, 0x34a0, 0x3330, 0x3330, 0x7158, 0x34b0
.long 0x7ff00000, 0x7ff00000, 0x6d40, 0x34c0, 0x7ff00000, 0x7ff00000, 0x6da0, 0x34d0
.long 0x7ff00000, 0x7ff00000, 0x6e00, 0x34e0, 0x7ff00000, 0x7ff00000, 0x6e60, 0x34f0
.long 0x3340, 0x3340, 0x6ec0, 0x3500, 0x3350, 0x3350, 0x6f20, 0x3510
.long 0x3360, 0x3360, 0x6f80, 0x3520, 0x3370, 0x3370, 0x6fe0, 0x3530
.long 0x3380, 0x3380, 0x7040, 0x3540, 0x3390, 0x3390, 0x70a0, 0x3550
.long 0x33a0, 0x33a0, 0x7100, 0x3560, 0x33b0, 0x33b0, 0x7160, 0x3570
.long 0x33c0, 0x33c0, 0x6d48, 0x3580, 0x33d0, 0x33d0, 0x6da8, 0x3590
.long 0x33e0, 0x33e0, 0x6e08, 0x35a0, 0x33f0, 0x33f0, 0x6e68, 0x35b0
.long 0x7ff00000, 0x7ff00000, 0x6ec8, 0x35c0, 0x7ff00000, 0x7ff00000, 0x6f28, 0x35d0
.long 0x7ff00000, 0x7ff00000, 0x6f88, 0x35e0, 0x7ff00000, 0x7ff00000, 0x6fe8, 0x35f0
.long 0x3400, 0x7ff00000, 0x7048, 0x3600, 0x3410, 0x7ff00000, 0x70a8, 0x3610
.long 0x3420, 0x7ff00000, 0x7108, 0x3620, 0x3430, 0x7ff00000, 0x7168, 0x3630
.long 0x3440, 0x7ff00000, 0x6d50, 0x3640, 0x3450, 0x7ff00000, 0x6db0, 0x3650
.long 0x3460, 0x7ff00000, 0x6e10, 0x3660, 0x3470, 0x7ff00000, 0x6e70, 0x3670
.long 0x3480, 0x7ff00000, 0x6ed0, 0x3680, 0x3490, 0x7ff00000, 0x6f30, 0x3690
.long 0x34a0, 0x7ff00000, 0x6f90, 0x36a0, 0x34b0, 0x7ff00000, 0x6ff0, 0x36b0
.long 0x7ff00000, 0x7ff00000, 0x7050, 0x36c0, 0x7ff00000, 0x7ff00000, 0x70b0, 0x36d0
.long 0x7ff00000, 0x7ff00000, 0x7110, 0x36e0, 0x7ff00000, 0x7ff00000, 0x7170, 0x36f0
.long 0x34c0, 0x7ff00000, 0x7600, 0x7ff00000, 0x34d0, 0x7ff00000, 0x7660, 0x7ff00000
.long 0x34e0, 0x7ff00000, 0x76c0, 0x7ff00000, 0x34f0, 0x7ff00000, 0x7720, 0x7ff00000
.long 0x3500, 0x7ff00000, 0x7780, 0x7ff00000, 0x3510, 0x7ff00000, 0x77e0, 0x7ff00000
.long 0x3520, 0x7ff00000, 0x7840, 0x7ff00000, 0x3530, 0x7ff00000, 0x78a0, 0x7ff00000
.long 0x3540, 0x7ff00000, 0x7900, 0x7ff00000, 0x3550, 0x7ff00000, 0x7960, 0x7ff00000
.long 0x3560, 0x7ff00000, 0x79c0, 0x7ff00000, 0x3570, 0x7ff00000, 0x7a20, 0x7ff00000
.long 0x7ff00000, 0x7ff00000, 0x7608, 0x7ff00000, 0x7ff00000, 0x7ff00000, 0x7668, 0x7ff00000
.long 0x7ff00000, 0x7ff00000, 0x76c8, 0x7ff00000, 0x7ff00000, 0x7ff00000, 0x7728, 0x7ff00000
.long 0x0, 0x0, 0xfc40, 0xff10, 0x10, 0x10, 0xfc50, 0xff20
.long 0x20, 0x20, 0xfc60, 0xff30, 0x30, 0x30, 0xfc70, 0xff40
.long 0x40, 0x40, 0xfc80, 0x10400, 0x50, 0x500, 0xfc90, 0x10410
.long 0x60, 0x510, 0xfca0, 0x10420, 0x70, 0x520, 0xfcb0, 0x10430
.long 0x80, 0x530, 0x10800, 0x10440, 0x90, 0x540, 0x10810, 0x10900
.long 0xa0, 0xa00, 0x10820, 0x10910, 0xb0, 0xa10, 0x10830, 0x10920
.long 0xc00, 0xa20, 0x10840, 0x10930, 0xc10, 0xa30, 0x10850, 0x10940
.long 0xc20, 0xa40, 0x10860, 0x10e00, 0xc30, 0xf00, 0x10870, 0x10e10
.long 0xc40, 0xf10, 0x10880, 0x10e20, 0xc50, 0xf20, 0x10890, 0x10e30
.long 0xc60, 0xf30, 0x108a0, 0x10e40, 0xc70, 0xf40, 0x108b0, 0x11300
.long 0xc80, 0x1400, 0x11400, 0x11310, 0xc90, 0x1410, 0x11410, 0x11320
.long 0xca0, 0x1420, 0x11420, 0x11330, 0xcb0, 0x1430, 0x11430, 0x11340
.long 0x1800, 0x1440, 0x11440, 0x11800, 0x1810, 0x1900, 0x11450, 0x11810
.long 0x1820, 0x1910, 0x11460, 0x11820, 0x1830, 0x1920, 0x11470, 0x11830
.long 0x1840, 0x1930, 0x11480, 0x11840, 0x1850, 0x1940, 0x11490, 0x11d00
.long 0x1860, 0x1e00, 0x114a0, 0x11d10, 0x1870, 0x1e10, 0x114b0, 0x11d20
.long 0x1880, 0x1e20, 0x12000, 0x11d30, 0x1890, 0x1e30, 0x12010, 0x11d40
.long 0x18a0, 0x1e40, 0x12020, 0x12200, 0x18b0, 0x2300, 0x12030, 0x12210
.long 0x2400, 0x2310, 0x12040, 0x12220, 0x2410, 0x2320, 0x12050, 0x12230
.long 0x2420, 0x2330, 0x12060, 0x12240, 0x2430, 0x2340, 0x12070, 0x12700
.long 0x2440, 0x2800, 0x12080, 0x12710, 0x2450, 0x2810, 0x12090, 0x12720
.long 0x2460, 0x2820, 0x120a0, 0x12730, 0x2470, 0x2830, 0x120b0, 0x12740
.long 0x2480, 0x2840, 0x12c00, 0x12c00, 0x2490, 0x2d00, 0x12c10, 0x12c10
.long 0x24a0, 0x2d10, 0x12c20, 0x12c20, 0x24b0, 0x2d20, 0x12c30, 0x12c30
.long 0x3000, 0x2d30, 0x12c40, 0x12c40, 0x3010, 0x2d40, 0x12c50, 0x13100
.long 0x3020, 0x3200, 0x12c60, 0x13110, 0x3030, 0x3210, 0x12c70, 0x13120
.long 0x3040, 0x3220, 0x12c80, 0x13130, 0x3050, 0x3230, 0x12c90, 0x13140
.long 0x3060, 0x3240, 0x12ca0, 0x13600, 0x3070, 0x3700, 0x12cb0, 0x13610
.long 0x3080, 0x3710, 0x13800, 0x13620, 0x3090, 0x3720, 0x13810, 0x13630
.long 0x30a0, 0x3730, 0x13820, 0x13640, 0x30b0, 0x3740, 0x13830, 0x13b00
.long 0x3c00, 0x3c00, 0x13840, 0x13b10, 0x3c10, 0x3c10, 0x13850, 0x13b20
.long 0x3c20, 0x3c20, 0x13860, 0x13b30, 0x3c30, 0x3c30, 0x13870, 0x13b40
.long 0x3c40, 0x3c40, 0x13880, 0x14000, 0x3c50, 0x4100, 0x13890, 0x14010
.long 0x3c60, 0x4110, 0x138a0, 0x14020, 0x3c70, 0x4120, 0x138b0, 0x14030
.long 0x3c80, 0x4130, 0x14400, 0x14040, 0x3c90, 0x4140, 0x14410, 0x14500
.long 0x3ca0, 0x4600, 0x14420, 0x14510, 0x3cb0, 0x4610, 0x14430, 0x14520
.long 0x4800, 0x4620, 0x14440, 0x14530, 0x4810, 0x4630, 0x14450, 0x14540
.long 0x4820, 0x4640, 0x14460, 0x14a00, 0x4830, 0x4b00, 0x14470, 0x14a10
.long 0x4840, 0x4b10, 0x14480, 0x14a20, 0x4850, 0x4b20, 0x14490, 0x14a30
.long 0x4860, 0x4b30, 0x144a0, 0x14a40, 0x4870, 0x4b40, 0x144b0, 0x14f00
.long 0x4880, 0x5000, 0x15000, 0x14f10, 0x4890, 0x5010, 0x15010, 0x14f20
.long 0x48a0, 0x5020, 0x15020, 0x14f30, 0x48b0, 0x5030, 0x15030, 0x14f40
.long 0x5400, 0x5040, 0x15040, 0x15400, 0x5410, 0x5500, 0x15050, 0x15410
.long 0x5420, 0x5510, 0x15060, 0x15420, 0x5430, 0x5520, 0x15070, 0x15430
.long 0x5440, 0x5530, 0x15080, 0x15440, 0x5450, 0x5540, 0x15090, 0x15900
.long 0x5460, 0x5a00, 0x150a0, 0x15910, 0x5470, 0x5a10, 0x150b0, 0x15920
.long 0x5480, 0x5a20, 0x15c00, 0x15930, 0x5490, 0x5a30, 0x15c10, 0x15940
.long 0x54a0, 0x5a40, 0x15c20, 0x15e00, 0x54b0, 0x5f00, 0x15c30, 0x15e10
.long 0x6000, 0x5f10, 0x15c40, 0x15e20, 0x6010, 0x5f20, 0x15c50, 0x15e30
.long 0x6020, 0x5f30, 0x15c60, 0x15e40, 0x6030, 0x5f40, 0x15c70, 0x16300
.long 0x6040, 0x6400, 0x15c80, 0x16310, 0x6050, 0x6410, 0x15c90, 0x16320
.long 0x6060, 0x6420, 0x15ca0, 0x16330, 0x6070, 0x6430, 0x15cb0, 0x16340
.long 0x6080, 0x6440, 0x16800, 0x16800, 0x6090, 0x6900, 0x16810, 0x16810
.long 0x60a0, 0x6910, 0x16820, 0x16820, 0x60b0, 0x6920, 0x16830, 0x16830
.long 0x6c00, 0x6930, 0x16840, 0x16840, 0x6c10, 0x6940, 0x16850, 0x16d00
.long 0x6c20, 0x6e00, 0x16860, 0x16d10, 0x6c30, 0x6e10, 0x16870, 0x16d20
.long 0x6c40, 0x6e20, 0x16880, 0x16d30, 0x6c50, 0x6e30, 0x16890, 0x16d40
.long 0x6c60, 0x6e40, 0x168a0, 0x17200, 0x6c70, 0x7300, 0x168b0, 0x17210
.long 0x6c80, 0x7310, 0x17400, 0x17220, 0x6c90, 0x7320, 0x17410, 0x17230
.long 0x6ca0, 0x7330, 0x17420, 0x17240, 0x6cb0, 0x7340, 0x17430, 0x17700
.long 0x7800, 0x7800, 0x17440, 0x17710, 0x7810, 0x7810, 0x17450, 0x17720
.long 0x7820, 0x7820, 0x17460, 0x17730, 0x7830, 0x7830, 0x17470, 0x17740
.long 0x7840, 0x7840, 0x17480, 0x17c00, 0x7850, 0x7d00, 0x17490, 0x17c10
.long 0x7860, 0x7d10, 0x174a0, 0x17c20, 0x7870, 0x7d20, 0x174b0, 0x17c30
.long 0x7880, 0x7d30, 0x18000, 0x17c40, 0x7890, 0x7d40, 0x18010, 0x18100
.long 0x78a0, 0x8200, 0x18020, 0x18110, 0x78b0, 0x8210, 0x18030, 0x18120
.long 0x8400, 0x8220, 0x18040, 0x18130, 0x8410, 0x8230, 0x18050, 0x18140
.long 0x8420, 0x8240, 0x18060, 0x18600, 0x8430, 0x8700, 0x18070, 0x18610
.long 0x8440, 0x8710, 0x18080, 0x18620, 0x8450, 0x8720, 0x18090, 0x18630
.long 0x8460, 0x8730, 0x180a0, 0x18640, 0x8470, 0x8740, 0x180b0, 0x18b00
.long 0x8480, 0x8c00, 0x18c00, 0x18b10, 0x8490, 0x8c10, 0x18c10, 0x18b20
.long 0x84a0, 0x8c20, 0x18c20, 0x18b30, 0x84b0, 0x8c30, 0x18c30, 0x18b40
.long 0x9000, 0x8c40, 0x18c40, 0x19000, 0x9010, 0x9100, 0x18c50, 0x19010
.long 0x9020, 0x9110, 0x18c60, 0x19020, 0x9030, 0x9120, 0x18c70, 0x19030
.long 0x9040, 0x9130, 0x18c80, 0x19040, 0x9050, 0x9140, 0x18c90, 0x19500
.long 0x9060, 0x9600, 0x18ca0, 0x19510, 0x9070, 0x9610, 0x18cb0, 0x19520
.long 0x9080, 0x9620, 0x19800, 0x19530, 0x9090, 0x9630, 0x19810, 0x19540
.long 0x90a0, 0x9640, 0x19820, 0x19a00, 0x90b0, 0x9b00, 0x19830, 0x19a10
.long 0x9c00, 0x9b10, 0x19840, 0x19a20, 0x9c10, 0x9b20, 0x19850, 0x19a30
.long 0x9c20, 0x9b30, 0x19860, 0x19a40, 0x9c30, 0x9b40, 0x19870, 0x19f00
.long 0x9c40, 0xa000, 0x19880, 0x19f10, 0x9c50, 0xa010, 0x19890, 0x19f20
.long 0x9c60, 0xa020, 0x198a0, 0x19f30, 0x9c70, 0xa030, 0x198b0, 0x19f40
.long 0x9c80, 0xa040, 0x1a400, 0x1a400, 0x9c90, 0xa500, 0x1a410, 0x1a410
.long 0x9ca0, 0xa510, 0x1a420, 0x1a420, 0x9cb0, 0xa520, 0x1a430, 0x1a430
.long 0xa800, 0xa530, 0x1a440, 0x1a440, 0xa810, 0xa540, 0x1a450, 0x1a900
.long 0xa820, 0xaa00, 0x1a460, 0x1a910, 0xa830, 0xaa10, 0x1a470, 0x1a920
.long 0xa840, 0xaa20, 0x1a480, 0x1a930, 0xa850, 0xaa30, 0x1a490, 0x1a940
.long 0xa860, 0xaa40, 0x1a4a0, 0x1ae00, 0xa870, 0xaf00, 0x1a4b0, 0x1ae10
.long 0xa880, 0xaf10, 0x1b000, 0x1ae20, 0xa890, 0xaf20, 0x1b010, 0x1ae30
.long 0xa8a0, 0xaf30, 0x1b020, 0x1ae40, 0xa8b0, 0xaf40, 0x1b030, 0x1b300
.long 0xb400, 0xb400, 0x1b040, 0x1b310, 0xb410, 0xb410, 0x1b050, 0x1b320
.long 0xb420, 0xb420, 0x1b060, 0x1b330, 0xb430, 0xb430, 0x1b070, 0x1b340
.long 0xb440, 0xb440, 0x1b080, 0x1b800, 0xb450, 0xb900, 0x1b090, 0x1b810
.long 0xb460, 0xb910, 0x1b0a0, 0x1b820, 0xb470, 0xb920, 0x1b0b0, 0x1b830
.long 0xb480, 0xb930, 0x1bc00, 0x1b840, 0xb490, 0xb940, 0x1bc10, 0x1bd00
.long 0xb4a0, 0xbe00, 0x1bc20, 0x1bd10, 0xb4b0, 0xbe10, 0x1bc30, 0x1bd20
.long 0xc000, 0xbe20, 0x1bc40, 0x1bd30, 0xc010, 0xbe30, 0x1bc50, 0x1bd40
.long 0xc020, 0xbe40, 0x1bc60, 0x1c200, 0xc030, 0xc300, 0x1bc70, 0x1c210
.long 0xc040, 0xc310, 0x1bc80, 0x1c220, 0xc050, 0xc320, 0x1bc90, 0x1c230
.long 0xc060, 0xc330, 0x1bca0, 0x1c240, 0xc070, 0xc340, 0x1bcb0, 0x1c700
.long 0xc080, 0xc800, 0x1c800, 0x1c710, 0xc090, 0xc810, 0x1c810, 0x1c720
.long 0xc0a0, 0xc820, 0x1c820, 0x1c730, 0xc0b0, 0xc830, 0x1c830, 0x1c740
.long 0xcc00, 0xc840, 0x1c840, 0x1cc00, 0xcc10, 0xcd00, 0x1c850, 0x1cc10
.long 0xcc20, 0xcd10, 0x1c860, 0x1cc20, 0xcc30, 0xcd20, 0x1c870, 0x1cc30
.long 0xcc40, 0xcd30, 0x1c880, 0x1cc40, 0xcc50, 0xcd40, 0x1c890, 0x1d100
.long 0xcc60, 0xd200, 0x1c8a0, 0x1d110, 0xcc70, 0xd210, 0x1c8b0, 0x1d120
.long 0xcc80, 0xd220, 0x1d400, 0x1d130, 0xcc90, 0xd230, 0x1d410, 0x1d140
.long 0xcca0, 0xd240, 0x1d420, 0x1d600, 0xccb0, 0xd700, 0x1d430, 0x1d610
.long 0xd800, 0xd710, 0x1d440, 0x1d620, 0xd810, 0xd720, 0x1d450, 0x1d630
.long 0xd820, 0xd730, 0x1d460, 0x1d640, 0xd830, 0xd740, 0x1d470, 0x1db00
.long 0xd840, 0xdc00, 0x1d480, 0x1db10, 0xd850, 0xdc10, 0x1d490, 0x1db20
.long 0xd860, 0xdc20, 0x1d4a0, 0x1db30, 0xd870, 0xdc30, 0x1d4b0, 0x1db40
.long 0xd880, 0xdc40, 0x7ff00000, 0x7ff00000, 0xd890, 0xe100, 0x7ff00000, 0x7ff00000
.long 0xd8a0, 0xe110, 0x7ff00000, 0x7ff00000, 0xd8b0, 0xe120, 0x7ff00000, 0x7ff00000
.long 0xe400, 0xe130, 0x7ff00000, 0x7ff00000, 0xe410, 0xe140, 0x7ff00000, 0x7ff00000
.long 0xe420, 0xe600, 0x7ff00000, 0x7ff00000, 0xe430, 0xe610, 0x7ff00000, 0x7ff00000
.long 0xe440, 0xe620, 0x7ff00000, 0x7ff00000, 0xe450, 0xe630, 0x7ff00000, 0x7ff00000
.long 0xe460, 0xe640, 0x7ff00000, 0x7ff00000, 0xe470, 0xeb00, 0x7ff00000, 0x7ff00000
.long 0xe480, 0xeb10, 0x7ff00000, 0x7ff00000, 0xe490, 0xeb20, 0x7ff00000, 0x7ff00000
.long 0xe4a0, 0xeb30, 0x7ff00000, 0x7ff00000, 0xe4b0, 0xeb40, 0x7ff00000, 0x7ff00000
.long 0xf000, 0xf000, 0x7ff00000, 0x7ff00000, 0xf010, 0xf010, 0x7ff00000, 0x7ff00000
.long 0xf020, 0xf020, 0x7ff00000, 0x7ff00000, 0xf030, 0xf030, 0x7ff00000, 0x7ff00000
.long 0xf040, 0xf040, 0x7ff00000, 0x7ff00000, 0xf050, 0xf500, 0x7ff00000, 0x7ff00000
.long 0xf060, 0xf510, 0x7ff00000, 0x7ff00000, 0xf070, 0xf520, 0x7ff00000, 0x7ff00000
.long 0xf080, 0xf530, 0x7ff00000, 0x7ff00000, 0xf090, 0xf540, 0x7ff00000, 0x7ff00000
.long 0xf0a0, 0xfa00, 0x7ff00000, 0x7ff00000, 0xf0b0, 0xfa10, 0x7ff00000, 0x7ff00000
.long 0xfc00, 0xfa20, 0x7ff00000, 0x7ff00000, 0xfc10, 0xfa30, 0x7ff00000, 0x7ff00000
.long 0xfc20, 0xfa40, 0x7ff00000, 0x7ff00000, 0xfc30, 0xff00, 0x7ff00000, 0x7ff00000
.long 0x4, 0x14, 0x24, 0x34, 0x44, 0x54, 0x64, 0x74
.long 0x84, 0x94, 0x504, 0x514, 0x524, 0x534, 0x544, 0x554
.long 0x564, 0x574, 0x584, 0x594, 0xa04, 0xa14, 0xa24, 0xa34
.long 0xa44, 0xa54, 0xa64, 0xa74, 0xa84, 0xa94, 0xf04, 0xf14
.long 0xf24, 0xf34, 0xf44, 0xf54, 0xf64, 0xf74, 0xf84, 0xf94
.long 0x1404, 0x1414, 0x1424, 0x1434, 0x1444, 0x1454, 0x1464, 0x1474
.long 0x1484, 0x1494, 0x1904, 0x1914, 0x1924, 0x1934, 0x1944, 0x1954
.long 0x1964, 0x1974, 0x1984, 0x1994, 0x1e04, 0x1e14, 0x1e24, 0x1e34
.long 0x1e44, 0x1e54, 0x1e64, 0x1e74, 0x1e84, 0x1e94, 0x2304, 0x2314
.long 0x2324, 0x2334, 0x2344, 0x2354, 0x2364, 0x2374, 0x2384, 0x2394
.long 0x4604, 0x4614, 0x4624, 0x4634, 0x4644, 0x4654, 0x4664, 0x4674
.long 0x4684, 0x4694, 0x4b04, 0x4b14, 0x4b24, 0x4b34, 0x4b44, 0x4b54
.long 0x4b64, 0x4b74, 0x4b84, 0x4b94, 0x5004, 0x5014, 0x5024, 0x5034
.long 0x5044, 0x5054, 0x5064, 0x5074, 0x5084, 0x5094, 0x5504, 0x5514
.long 0x5524, 0x5534, 0x5544, 0x5554, 0x5564, 0x5574, 0x5584, 0x5594
.long 0x3204, 0x3214, 0x3224, 0x3234, 0x3244, 0x3254, 0x3264, 0x3274
.long 0x3284, 0x3294, 0x3704, 0x3714, 0x3724, 0x3734, 0x3744, 0x3754
.long 0x3764, 0x3774, 0x3784, 0x3794, 0x3c04, 0x3c14, 0x3c24, 0x3c34
.long 0x3c44, 0x3c54, 0x3c64, 0x3c74, 0x3c84, 0x3c94, 0x4104, 0x4114
.long 0x4124, 0x4134, 0x4144, 0x4154, 0x4164, 0x4174, 0x4184, 0x4194
.long 0x6404, 0x6414, 0x6424, 0x6434, 0x6444, 0x6454, 0x6464, 0x6474
.long 0x6484, 0x6494, 0x6904, 0x6914, 0x6924, 0x6934, 0x6944, 0x6954
.long 0x6964, 0x6974, 0x6984, 0x6994, 0x6e04, 0x6e14, 0x6e24, 0x6e34
.long 0x6e44, 0x6e54, 0x6e64, 0x6e74, 0x6e84, 0x6e94, 0x7304, 0x7314
.long 0x7324, 0x7334, 0x7344, 0x7354, 0x7364, 0x7374, 0x7384, 0x7394
.long 0x7ff00008, 0x7ff00008, 0x7ff00008, 0x7ff00008, 0x7ff00008, 0x7ff00008, 0x7ff00008, 0x7ff00008
.long 0x7ff00008, 0x7ff00008, 0x7ff00008, 0x7ff00008, 0x7ff00008, 0x7ff00008, 0x7ff00008, 0x7ff00008
.long 0x7ff00008, 0x7ff00008, 0x7ff00008, 0x7ff00008, 0x7ff00008, 0x7ff00008, 0x7ff00008, 0x7ff00008
.long 0x7ff00008, 0x7ff00008, 0x7ff00008, 0x7ff00008, 0x7ff00008, 0x7ff00008, 0x7ff00008, 0x7ff00008
.long 0x7ff00008, 0x7ff00008, 0x7ff00008, 0x7ff00008, 0x7ff00008, 0x7ff00008, 0x7ff00008, 0x7ff00008
.long 0x7ff00008, 0x7ff00008, 0x7ff00008, 0x7ff00008, 0x7ff00008, 0x7ff00008, 0x7ff00008, 0x7ff00008
.long 0x7ff00008, 0x7ff00008, 0x7ff00008, 0x7ff00008, 0x7ff00008, 0x7ff00008, 0x7ff00008, 0x7ff00008
.long 0x7804, 0x7814, 0x7824, 0x7834, 0x7844, 0x7854, 0x7864, 0x7874
.long 0x7884, 0x7894, 0x7d04, 0x7d14, 0x7d24, 0x7d34, 0x7d44, 0x7d54
.long 0x7d64, 0x7d74, 0x7d84, 0x7d94, 0x8204, 0x8214, 0x8224, 0x8234
.long 0x8244, 0x8254, 0x8264, 0x8274, 0x8284, 0x8294, 0x8704, 0x8714
.long 0x8724, 0x8734, 0x8744, 0x8754, 0x8764, 0x8774, 0x8784, 0x8794
.long 0xaa04, 0xaa14, 0xaa24, 0xaa34, 0xaa44, 0xaa54, 0xaa64, 0xaa74
.long 0xaa84, 0xaa94, 0xaf04, 0xaf14, 0xaf24, 0xaf34, 0xaf44, 0xaf54
.long 0xaf64, 0xaf74, 0xaf84, 0xaf94, 0xb404, 0xb414, 0xb424, 0xb434
.long 0xb444, 0xb454, 0xb464, 0xb474, 0xb484, 0xb494, 0xb904, 0xb914
.long 0xb924, 0xb934, 0xb944, 0xb954, 0xb964, 0xb974, 0xb984, 0xb994
.long 0x9604, 0x9614, 0x9624, 0x9634, 0x9644, 0x9654, 0x9664, 0x9674
.long 0x9684, 0x9694, 0x9b04, 0x9b14, 0x9b24, 0x9b34, 0x9b44, 0x9b54
.long 0x9b64, 0x9b74, 0x9b84, 0x9b94, 0xa004, 0xa014, 0xa024, 0xa034
.long 0xa044, 0xa054, 0xa064, 0xa074, 0xa084, 0xa094, 0xa504, 0xa514
.long 0xa524, 0xa534, 0xa544, 0xa554, 0xa564, 0xa574, 0xa584, 0xa594
.long 0x5, 0x15, 0x25, 0x35, 0x45, 0x55, 0x65, 0x75
.long 0x85, 0x95, 0x505, 0x515, 0x525, 0x535, 0x545, 0x555
.long 0x565, 0x575, 0x585, 0x595, 0xa05, 0xa15, 0xa25, 0xa35
.long 0xa45, 0xa55, 0xa65, 0xa75, 0xa85, 0xa95, 0xf05, 0xf15
.long 0xf25, 0xf35, 0xf45, 0xf55, 0xf65, 0xf75, 0xf85, 0xf95
.long 0x1405, 0x1415, 0x1425, 0x1435, 0x1445, 0x1455, 0x1465, 0x1475
.long 0x1485, 0x1495, 0x1905, 0x1915, 0x1925, 0x1935, 0x1945, 0x1955
.long 0x1965, 0x1975, 0x1985, 0x1995, 0x1e05, 0x1e15, 0x1e25, 0x1e35
.long 0x1e45, 0x1e55, 0x1e65, 0x1e75, 0x1e85, 0x1e95, 0x2305, 0x2315
.long 0x2325, 0x2335, 0x2345, 0x2355, 0x2365, 0x2375, 0x2385, 0x2395
.long 0x7ff00008, 0x7ff00008, 0x7ff00008, 0x7ff00008, 0x7ff00008, 0x7ff00008, 0x7ff00008, 0x7ff00008
.long 0x7ff00008, 0x7ff00008, 0x7ff00008, 0x7ff00008, 0x7ff00008, 0x7ff00008, 0x7ff00008, 0x7ff00008
.long 0x7ff00008, 0x7ff00008, 0x7ff00008, 0x7ff00008, 0x7ff00008, 0x7ff00008, 0x7ff00008, 0x7ff00008
.long 0x7ff00008, 0x7ff00008, 0x7ff00008, 0x7ff00008, 0x7ff00008, 0x7ff00008, 0x7ff00008, 0x7ff00008
.long 0x7ff00008, 0x7ff00008, 0x7ff00008, 0x7ff00008, 0x7ff00008, 0x7ff00008, 0x7ff00008, 0x7ff00008
.long 0x7ff00008, 0x7ff00008, 0x7ff00008, 0x7ff00008, 0x7ff00008, 0x7ff00008, 0x7ff00008, 0x7ff00008
.long 0x7ff00008, 0x7ff00008, 0x7ff00008, 0x7ff00008, 0x7ff00008, 0x7ff00008, 0x7ff00008, 0x7ff00008
.long 0x4605, 0x4615, 0x4625, 0x4635, 0x4645, 0x4655, 0x4665, 0x4675
.long 0x4685, 0x4695, 0x4b05, 0x4b15, 0x4b25, 0x4b35, 0x4b45, 0x4b55
.long 0x4b65, 0x4b75, 0x4b85, 0x4b95, 0x5005, 0x5015, 0x5025, 0x5035
.long 0x5045, 0x5055, 0x5065, 0x5075, 0x5085, 0x5095, 0x5505, 0x5515
.long 0x5525, 0x5535, 0x5545, 0x5555, 0x5565, 0x5575, 0x5585, 0x5595
.long 0x3205, 0x3215, 0x3225, 0x3235, 0x3245, 0x3255, 0x3265, 0x3275
.long 0x3285, 0x3295, 0x3705, 0x3715, 0x3725, 0x3735, 0x3745, 0x3755
.long 0x3765, 0x3775, 0x3785, 0x3795, 0x3c05, 0x3c15, 0x3c25, 0x3c35
.long 0x3c45, 0x3c55, 0x3c65, 0x3c75, 0x3c85, 0x3c95, 0x4105, 0x4115
.long 0x4125, 0x4135, 0x4145, 0x4155, 0x4165, 0x4175, 0x4185, 0x4195
.long 0x6405, 0x6415, 0x6425, 0x6435, 0x6445, 0x6455, 0x6465, 0x6475
.long 0x6485, 0x6495, 0x6905, 0x6915, 0x6925, 0x6935, 0x6945, 0x6955
.long 0x6965, 0x6975, 0x6985, 0x6995, 0x6e05, 0x6e15, 0x6e25, 0x6e35
.long 0x6e45, 0x6e55, 0x6e65, 0x6e75, 0x6e85, 0x6e95, 0x7305, 0x7315
.long 0x7325, 0x7335, 0x7345, 0x7355, 0x7365, 0x7375, 0x7385, 0x7395
.long 0x7805, 0x7815, 0x7825, 0x7835, 0x7845, 0x7855, 0x7865, 0x7875
.long 0x7885, 0x7895, 0x7d05, 0x7d15, 0x7d25, 0x7d35, 0x7d45, 0x7d55
.long 0x7d65, 0x7d75, 0x7d85, 0x7d95, 0x8205, 0x8215, 0x8225, 0x8235
.long 0x8245, 0x8255, 0x8265, 0x8275, 0x8285, 0x8295, 0x8705, 0x8715
.long 0x8725, 0x8735, 0x8745, 0x8755, 0x8765, 0x8775, 0x8785, 0x8795
.long 0xaa05, 0xaa15, 0xaa25, 0xaa35, 0xaa45, 0xaa55, 0xaa65, 0xaa75
.long 0xaa85, 0xaa95, 0xaf05, 0xaf15, 0xaf25, 0xaf35, 0xaf45, 0xaf55
.long 0xaf65, 0xaf75, 0xaf85, 0xaf95, 0xb405, 0xb415, 0xb425, 0xb435
.long 0xb445, 0xb455, 0xb465, 0xb475, 0xb485, 0xb495, 0xb905, 0xb915
.long 0xb925, 0xb935, 0xb945, 0xb955, 0xb965, 0xb975, 0xb985, 0xb995
.long 0x7ff00008, 0x7ff00008, 0x7ff00008, 0x7ff00008, 0x7ff00008, 0x7ff00008, 0x7ff00008, 0x7ff00008
.long 0x7ff00008, 0x7ff00008, 0x7ff00008, 0x7ff00008, 0x7ff00008, 0x7ff00008, 0x7ff00008, 0x7ff00008
.long 0x7ff00008, 0x7ff00008, 0x7ff00008, 0x7ff00008, 0x7ff00008, 0x7ff00008, 0x7ff00008, 0x7ff00008
.long 0x7ff00008, 0x7ff00008, 0x7ff00008, 0x7ff00008, 0x7ff00008, 0x7ff00008, 0x7ff00008, 0x7ff00008
.long 0x7ff00008, 0x7ff00008, 0x7ff00008, 0x7ff00008, 0x7ff00008, 0x7ff00008, 0x7ff00008, 0x7ff00008
.long 0x7ff00008, 0x7ff00008, 0x7ff00008, 0x7ff00008, 0x7ff00008, 0x7ff00008, 0x7ff00008, 0x7ff00008
.long 0x7ff00008, 0x7ff00008, 0x7ff00008, 0x7ff00008, 0x7ff00008, 0x7ff00008, 0x7ff00008, 0x7ff00008
.long 0x9605, 0x9615, 0x9625, 0x9635, 0x9645, 0x9655, 0x9665, 0x9675
.long 0x9685, 0x9695, 0x9b05, 0x9b15, 0x9b25, 0x9b35, 0x9b45, 0x9b55
.long 0x9b65, 0x9b75, 0x9b85, 0x9b95, 0xa005, 0xa015, 0xa025, 0xa035
.long 0xa045, 0xa055, 0xa065, 0xa075, 0xa085, 0xa095, 0xa505, 0xa515
.long 0xa525, 0xa535, 0xa545, 0xa555, 0xa565, 0xa575, 0xa585, 0xa595
.long 0x6, 0x16, 0x26, 0x36, 0x46, 0x56, 0x66, 0x76
.long 0x86, 0x96, 0x506, 0x516, 0x526, 0x536, 0x546, 0x556
.long 0x566, 0x576, 0x586, 0x596, 0xa06, 0xa16, 0xa26, 0xa36
.long 0xa46, 0xa56, 0xa66, 0xa76, 0xa86, 0xa96, 0xf06, 0xf16
.long 0xf26, 0xf36, 0xf46, 0xf56, 0xf66, 0xf76, 0xf86, 0xf96
.long 0x1406, 0x1416, 0x1426, 0x1436, 0x1446, 0x1456, 0x1466, 0x1476
.long 0x1486, 0x1496, 0x1906, 0x1916, 0x1926, 0x1936, 0x1946, 0x1956
.long 0x1966, 0x1976, 0x1986, 0x1996, 0x1e06, 0x1e16, 0x1e26, 0x1e36
.long 0x1e46, 0x1e56, 0x1e66, 0x1e76, 0x1e86, 0x1e96, 0x2306, 0x2316
.long 0x2326, 0x2336, 0x2346, 0x2356, 0x2366, 0x2376, 0x2386, 0x2396
.long 0x4606, 0x4616, 0x4626, 0x4636, 0x4646, 0x4656, 0x4666, 0x4676
.long 0x4686, 0x4696, 0x4b06, 0x4b16, 0x4b26, 0x4b36, 0x4b46, 0x4b56
.long 0x4b66, 0x4b76, 0x4b86, 0x4b96, 0x5006, 0x5016, 0x5026, 0x5036
.long 0x5046, 0x5056, 0x5066, 0x5076, 0x5086, 0x5096, 0x5506, 0x5516
.long 0x5526, 0x5536, 0x5546, 0x5556, 0x5566, 0x5576, 0x5586, 0x5596
.long 0x3206, 0x3216, 0x3226, 0x3236, 0x3246, 0x3256, 0x3266, 0x3276
.long 0x3286, 0x3296, 0x3706, 0x3716, 0x3726, 0x3736, 0x3746, 0x3756
.long 0x3766, 0x3776, 0x3786, 0x3796, 0x3c06, 0x3c16, 0x3c26, 0x3c36
.long 0x3c46, 0x3c56, 0x3c66, 0x3c76, 0x3c86, 0x3c96, 0x4106, 0x4116
.long 0x4126, 0x4136, 0x4146, 0x4156, 0x4166, 0x4176, 0x4186, 0x4196
.long 0x7ff00008, 0x7ff00008, 0x7ff00008, 0x7ff00008, 0x7ff00008, 0x7ff00008, 0x7ff00008, 0x7ff00008
.long 0x7ff00008, 0x7ff00008, 0x7ff00008, 0x7ff00008, 0x7ff00008, 0x7ff00008, 0x7ff00008, 0x7ff00008
.long 0x7ff00008, 0x7ff00008, 0x7ff00008, 0x7ff00008, 0x7ff00008, 0x7ff00008, 0x7ff00008, 0x7ff00008
.long 0x7ff00008, 0x7ff00008, 0x7ff00008, 0x7ff00008, 0x7ff00008, 0x7ff00008, 0x7ff00008, 0x7ff00008
.long 0x7ff00008, 0x7ff00008, 0x7ff00008, 0x7ff00008, 0x7ff00008, 0x7ff00008, 0x7ff00008, 0x7ff00008
.long 0x7ff00008, 0x7ff00008, 0x7ff00008, 0x7ff00008, 0x7ff00008, 0x7ff00008, 0x7ff00008, 0x7ff00008
.long 0x7ff00008, 0x7ff00008, 0x7ff00008, 0x7ff00008, 0x7ff00008, 0x7ff00008, 0x7ff00008, 0x7ff00008
.long 0x6406, 0x6416, 0x6426, 0x6436, 0x6446, 0x6456, 0x6466, 0x6476
.long 0x6486, 0x6496, 0x6906, 0x6916, 0x6926, 0x6936, 0x6946, 0x6956
.long 0x6966, 0x6976, 0x6986, 0x6996, 0x6e06, 0x6e16, 0x6e26, 0x6e36
.long 0x6e46, 0x6e56, 0x6e66, 0x6e76, 0x6e86, 0x6e96, 0x7306, 0x7316
.long 0x7326, 0x7336, 0x7346, 0x7356, 0x7366, 0x7376, 0x7386, 0x7396
.long 0x7806, 0x7816, 0x7826, 0x7836, 0x7846, 0x7856, 0x7866, 0x7876
.long 0x7886, 0x7896, 0x7d06, 0x7d16, 0x7d26, 0x7d36, 0x7d46, 0x7d56
.long 0x7d66, 0x7d76, 0x7d86, 0x7d96, 0x8206, 0x8216, 0x8226, 0x8236
.long 0x8246, 0x8256, 0x8266, 0x8276, 0x8286, 0x8296, 0x8706, 0x8716
.long 0x8726, 0x8736, 0x8746, 0x8756, 0x8766, 0x8776, 0x8786, 0x8796
.long 0xaa06, 0xaa16, 0xaa26, 0xaa36, 0xaa46, 0xaa56, 0xaa66, 0xaa76
.long 0xaa86, 0xaa96, 0xaf06, 0xaf16, 0xaf26, 0xaf36, 0xaf46, 0xaf56
.long 0xaf66, 0xaf76, 0xaf86, 0xaf96, 0xb406, 0xb416, 0xb426, 0xb436
.long 0xb446, 0xb456, 0xb466, 0xb476, 0xb486, 0xb496, 0xb906, 0xb916
.long 0xb926, 0xb936, 0xb946, 0xb956, 0xb966, 0xb976, 0xb986, 0xb996
.long 0x9606, 0x9616, 0x9626, 0x9636, 0x9646, 0x9656, 0x9666, 0x9676
.long 0x9686, 0x9696, 0x9b06, 0x9b16, 0x9b26, 0x9b36, 0x9b46, 0x9b56
.long 0x9b66, 0x9b76, 0x9b86, 0x9b96, 0xa006, 0xa016, 0xa026, 0xa036
.long 0xa046, 0xa056, 0xa066, 0xa076, 0xa086, 0xa096, 0xa506, 0xa516
.long 0xa526, 0xa536, 0xa546, 0xa556, 0xa566, 0xa576, 0xa586, 0xa596
.long 0x64004, 0x64014, 0x64024, 0x64034, 0x64044, 0x64054, 0x64064, 0x64074
.long 0x64084, 0x64094, 0x64504, 0x64514, 0x64524, 0x64534, 0x64544, 0x64554
.long 0x64564, 0x64574, 0x64584, 0x64594, 0x64a04, 0x64a14, 0x64a24, 0x64a34
.long 0x64a44, 0x64a54, 0x64a64, 0x64a74, 0x64a84, 0x64a94, 0x64f04, 0x64f14
.long 0x64f24, 0x64f34, 0x64f44, 0x64f54, 0x64f64, 0x64f74, 0x64f84, 0x64f94
.long 0x7ff00008, 0x7ff00008, 0x7ff00008, 0x7ff00008, 0x7ff00008, 0x7ff00008, 0x7ff00008, 0x7ff00008
.long 0x7ff00008, 0x7ff00008, 0x7ff00008, 0x7ff00008, 0x7ff00008, 0x7ff00008, 0x7ff00008, 0x7ff00008
.long 0x7ff00008, 0x7ff00008, 0x7ff00008, 0x7ff00008, 0x7ff00008, 0x7ff00008, 0x7ff00008, 0x7ff00008
.long 0x7ff00008, 0x7ff00008, 0x7ff00008, 0x7ff00008, 0x7ff00008, 0x7ff00008, 0x7ff00008, 0x7ff00008
.long 0x7ff00008, 0x7ff00008, 0x7ff00008, 0x7ff00008, 0x7ff00008, 0x7ff00008, 0x7ff00008, 0x7ff00008
.long 0x7ff00008, 0x7ff00008, 0x7ff00008, 0x7ff00008, 0x7ff00008, 0x7ff00008, 0x7ff00008, 0x7ff00008
.long 0x7ff00008, 0x7ff00008, 0x7ff00008, 0x7ff00008, 0x7ff00008, 0x7ff00008, 0x7ff00008, 0x7ff00008
.long 0x65404, 0x65414, 0x65424, 0x65434, 0x65444, 0x65454, 0x65464, 0x65474
.long 0x65484, 0x65494, 0x65904, 0x65914, 0x65924, 0x65934, 0x65944, 0x65954
.long 0x65964, 0x65974, 0x65984, 0x65994, 0x65e04, 0x65e14, 0x65e24, 0x65e34
.long 0x65e44, 0x65e54, 0x65e64, 0x65e74, 0x65e84, 0x65e94, 0x66304, 0x66314
.long 0x66324, 0x66334, 0x66344, 0x66354, 0x66364, 0x66374, 0x66384, 0x66394
.long 0x68604, 0x68614, 0x68624, 0x68634, 0x68644, 0x68654, 0x68664, 0x68674
.long 0x68684, 0x68694, 0x68b04, 0x68b14, 0x68b24, 0x68b34, 0x68b44, 0x68b54
.long 0x68b64, 0x68b74, 0x68b84, 0x68b94, 0x69004, 0x69014, 0x69024, 0x69034
.long 0x69044, 0x69054, 0x69064, 0x69074, 0x69084, 0x69094, 0x69504, 0x69514
.long 0x69524, 0x69534, 0x69544, 0x69554, 0x69564, 0x69574, 0x69584, 0x69594
.long 0x67204, 0x67214, 0x67224, 0x67234, 0x67244, 0x67254, 0x67264, 0x67274
.long 0x67284, 0x67294, 0x67704, 0x67714, 0x67724, 0x67734, 0x67744, 0x67754
.long 0x67764, 0x67774, 0x67784, 0x67794, 0x67c04, 0x67c14, 0x67c24, 0x67c34
.long 0x67c44, 0x67c54, 0x67c64, 0x67c74, 0x67c84, 0x67c94, 0x68104, 0x68114
.long 0x68124, 0x68134, 0x68144, 0x68154, 0x68164, 0x68174, 0x68184, 0x68194
.long 0x6a404, 0x6a414, 0x6a424, 0x6a434, 0x6a444, 0x6a454, 0x6a464, 0x6a474
.long 0x6a484, 0x6a494, 0x6a904, 0x6a914, 0x6a924, 0x6a934, 0x6a944, 0x6a954
.long 0x6a964, 0x6a974, 0x6a984, 0x6a994, 0x6ae04, 0x6ae14, 0x6ae24, 0x6ae34
.long 0x6ae44, 0x6ae54, 0x6ae64, 0x6ae74, 0x6ae84, 0x6ae94, 0x6b304, 0x6b314
.long 0x6b324, 0x6b334, 0x6b344, 0x6b354, 0x6b364, 0x6b374, 0x6b384, 0x6b394
.long 0x6b804, 0x6b814, 0x6b824, 0x6b834, 0x6b844, 0x6b854, 0x6b864, 0x6b874
.long 0x6b884, 0x6b894, 0x6bd04, 0x6bd14, 0x6bd24, 0x6bd34, 0x6bd44, 0x6bd54
.long 0x6bd64, 0x6bd74, 0x6bd84, 0x6bd94, 0x6c204, 0x6c214, 0x6c224, 0x6c234
.long 0x6c244, 0x6c254, 0x6c264, 0x6c274, 0x6c284, 0x6c294, 0x6c704, 0x6c714
.long 0x6c724, 0x6c734, 0x6c744, 0x6c754, 0x6c764, 0x6c774, 0x6c784, 0x6c794
.long 0x7ff00008, 0x7ff00008, 0x7ff00008, 0x7ff00008, 0x7ff00008, 0x7ff00008, 0x7ff00008, 0x7ff00008
.long 0x7ff00008, 0x7ff00008, 0x7ff00008, 0x7ff00008, 0x7ff00008, 0x7ff00008, 0x7ff00008, 0x7ff00008
.long 0x7ff00008, 0x7ff00008, 0x7ff00008, 0x7ff00008, 0x7ff00008, 0x7ff00008, 0x7ff00008, 0x7ff00008
.long 0x7ff00008, 0x7ff00008, 0x7ff00008, 0x7ff00008, 0x7ff00008, 0x7ff00008, 0x7ff00008, 0x7ff00008
.long 0x7ff00008, 0x7ff00008, 0x7ff00008, 0x7ff00008, 0x7ff00008, 0x7ff00008, 0x7ff00008, 0x7ff00008
.long 0x7ff00008, 0x7ff00008, 0x7ff00008, 0x7ff00008, 0x7ff00008, 0x7ff00008, 0x7ff00008, 0x7ff00008
.long 0x7ff00008, 0x7ff00008, 0x7ff00008, 0x7ff00008, 0x7ff00008, 0x7ff00008, 0x7ff00008, 0x7ff00008
.long 0x6ea04, 0x6ea14, 0x6ea24, 0x6ea34, 0x6ea44, 0x6ea54, 0x6ea64, 0x6ea74
.long 0x6ea84, 0x6ea94, 0x6ef04, 0x6ef14, 0x6ef24, 0x6ef34, 0x6ef44, 0x6ef54
.long 0x6ef64, 0x6ef74, 0x6ef84, 0x6ef94, 0x6f404, 0x6f414, 0x6f424, 0x6f434
.long 0x6f444, 0x6f454, 0x6f464, 0x6f474, 0x6f484, 0x6f494, 0x6f904, 0x6f914
.long 0x6f924, 0x6f934, 0x6f944, 0x6f954, 0x6f964, 0x6f974, 0x6f984, 0x6f994
.long 0x6d604, 0x6d614, 0x6d624, 0x6d634, 0x6d644, 0x6d654, 0x6d664, 0x6d674
.long 0x6d684, 0x6d694, 0x6db04, 0x6db14, 0x6db24, 0x6db34, 0x6db44, 0x6db54
.long 0x6db64, 0x6db74, 0x6db84, 0x6db94, 0x6e004, 0x6e014, 0x6e024, 0x6e034
.long 0x6e044, 0x6e054, 0x6e064, 0x6e074, 0x6e084, 0x6e094, 0x6e504, 0x6e514
.long 0x6e524, 0x6e534, 0x6e544, 0x6e554, 0x6e564, 0x6e574, 0x6e584, 0x6e594
.long 0x64005, 0x64015, 0x64025, 0x64035, 0x64045, 0x64055, 0x64065, 0x64075
.long 0x64085, 0x64095, 0x64505, 0x64515, 0x64525, 0x64535, 0x64545, 0x64555
.long 0x64565, 0x64575, 0x64585, 0x64595, 0x64a05, 0x64a15, 0x64a25, 0x64a35
.long 0x64a45, 0x64a55, 0x64a65, 0x64a75, 0x64a85, 0x64a95, 0x64f05, 0x64f15
.long 0x64f25, 0x64f35, 0x64f45, 0x64f55, 0x64f65, 0x64f75, 0x64f85, 0x64f95
.long 0x65405, 0x65415, 0x65425, 0x65435, 0x65445, 0x65455, 0x65465, 0x65475
.long 0x65485, 0x65495, 0x65905, 0x65915, 0x65925, 0x65935, 0x65945, 0x65955
.long 0x65965, 0x65975, 0x65985, 0x65995, 0x65e05, 0x65e15, 0x65e25, 0x65e35
.long 0x65e45, 0x65e55, 0x65e65, 0x65e75, 0x65e85, 0x65e95, 0x66305, 0x66315
.long 0x66325, 0x66335, 0x66345, 0x66355, 0x66365, 0x66375, 0x66385, 0x66395
.long 0x68605, 0x68615, 0x68625, 0x68635, 0x68645, 0x68655, 0x68665, 0x68675
.long 0x68685, 0x68695, 0x68b05, 0x68b15, 0x68b25, 0x68b35, 0x68b45, 0x68b55
.long 0x68b65, 0x68b75, 0x68b85, 0x68b95, 0x69005, 0x69015, 0x69025, 0x69035
.long 0x69045, 0x69055, 0x69065, 0x69075, 0x69085, 0x69095, 0x69505, 0x69515
.long 0x69525, 0x69535, 0x69545, 0x69555, 0x69565, 0x69575, 0x69585, 0x69595
.long 0x7ff00008, 0x7ff00008, 0x7ff00008, 0x7ff00008, 0x7ff00008, 0x7ff00008, 0x7ff00008, 0x7ff00008
.long 0x7ff00008, 0x7ff00008, 0x7ff00008, 0x7ff00008, 0x7ff00008, 0x7ff00008, 0x7ff00008, 0x7ff00008
.long 0x7ff00008, 0x7ff00008, 0x7ff00008, 0x7ff00008, 0x7ff00008, 0x7ff00008, 0x7ff00008, 0x7ff00008
.long 0x7ff00008, 0x7ff00008, 0x7ff00008, 0x7ff00008, 0x7ff00008, 0x7ff00008, 0x7ff00008, 0x7ff00008
.long 0x7ff00008, 0x7ff00008, 0x7ff00008, 0x7ff00008, 0x7ff00008, 0x7ff00008, 0x7ff00008, 0x7ff00008
.long 0x7ff00008, 0x7ff00008, 0x7ff00008, 0x7ff00008, 0x7ff00008, 0x7ff00008, 0x7ff00008, 0x7ff00008
.long 0x7ff00008, 0x7ff00008, 0x7ff00008, 0x7ff00008, 0x7ff00008, 0x7ff00008, 0x7ff00008, 0x7ff00008
.long 0x67205, 0x67215, 0x67225, 0x67235, 0x67245, 0x67255, 0x67265, 0x67275
.long 0x67285, 0x67295, 0x67705, 0x67715, 0x67725, 0x67735, 0x67745, 0x67755
.long 0x67765, 0x67775, 0x67785, 0x67795, 0x67c05, 0x67c15, 0x67c25, 0x67c35
.long 0x67c45, 0x67c55, 0x67c65, 0x67c75, 0x67c85, 0x67c95, 0x68105, 0x68115
.long 0x68125, 0x68135, 0x68145, 0x68155, 0x68165, 0x68175, 0x68185, 0x68195
.long 0x6a405, 0x6a415, 0x6a425, 0x6a435, 0x6a445, 0x6a455, 0x6a465, 0x6a475
.long 0x6a485, 0x6a495, 0x6a905, 0x6a915, 0x6a925, 0x6a935, 0x6a945, 0x6a955
.long 0x6a965, 0x6a975, 0x6a985, 0x6a995, 0x6ae05, 0x6ae15, 0x6ae25, 0x6ae35
.long 0x6ae45, 0x6ae55, 0x6ae65, 0x6ae75, 0x6ae85, 0x6ae95, 0x6b305, 0x6b315
.long 0x6b325, 0x6b335, 0x6b345, 0x6b355, 0x6b365, 0x6b375, 0x6b385, 0x6b395
.long 0x6b805, 0x6b815, 0x6b825, 0x6b835, 0x6b845, 0x6b855, 0x6b865, 0x6b875
.long 0x6b885, 0x6b895, 0x6bd05, 0x6bd15, 0x6bd25, 0x6bd35, 0x6bd45, 0x6bd55
.long 0x6bd65, 0x6bd75, 0x6bd85, 0x6bd95, 0x6c205, 0x6c215, 0x6c225, 0x6c235
.long 0x6c245, 0x6c255, 0x6c265, 0x6c275, 0x6c285, 0x6c295, 0x6c705, 0x6c715
.long 0x6c725, 0x6c735, 0x6c745, 0x6c755, 0x6c765, 0x6c775, 0x6c785, 0x6c795
.long 0x6ea05, 0x6ea15, 0x6ea25, 0x6ea35, 0x6ea45, 0x6ea55, 0x6ea65, 0x6ea75
.long 0x6ea85, 0x6ea95, 0x6ef05, 0x6ef15, 0x6ef25, 0x6ef35, 0x6ef45, 0x6ef55
.long 0x6ef65, 0x6ef75, 0x6ef85, 0x6ef95, 0x6f405, 0x6f415, 0x6f425, 0x6f435
.long 0x6f445, 0x6f455, 0x6f465, 0x6f475, 0x6f485, 0x6f495, 0x6f905, 0x6f915
.long 0x6f925, 0x6f935, 0x6f945, 0x6f955, 0x6f965, 0x6f975, 0x6f985, 0x6f995
.long 0x6d605, 0x6d615, 0x6d625, 0x6d635, 0x6d645, 0x6d655, 0x6d665, 0x6d675
.long 0x6d685, 0x6d695, 0x6db05, 0x6db15, 0x6db25, 0x6db35, 0x6db45, 0x6db55
.long 0x6db65, 0x6db75, 0x6db85, 0x6db95, 0x6e005, 0x6e015, 0x6e025, 0x6e035
.long 0x6e045, 0x6e055, 0x6e065, 0x6e075, 0x6e085, 0x6e095, 0x6e505, 0x6e515
.long 0x6e525, 0x6e535, 0x6e545, 0x6e555, 0x6e565, 0x6e575, 0x6e585, 0x6e595
.long 0x7ff00008, 0x7ff00008, 0x7ff00008, 0x7ff00008, 0x7ff00008, 0x7ff00008, 0x7ff00008, 0x7ff00008
.long 0x7ff00008, 0x7ff00008, 0x7ff00008, 0x7ff00008, 0x7ff00008, 0x7ff00008, 0x7ff00008, 0x7ff00008
.long 0x7ff00008, 0x7ff00008, 0x7ff00008, 0x7ff00008, 0x7ff00008, 0x7ff00008, 0x7ff00008, 0x7ff00008
.long 0x7ff00008, 0x7ff00008, 0x7ff00008, 0x7ff00008, 0x7ff00008, 0x7ff00008, 0x7ff00008, 0x7ff00008
.long 0x7ff00008, 0x7ff00008, 0x7ff00008, 0x7ff00008, 0x7ff00008, 0x7ff00008, 0x7ff00008, 0x7ff00008
.long 0x7ff00008, 0x7ff00008, 0x7ff00008, 0x7ff00008, 0x7ff00008, 0x7ff00008, 0x7ff00008, 0x7ff00008
.long 0x7ff00008, 0x7ff00008, 0x7ff00008, 0x7ff00008, 0x7ff00008, 0x7ff00008, 0x7ff00008, 0x7ff00008
.long 0x64006, 0x64016, 0x64026, 0x64036, 0x64046, 0x64056, 0x64066, 0x64076
.long 0x64086, 0x64096, 0x64506, 0x64516, 0x64526, 0x64536, 0x64546, 0x64556
.long 0x64566, 0x64576, 0x64586, 0x64596, 0x64a06, 0x64a16, 0x64a26, 0x64a36
.long 0x64a46, 0x64a56, 0x64a66, 0x64a76, 0x64a86, 0x64a96, 0x64f06, 0x64f16
.long 0x64f26, 0x64f36, 0x64f46, 0x64f56, 0x64f66, 0x64f76, 0x64f86, 0x64f96
.long 0x65406, 0x65416, 0x65426, 0x65436, 0x65446, 0x65456, 0x65466, 0x65476
.long 0x65486, 0x65496, 0x65906, 0x65916, 0x65926, 0x65936, 0x65946, 0x65956
.long 0x65966, 0x65976, 0x65986, 0x65996, 0x65e06, 0x65e16, 0x65e26, 0x65e36
.long 0x65e46, 0x65e56, 0x65e66, 0x65e76, 0x65e86, 0x65e96, 0x66306, 0x66316
.long 0x66326, 0x66336, 0x66346, 0x66356, 0x66366, 0x66376, 0x66386, 0x66396
.long 0x68606, 0x68616, 0x68626, 0x68636, 0x68646, 0x68656, 0x68666, 0x68676
.long 0x68686, 0x68696, 0x68b06, 0x68b16, 0x68b26, 0x68b36, 0x68b46, 0x68b56
.long 0x68b66, 0x68b76, 0x68b86, 0x68b96, 0x69006, 0x69016, 0x69026, 0x69036
.long 0x69046, 0x69056, 0x69066, 0x69076, 0x69086, 0x69096, 0x69506, 0x69516
.long 0x69526, 0x69536, 0x69546, 0x69556, 0x69566, 0x69576, 0x69586, 0x69596
.long 0x67206, 0x67216, 0x67226, 0x67236, 0x67246, 0x67256, 0x67266, 0x67276
.long 0x67286, 0x67296, 0x67706, 0x67716, 0x67726, 0x67736, 0x67746, 0x67756
.long 0x67766, 0x67776, 0x67786, 0x67796, 0x67c06, 0x67c16, 0x67c26, 0x67c36
.long 0x67c46, 0x67c56, 0x67c66, 0x67c76, 0x67c86, 0x67c96, 0x68106, 0x68116
.long 0x68126, 0x68136, 0x68146, 0x68156, 0x68166, 0x68176, 0x68186, 0x68196
.long 0x6a406, 0x6a416, 0x6a426, 0x6a436, 0x6a446, 0x6a456, 0x6a466, 0x6a476
.long 0x6a486, 0x6a496, 0x6a906, 0x6a916, 0x6a926, 0x6a936, 0x6a946, 0x6a956
.long 0x6a966, 0x6a976, 0x6a986, 0x6a996, 0x6ae06, 0x6ae16, 0x6ae26, 0x6ae36
.long 0x6ae46, 0x6ae56, 0x6ae66, 0x6ae76, 0x6ae86, 0x6ae96, 0x6b306, 0x6b316
.long 0x6b326, 0x6b336, 0x6b346, 0x6b356, 0x6b366, 0x6b376, 0x6b386, 0x6b396
.long 0x7ff00008, 0x7ff00008, 0x7ff00008, 0x7ff00008, 0x7ff00008, 0x7ff00008, 0x7ff00008, 0x7ff00008
.long 0x7ff00008, 0x7ff00008, 0x7ff00008, 0x7ff00008, 0x7ff00008, 0x7ff00008, 0x7ff00008, 0x7ff00008
.long 0x7ff00008, 0x7ff00008, 0x7ff00008, 0x7ff00008, 0x7ff00008, 0x7ff00008, 0x7ff00008, 0x7ff00008
.long 0x7ff00008, 0x7ff00008, 0x7ff00008, 0x7ff00008, 0x7ff00008, 0x7ff00008, 0x7ff00008, 0x7ff00008
.long 0x7ff00008, 0x7ff00008, 0x7ff00008, 0x7ff00008, 0x7ff00008, 0x7ff00008, 0x7ff00008, 0x7ff00008
.long 0x7ff00008, 0x7ff00008, 0x7ff00008, 0x7ff00008, 0x7ff00008, 0x7ff00008, 0x7ff00008, 0x7ff00008
.long 0x7ff00008, 0x7ff00008, 0x7ff00008, 0x7ff00008, 0x7ff00008, 0x7ff00008, 0x7ff00008, 0x7ff00008
.long 0x6b806, 0x6b816, 0x6b826, 0x6b836, 0x6b846, 0x6b856, 0x6b866, 0x6b876
.long 0x6b886, 0x6b896, 0x6bd06, 0x6bd16, 0x6bd26, 0x6bd36, 0x6bd46, 0x6bd56
.long 0x6bd66, 0x6bd76, 0x6bd86, 0x6bd96, 0x6c206, 0x6c216, 0x6c226, 0x6c236
.long 0x6c246, 0x6c256, 0x6c266, 0x6c276, 0x6c286, 0x6c296, 0x6c706, 0x6c716
.long 0x6c726, 0x6c736, 0x6c746, 0x6c756, 0x6c766, 0x6c776, 0x6c786, 0x6c796
.long 0x6ea06, 0x6ea16, 0x6ea26, 0x6ea36, 0x6ea46, 0x6ea56, 0x6ea66, 0x6ea76
.long 0x6ea86, 0x6ea96, 0x6ef06, 0x6ef16, 0x6ef26, 0x6ef36, 0x6ef46, 0x6ef56
.long 0x6ef66, 0x6ef76, 0x6ef86, 0x6ef96, 0x6f406, 0x6f416, 0x6f426, 0x6f436
.long 0x6f446, 0x6f456, 0x6f466, 0x6f476, 0x6f486, 0x6f496, 0x6f906, 0x6f916
.long 0x6f926, 0x6f936, 0x6f946, 0x6f956, 0x6f966, 0x6f976, 0x6f986, 0x6f996
.long 0x6d606, 0x6d616, 0x6d626, 0x6d636, 0x6d646, 0x6d656, 0x6d666, 0x6d676
.long 0x6d686, 0x6d696, 0x6db06, 0x6db16, 0x6db26, 0x6db36, 0x6db46, 0x6db56
.long 0x6db66, 0x6db76, 0x6db86, 0x6db96, 0x6e006, 0x6e016, 0x6e026, 0x6e036
.long 0x6e046, 0x6e056, 0x6e066, 0x6e076, 0x6e086, 0x6e096, 0x6e506, 0x6e516
.long 0x6e526, 0x6e536, 0x6e546, 0x6e556, 0x6e566, 0x6e576, 0x6e586, 0x6e596
.long 0x0, 0x10, 0x20, 0x30, 0x40, 0x50, 0x60, 0x70
.long 0x80, 0x90, 0x500, 0x510, 0x520, 0x530, 0x540, 0x550
.long 0x560, 0x570, 0x580, 0x590, 0xa00, 0xa10, 0xa20, 0xa30
.long 0xa40, 0xa50, 0xa60, 0xa70, 0xa80, 0xa90, 0xf00, 0xf10
.long 0xf20, 0xf30, 0xf40, 0xf50, 0xf60, 0xf70, 0xf80, 0xf90
.long 0x1400, 0x1410, 0x1420, 0x1430, 0x1440, 0x1450, 0x1460, 0x1470
.long 0x1480, 0x1490, 0x1900, 0x1910, 0x1920, 0x1930, 0x1940, 0x1950
.long 0x1960, 0x1970, 0x1980, 0x1990, 0x1e00, 0x1e10, 0x1e20, 0x1e30
.long 0x1e40, 0x1e50, 0x1e60, 0x1e70, 0x1e80, 0x1e90, 0x2300, 0x2310
.long 0x2320, 0x2330, 0x2340, 0x2350, 0x2360, 0x2370, 0x2380, 0x2390
.long 0x7ff00008, 0x7ff00008, 0x7ff00008, 0x7ff00008, 0x7ff00008, 0x7ff00008, 0x7ff00008, 0x7ff00008
.long 0x7ff00008, 0x7ff00008, 0x7ff00008, 0x7ff00008, 0x7ff00008, 0x7ff00008, 0x7ff00008, 0x7ff00008
.long 0x7ff00008, 0x7ff00008, 0x7ff00008, 0x7ff00008, 0x7ff00008, 0x7ff00008, 0x7ff00008, 0x7ff00008
.long 0x7ff00008, 0x7ff00008, 0x7ff00008, 0x7ff00008, 0x7ff00008, 0x7ff00008, 0x7ff00008, 0x7ff00008
.long 0x7ff00008, 0x7ff00008, 0x7ff00008, 0x7ff00008, 0x7ff00008, 0x7ff00008, 0x7ff00008, 0x7ff00008
.long 0x7ff00008, 0x7ff00008, 0x7ff00008, 0x7ff00008, 0x7ff00008, 0x7ff00008, 0x7ff00008, 0x7ff00008
.long 0x7ff00008, 0x7ff00008, 0x7ff00008, 0x7ff00008, 0x7ff00008, 0x7ff00008, 0x7ff00008, 0x7ff00008
.long 0x4600, 0x4610, 0x4620, 0x4630, 0x4640, 0x4650, 0x4660, 0x4670
.long 0x4680, 0x4690, 0x4b00, 0x4b10, 0x4b20, 0x4b30, 0x4b40, 0x4b50
.long 0x4b60, 0x4b70, 0x4b80, 0x4b90, 0x5000, 0x5010, 0x5020, 0x5030
.long 0x5040, 0x5050, 0x5060, 0x5070, 0x5080, 0x5090, 0x5500, 0x5510
.long 0x5520, 0x5530, 0x5540, 0x5550, 0x5560, 0x5570, 0x5580, 0x5590
.long 0x3200, 0x3210, 0x3220, 0x3230, 0x3240, 0x3250, 0x3260, 0x3270
.long 0x3280, 0x3290, 0x3700, 0x3710, 0x3720, 0x3730, 0x3740, 0x3750
.long 0x3760, 0x3770, 0x3780, 0x3790, 0x3c00, 0x3c10, 0x3c20, 0x3c30
.long 0x3c40, 0x3c50, 0x3c60, 0x3c70, 0x3c80, 0x3c90, 0x4100, 0x4110
.long 0x4120, 0x4130, 0x4140, 0x4150, 0x4160, 0x4170, 0x4180, 0x4190
.long 0x6400, 0x6410, 0x6420, 0x6430, 0x6440, 0x6450, 0x6460, 0x6470
.long 0x6480, 0x6490, 0x6900, 0x6910, 0x6920, 0x6930, 0x6940, 0x6950
.long 0x6960, 0x6970, 0x6980, 0x6990, 0x6e00, 0x6e10, 0x6e20, 0x6e30
.long 0x6e40, 0x6e50, 0x6e60, 0x6e70, 0x6e80, 0x6e90, 0x7300, 0x7310
.long 0x7320, 0x7330, 0x7340, 0x7350, 0x7360, 0x7370, 0x7380, 0x7390
.long 0x7800, 0x7810, 0x7820, 0x7830, 0x7840, 0x7850, 0x7860, 0x7870
.long 0x7880, 0x7890, 0x7d00, 0x7d10, 0x7d20, 0x7d30, 0x7d40, 0x7d50
.long 0x7d60, 0x7d70, 0x7d80, 0x7d90, 0x8200, 0x8210, 0x8220, 0x8230
.long 0x8240, 0x8250, 0x8260, 0x8270, 0x8280, 0x8290, 0x8700, 0x8710
.long 0x8720, 0x8730, 0x8740, 0x8750, 0x8760, 0x8770, 0x8780, 0x8790
.long 0xaa00, 0xaa10, 0xaa20, 0xaa30, 0xaa40, 0xaa50, 0xaa60, 0xaa70
.long 0xaa80, 0xaa90, 0xaf00, 0xaf10, 0xaf20, 0xaf30, 0xaf40, 0xaf50
.long 0xaf60, 0xaf70, 0xaf80, 0xaf90, 0xb400, 0xb410, 0xb420, 0xb430
.long 0xb440, 0xb450, 0xb460, 0xb470, 0xb480, 0xb490, 0xb900, 0xb910
.long 0xb920, 0xb930, 0xb940, 0xb950, 0xb960, 0xb970, 0xb980, 0xb990
.long 0x7ff00008, 0x7ff00008, 0x7ff00008, 0x7ff00008, 0x7ff00008, 0x7ff00008, 0x7ff00008, 0x7ff00008
.long 0x7ff00008, 0x7ff00008, 0x7ff00008, 0x7ff00008, 0x7ff00008, 0x7ff00008, 0x7ff00008, 0x7ff00008
.long 0x7ff00008, 0x7ff00008, 0x7ff00008, 0x7ff00008, 0x7ff00008, 0x7ff00008, 0x7ff00008, 0x7ff00008
.long 0x7ff00008, 0x7ff00008, 0x7ff00008, 0x7ff00008, 0x7ff00008, 0x7ff00008, 0x7ff00008, 0x7ff00008
.long 0x7ff00008, 0x7ff00008, 0x7ff00008, 0x7ff00008, 0x7ff00008, 0x7ff00008, 0x7ff00008, 0x7ff00008
.long 0x7ff00008, 0x7ff00008, 0x7ff00008, 0x7ff00008, 0x7ff00008, 0x7ff00008, 0x7ff00008, 0x7ff00008
.long 0x7ff00008, 0x7ff00008, 0x7ff00008, 0x7ff00008, 0x7ff00008, 0x7ff00008, 0x7ff00008, 0x7ff00008
.long 0x9600, 0x9610, 0x9620, 0x9630, 0x9640, 0x9650, 0x9660, 0x9670
.long 0x9680, 0x9690, 0x9b00, 0x9b10, 0x9b20, 0x9b30, 0x9b40, 0x9b50
.long 0x9b60, 0x9b70, 0x9b80, 0x9b90, 0xa000, 0xa010, 0xa020, 0xa030
.long 0xa040, 0xa050, 0xa060, 0xa070, 0xa080, 0xa090, 0xa500, 0xa510
.long 0xa520, 0xa530, 0xa540, 0xa550, 0xa560, 0xa570, 0xa580, 0xa590
.long 0x1, 0x11, 0x21, 0x31, 0x41, 0x51, 0x61, 0x71
.long 0x81, 0x91, 0x501, 0x511, 0x521, 0x531, 0x541, 0x551
.long 0x561, 0x571, 0x581, 0x591, 0xa01, 0xa11, 0xa21, 0xa31
.long 0xa41, 0xa51, 0xa61, 0xa71, 0xa81, 0xa91, 0xf01, 0xf11
.long 0xf21, 0xf31, 0xf41, 0xf51, 0xf61, 0xf71, 0xf81, 0xf91
.long 0x1401, 0x1411, 0x1421, 0x1431, 0x1441, 0x1451, 0x1461, 0x1471
.long 0x1481, 0x1491, 0x1901, 0x1911, 0x1921, 0x1931, 0x1941, 0x1951
.long 0x1961, 0x1971, 0x1981, 0x1991, 0x1e01, 0x1e11, 0x1e21, 0x1e31
.long 0x1e41, 0x1e51, 0x1e61, 0x1e71, 0x1e81, 0x1e91, 0x2301, 0x2311
.long 0x2321, 0x2331, 0x2341, 0x2351, 0x2361, 0x2371, 0x2381, 0x2391
.long 0x4601, 0x4611, 0x4621, 0x4631, 0x4641, 0x4651, 0x4661, 0x4671
.long 0x4681, 0x4691, 0x4b01, 0x4b11, 0x4b21, 0x4b31, 0x4b41, 0x4b51
.long 0x4b61, 0x4b71, 0x4b81, 0x4b91, 0x5001, 0x5011, 0x5021, 0x5031
.long 0x5041, 0x5051, 0x5061, 0x5071, 0x5081, 0x5091, 0x5501, 0x5511
.long 0x5521, 0x5531, 0x5541, 0x5551, 0x5561, 0x5571, 0x5581, 0x5591
.long 0x3201, 0x3211, 0x3221, 0x3231, 0x3241, 0x3251, 0x3261, 0x3271
.long 0x3281, 0x3291, 0x3701, 0x3711, 0x3721, 0x3731, 0x3741, 0x3751
.long 0x3761, 0x3771, 0x3781, 0x3791, 0x3c01, 0x3c11, 0x3c21, 0x3c31
.long 0x3c41, 0x3c51, 0x3c61, 0x3c71, 0x3c81, 0x3c91, 0x4101, 0x4111
.long 0x4121, 0x4131, 0x4141, 0x4151, 0x4161, 0x4171, 0x4181, 0x4191
.long 0x7ff00008, 0x7ff00008, 0x7ff00008, 0x7ff00008, 0x7ff00008, 0x7ff00008, 0x7ff00008, 0x7ff00008
.long 0x7ff00008, 0x7ff00008, 0x7ff00008, 0x7ff00008, 0x7ff00008, 0x7ff00008, 0x7ff00008, 0x7ff00008
.long 0x7ff00008, 0x7ff00008, 0x7ff00008, 0x7ff00008, 0x7ff00008, 0x7ff00008, 0x7ff00008, 0x7ff00008
.long 0x7ff00008, 0x7ff00008, 0x7ff00008, 0x7ff00008, 0x7ff00008, 0x7ff00008, 0x7ff00008, 0x7ff00008
.long 0x7ff00008, 0x7ff00008, 0x7ff00008, 0x7ff00008, 0x7ff00008, 0x7ff00008, 0x7ff00008, 0x7ff00008
.long 0x7ff00008, 0x7ff00008, 0x7ff00008, 0x7ff00008, 0x7ff00008, 0x7ff00008, 0x7ff00008, 0x7ff00008
.long 0x7ff00008, 0x7ff00008, 0x7ff00008, 0x7ff00008, 0x7ff00008, 0x7ff00008, 0x7ff00008, 0x7ff00008
.long 0x6401, 0x6411, 0x6421, 0x6431, 0x6441, 0x6451, 0x6461, 0x6471
.long 0x6481, 0x6491, 0x6901, 0x6911, 0x6921, 0x6931, 0x6941, 0x6951
.long 0x6961, 0x6971, 0x6981, 0x6991, 0x6e01, 0x6e11, 0x6e21, 0x6e31
.long 0x6e41, 0x6e51, 0x6e61, 0x6e71, 0x6e81, 0x6e91, 0x7301, 0x7311
.long 0x7321, 0x7331, 0x7341, 0x7351, 0x7361, 0x7371, 0x7381, 0x7391
.long 0x7801, 0x7811, 0x7821, 0x7831, 0x7841, 0x7851, 0x7861, 0x7871
.long 0x7881, 0x7891, 0x7d01, 0x7d11, 0x7d21, 0x7d31, 0x7d41, 0x7d51
.long 0x7d61, 0x7d71, 0x7d81, 0x7d91, 0x8201, 0x8211, 0x8221, 0x8231
.long 0x8241, 0x8251, 0x8261, 0x8271, 0x8281, 0x8291, 0x8701, 0x8711
.long 0x8721, 0x8731, 0x8741, 0x8751, 0x8761, 0x8771, 0x8781, 0x8791
.long 0xaa01, 0xaa11, 0xaa21, 0xaa31, 0xaa41, 0xaa51, 0xaa61, 0xaa71
.long 0xaa81, 0xaa91, 0xaf01, 0xaf11, 0xaf21, 0xaf31, 0xaf41, 0xaf51
.long 0xaf61, 0xaf71, 0xaf81, 0xaf91, 0xb401, 0xb411, 0xb421, 0xb431
.long 0xb441, 0xb451, 0xb461, 0xb471, 0xb481, 0xb491, 0xb901, 0xb911
.long 0xb921, 0xb931, 0xb941, 0xb951, 0xb961, 0xb971, 0xb981, 0xb991
.long 0x9601, 0x9611, 0x9621, 0x9631, 0x9641, 0x9651, 0x9661, 0x9671
.long 0x9681, 0x9691, 0x9b01, 0x9b11, 0x9b21, 0x9b31, 0x9b41, 0x9b51
.long 0x9b61, 0x9b71, 0x9b81, 0x9b91, 0xa001, 0xa011, 0xa021, 0xa031
.long 0xa041, 0xa051, 0xa061, 0xa071, 0xa081, 0xa091, 0xa501, 0xa511
.long 0xa521, 0xa531, 0xa541, 0xa551, 0xa561, 0xa571, 0xa581, 0xa591
.long 0x2, 0x12, 0x22, 0x32, 0x42, 0x52, 0x62, 0x72
.long 0x82, 0x92, 0x502, 0x512, 0x522, 0x532, 0x542, 0x552
.long 0x562, 0x572, 0x582, 0x592, 0xa02, 0xa12, 0xa22, 0xa32
.long 0xa42, 0xa52, 0xa62, 0xa72, 0xa82, 0xa92, 0xf02, 0xf12
.long 0xf22, 0xf32, 0xf42, 0xf52, 0xf62, 0xf72, 0xf82, 0xf92
.long 0x7ff00008, 0x7ff00008, 0x7ff00008, 0x7ff00008, 0x7ff00008, 0x7ff00008, 0x7ff00008, 0x7ff00008
.long 0x7ff00008, 0x7ff00008, 0x7ff00008, 0x7ff00008, 0x7ff00008, 0x7ff00008, 0x7ff00008, 0x7ff00008
.long 0x7ff00008, 0x7ff00008, 0x7ff00008, 0x7ff00008, 0x7ff00008, 0x7ff00008, 0x7ff00008, 0x7ff00008
.long 0x7ff00008, 0x7ff00008, 0x7ff00008, 0x7ff00008, 0x7ff00008, 0x7ff00008, 0x7ff00008, 0x7ff00008
.long 0x7ff00008, 0x7ff00008, 0x7ff00008, 0x7ff00008, 0x7ff00008, 0x7ff00008, 0x7ff00008, 0x7ff00008
.long 0x7ff00008, 0x7ff00008, 0x7ff00008, 0x7ff00008, 0x7ff00008, 0x7ff00008, 0x7ff00008, 0x7ff00008
.long 0x7ff00008, 0x7ff00008, 0x7ff00008, 0x7ff00008, 0x7ff00008, 0x7ff00008, 0x7ff00008, 0x7ff00008
.long 0x1402, 0x1412, 0x1422, 0x1432, 0x1442, 0x1452, 0x1462, 0x1472
.long 0x1482, 0x1492, 0x1902, 0x1912, 0x1922, 0x1932, 0x1942, 0x1952
.long 0x1962, 0x1972, 0x1982, 0x1992, 0x1e02, 0x1e12, 0x1e22, 0x1e32
.long 0x1e42, 0x1e52, 0x1e62, 0x1e72, 0x1e82, 0x1e92, 0x2302, 0x2312
.long 0x2322, 0x2332, 0x2342, 0x2352, 0x2362, 0x2372, 0x2382, 0x2392
.long 0x4602, 0x4612, 0x4622, 0x4632, 0x4642, 0x4652, 0x4662, 0x4672
.long 0x4682, 0x4692, 0x4b02, 0x4b12, 0x4b22, 0x4b32, 0x4b42, 0x4b52
.long 0x4b62, 0x4b72, 0x4b82, 0x4b92, 0x5002, 0x5012, 0x5022, 0x5032
.long 0x5042, 0x5052, 0x5062, 0x5072, 0x5082, 0x5092, 0x5502, 0x5512
.long 0x5522, 0x5532, 0x5542, 0x5552, 0x5562, 0x5572, 0x5582, 0x5592
.long 0x3202, 0x3212, 0x3222, 0x3232, 0x3242, 0x3252, 0x3262, 0x3272
.long 0x3282, 0x3292, 0x3702, 0x3712, 0x3722, 0x3732, 0x3742, 0x3752
.long 0x3762, 0x3772, 0x3782, 0x3792, 0x3c02, 0x3c12, 0x3c22, 0x3c32
.long 0x3c42, 0x3c52, 0x3c62, 0x3c72, 0x3c82, 0x3c92, 0x4102, 0x4112
.long 0x4122, 0x4132, 0x4142, 0x4152, 0x4162, 0x4172, 0x4182, 0x4192
.long 0x6402, 0x6412, 0x6422, 0x6432, 0x6442, 0x6452, 0x6462, 0x6472
.long 0x6482, 0x6492, 0x6902, 0x6912, 0x6922, 0x6932, 0x6942, 0x6952
.long 0x6962, 0x6972, 0x6982, 0x6992, 0x6e02, 0x6e12, 0x6e22, 0x6e32
.long 0x6e42, 0x6e52, 0x6e62, 0x6e72, 0x6e82, 0x6e92, 0x7302, 0x7312
.long 0x7322, 0x7332, 0x7342, 0x7352, 0x7362, 0x7372, 0x7382, 0x7392
.long 0x7802, 0x7812, 0x7822, 0x7832, 0x7842, 0x7852, 0x7862, 0x7872
.long 0x7882, 0x7892, 0x7d02, 0x7d12, 0x7d22, 0x7d32, 0x7d42, 0x7d52
.long 0x7d62, 0x7d72, 0x7d82, 0x7d92, 0x8202, 0x8212, 0x8222, 0x8232
.long 0x8242, 0x8252, 0x8262, 0x8272, 0x8282, 0x8292, 0x8702, 0x8712
.long 0x8722, 0x8732, 0x8742, 0x8752, 0x8762, 0x8772, 0x8782, 0x8792
.long 0x7ff00008, 0x7ff00008, 0x7ff00008, 0x7ff00008, 0x7ff00008, 0x7ff00008, 0x7ff00008, 0x7ff00008
.long 0x7ff00008, 0x7ff00008, 0x7ff00008, 0x7ff00008, 0x7ff00008, 0x7ff00008, 0x7ff00008, 0x7ff00008
.long 0x7ff00008, 0x7ff00008, 0x7ff00008, 0x7ff00008, 0x7ff00008, 0x7ff00008, 0x7ff00008, 0x7ff00008
.long 0x7ff00008, 0x7ff00008, 0x7ff00008, 0x7ff00008, 0x7ff00008, 0x7ff00008, 0x7ff00008, 0x7ff00008
.long 0x7ff00008, 0x7ff00008, 0x7ff00008, 0x7ff00008, 0x7ff00008, 0x7ff00008, 0x7ff00008, 0x7ff00008
.long 0x7ff00008, 0x7ff00008, 0x7ff00008, 0x7ff00008, 0x7ff00008, 0x7ff00008, 0x7ff00008, 0x7ff00008
.long 0x7ff00008, 0x7ff00008, 0x7ff00008, 0x7ff00008, 0x7ff00008, 0x7ff00008, 0x7ff00008, 0x7ff00008
.long 0xaa02, 0xaa12, 0xaa22, 0xaa32, 0xaa42, 0xaa52, 0xaa62, 0xaa72
.long 0xaa82, 0xaa92, 0xaf02, 0xaf12, 0xaf22, 0xaf32, 0xaf42, 0xaf52
.long 0xaf62, 0xaf72, 0xaf82, 0xaf92, 0xb402, 0xb412, 0xb422, 0xb432
.long 0xb442, 0xb452, 0xb462, 0xb472, 0xb482, 0xb492, 0xb902, 0xb912
.long 0xb922, 0xb932, 0xb942, 0xb952, 0xb962, 0xb972, 0xb982, 0xb992
.long 0x9602, 0x9612, 0x9622, 0x9632, 0x9642, 0x9652, 0x9662, 0x9672
.long 0x9682, 0x9692, 0x9b02, 0x9b12, 0x9b22, 0x9b32, 0x9b42, 0x9b52
.long 0x9b62, 0x9b72, 0x9b82, 0x9b92, 0xa002, 0xa012, 0xa022, 0xa032
.long 0xa042, 0xa052, 0xa062, 0xa072, 0xa082, 0xa092, 0xa502, 0xa512
.long 0xa522, 0xa532, 0xa542, 0xa552, 0xa562, 0xa572, 0xa582, 0xa592
.long 0x3, 0x13, 0x23, 0x33, 0x43, 0x53, 0x63, 0x73
.long 0x83, 0x93, 0x503, 0x513, 0x523, 0x533, 0x543, 0x553
.long 0x563, 0x573, 0x583, 0x593, 0xa03, 0xa13, 0xa23, 0xa33
.long 0xa43, 0xa53, 0xa63, 0xa73, 0xa83, 0xa93, 0xf03, 0xf13
.long 0xf23, 0xf33, 0xf43, 0xf53, 0xf63, 0xf73, 0xf83, 0xf93
.long 0x1403, 0x1413, 0x1423, 0x1433, 0x1443, 0x1453, 0x1463, 0x1473
.long 0x1483, 0x1493, 0x1903, 0x1913, 0x1923, 0x1933, 0x1943, 0x1953
.long 0x1963, 0x1973, 0x1983, 0x1993, 0x1e03, 0x1e13, 0x1e23, 0x1e33
.long 0x1e43, 0x1e53, 0x1e63, 0x1e73, 0x1e83, 0x1e93, 0x2303, 0x2313
.long 0x2323, 0x2333, 0x2343, 0x2353, 0x2363, 0x2373, 0x2383, 0x2393
.long 0x4603, 0x4613, 0x4623, 0x4633, 0x4643, 0x4653, 0x4663, 0x4673
.long 0x4683, 0x4693, 0x4b03, 0x4b13, 0x4b23, 0x4b33, 0x4b43, 0x4b53
.long 0x4b63, 0x4b73, 0x4b83, 0x4b93, 0x5003, 0x5013, 0x5023, 0x5033
.long 0x5043, 0x5053, 0x5063, 0x5073, 0x5083, 0x5093, 0x5503, 0x5513
.long 0x5523, 0x5533, 0x5543, 0x5553, 0x5563, 0x5573, 0x5583, 0x5593
.long 0x7ff00008, 0x7ff00008, 0x7ff00008, 0x7ff00008, 0x7ff00008, 0x7ff00008, 0x7ff00008, 0x7ff00008
.long 0x7ff00008, 0x7ff00008, 0x7ff00008, 0x7ff00008, 0x7ff00008, 0x7ff00008, 0x7ff00008, 0x7ff00008
.long 0x7ff00008, 0x7ff00008, 0x7ff00008, 0x7ff00008, 0x7ff00008, 0x7ff00008, 0x7ff00008, 0x7ff00008
.long 0x7ff00008, 0x7ff00008, 0x7ff00008, 0x7ff00008, 0x7ff00008, 0x7ff00008, 0x7ff00008, 0x7ff00008
.long 0x7ff00008, 0x7ff00008, 0x7ff00008, 0x7ff00008, 0x7ff00008, 0x7ff00008, 0x7ff00008, 0x7ff00008
.long 0x7ff00008, 0x7ff00008, 0x7ff00008, 0x7ff00008, 0x7ff00008, 0x7ff00008, 0x7ff00008, 0x7ff00008
.long 0x7ff00008, 0x7ff00008, 0x7ff00008, 0x7ff00008, 0x7ff00008, 0x7ff00008, 0x7ff00008, 0x7ff00008
.long 0x3203, 0x3213, 0x3223, 0x3233, 0x3243, 0x3253, 0x3263, 0x3273
.long 0x3283, 0x3293, 0x3703, 0x3713, 0x3723, 0x3733, 0x3743, 0x3753
.long 0x3763, 0x3773, 0x3783, 0x3793, 0x3c03, 0x3c13, 0x3c23, 0x3c33
.long 0x3c43, 0x3c53, 0x3c63, 0x3c73, 0x3c83, 0x3c93, 0x4103, 0x4113
.long 0x4123, 0x4133, 0x4143, 0x4153, 0x4163, 0x4173, 0x4183, 0x4193
.long 0x6403, 0x6413, 0x6423, 0x6433, 0x6443, 0x6453, 0x6463, 0x6473
.long 0x6483, 0x6493, 0x6903, 0x6913, 0x6923, 0x6933, 0x6943, 0x6953
.long 0x6963, 0x6973, 0x6983, 0x6993, 0x6e03, 0x6e13, 0x6e23, 0x6e33
.long 0x6e43, 0x6e53, 0x6e63, 0x6e73, 0x6e83, 0x6e93, 0x7303, 0x7313
.long 0x7323, 0x7333, 0x7343, 0x7353, 0x7363, 0x7373, 0x7383, 0x7393
.long 0x7803, 0x7813, 0x7823, 0x7833, 0x7843, 0x7853, 0x7863, 0x7873
.long 0x7883, 0x7893, 0x7d03, 0x7d13, 0x7d23, 0x7d33, 0x7d43, 0x7d53
.long 0x7d63, 0x7d73, 0x7d83, 0x7d93, 0x8203, 0x8213, 0x8223, 0x8233
.long 0x8243, 0x8253, 0x8263, 0x8273, 0x8283, 0x8293, 0x8703, 0x8713
.long 0x8723, 0x8733, 0x8743, 0x8753, 0x8763, 0x8773, 0x8783, 0x8793
.long 0xaa03, 0xaa13, 0xaa23, 0xaa33, 0xaa43, 0xaa53, 0xaa63, 0xaa73
.long 0xaa83, 0xaa93, 0xaf03, 0xaf13, 0xaf23, 0xaf33, 0xaf43, 0xaf53
.long 0xaf63, 0xaf73, 0xaf83, 0xaf93, 0xb403, 0xb413, 0xb423, 0xb433
.long 0xb443, 0xb453, 0xb463, 0xb473, 0xb483, 0xb493, 0xb903, 0xb913
.long 0xb923, 0xb933, 0xb943, 0xb953, 0xb963, 0xb973, 0xb983, 0xb993
.long 0x9603, 0x9613, 0x9623, 0x9633, 0x9643, 0x9653, 0x9663, 0x9673
.long 0x9683, 0x9693, 0x9b03, 0x9b13, 0x9b23, 0x9b33, 0x9b43, 0x9b53
.long 0x9b63, 0x9b73, 0x9b83, 0x9b93, 0xa003, 0xa013, 0xa023, 0xa033
.long 0xa043, 0xa053, 0xa063, 0xa073, 0xa083, 0xa093, 0xa503, 0xa513
.long 0xa523, 0xa533, 0xa543, 0xa553, 0xa563, 0xa573, 0xa583, 0xa593
.long 0x7ff00008, 0x7ff00008, 0x7ff00008, 0x7ff00008, 0x7ff00008, 0x7ff00008, 0x7ff00008, 0x7ff00008
.long 0x7ff00008, 0x7ff00008, 0x7ff00008, 0x7ff00008, 0x7ff00008, 0x7ff00008, 0x7ff00008, 0x7ff00008
.long 0x7ff00008, 0x7ff00008, 0x7ff00008, 0x7ff00008, 0x7ff00008, 0x7ff00008, 0x7ff00008, 0x7ff00008
.long 0x7ff00008, 0x7ff00008, 0x7ff00008, 0x7ff00008, 0x7ff00008, 0x7ff00008, 0x7ff00008, 0x7ff00008
.long 0x7ff00008, 0x7ff00008, 0x7ff00008, 0x7ff00008, 0x7ff00008, 0x7ff00008, 0x7ff00008, 0x7ff00008
.long 0x7ff00008, 0x7ff00008, 0x7ff00008, 0x7ff00008, 0x7ff00008, 0x7ff00008, 0x7ff00008, 0x7ff00008
.long 0x7ff00008, 0x7ff00008, 0x7ff00008, 0x7ff00008, 0x7ff00008, 0x7ff00008, 0x7ff00008, 0x7ff00008
.long 0x64000, 0x64010, 0x64020, 0x64030, 0x64040, 0x64050, 0x64060, 0x64070
.long 0x64080, 0x64090, 0x64500, 0x64510, 0x64520, 0x64530, 0x64540, 0x64550
.long 0x64560, 0x64570, 0x64580, 0x64590, 0x64a00, 0x64a10, 0x64a20, 0x64a30
.long 0x64a40, 0x64a50, 0x64a60, 0x64a70, 0x64a80, 0x64a90, 0x64f00, 0x64f10
.long 0x64f20, 0x64f30, 0x64f40, 0x64f50, 0x64f60, 0x64f70, 0x64f80, 0x64f90
.long 0x65400, 0x65410, 0x65420, 0x65430, 0x65440, 0x65450, 0x65460, 0x65470
.long 0x65480, 0x65490, 0x65900, 0x65910, 0x65920, 0x65930, 0x65940, 0x65950
.long 0x65960, 0x65970, 0x65980, 0x65990, 0x65e00, 0x65e10, 0x65e20, 0x65e30
.long 0x65e40, 0x65e50, 0x65e60, 0x65e70, 0x65e80, 0x65e90, 0x66300, 0x66310
.long 0x66320, 0x66330, 0x66340, 0x66350, 0x66360, 0x66370, 0x66380, 0x66390
.long 0x68600, 0x68610, 0x68620, 0x68630, 0x68640, 0x68650, 0x68660, 0x68670
.long 0x68680, 0x68690, 0x68b00, 0x68b10, 0x68b20, 0x68b30, 0x68b40, 0x68b50
.long 0x68b60, 0x68b70, 0x68b80, 0x68b90, 0x69000, 0x69010, 0x69020, 0x69030
.long 0x69040, 0x69050, 0x69060, 0x69070, 0x69080, 0x69090, 0x69500, 0x69510
.long 0x69520, 0x69530, 0x69540, 0x69550, 0x69560, 0x69570, 0x69580, 0x69590
.long 0x67200, 0x67210, 0x67220, 0x67230, 0x67240, 0x67250, 0x67260, 0x67270
.long 0x67280, 0x67290, 0x67700, 0x67710, 0x67720, 0x67730, 0x67740, 0x67750
.long 0x67760, 0x67770, 0x67780, 0x67790, 0x67c00, 0x67c10, 0x67c20, 0x67c30
.long 0x67c40, 0x67c50, 0x67c60, 0x67c70, 0x67c80, 0x67c90, 0x68100, 0x68110
.long 0x68120, 0x68130, 0x68140, 0x68150, 0x68160, 0x68170, 0x68180, 0x68190
.long 0x6a400, 0x6a410, 0x6a420, 0x6a430, 0x6a440, 0x6a450, 0x6a460, 0x6a470
.long 0x6a480, 0x6a490, 0x6a900, 0x6a910, 0x6a920, 0x6a930, 0x6a940, 0x6a950
.long 0x6a960, 0x6a970, 0x6a980, 0x6a990, 0x6ae00, 0x6ae10, 0x6ae20, 0x6ae30
.long 0x6ae40, 0x6ae50, 0x6ae60, 0x6ae70, 0x6ae80, 0x6ae90, 0x6b300, 0x6b310
.long 0x6b320, 0x6b330, 0x6b340, 0x6b350, 0x6b360, 0x6b370, 0x6b380, 0x6b390
.long 0x7ff00008, 0x7ff00008, 0x7ff00008, 0x7ff00008, 0x7ff00008, 0x7ff00008, 0x7ff00008, 0x7ff00008
.long 0x7ff00008, 0x7ff00008, 0x7ff00008, 0x7ff00008, 0x7ff00008, 0x7ff00008, 0x7ff00008, 0x7ff00008
.long 0x7ff00008, 0x7ff00008, 0x7ff00008, 0x7ff00008, 0x7ff00008, 0x7ff00008, 0x7ff00008, 0x7ff00008
.long 0x7ff00008, 0x7ff00008, 0x7ff00008, 0x7ff00008, 0x7ff00008, 0x7ff00008, 0x7ff00008, 0x7ff00008
.long 0x7ff00008, 0x7ff00008, 0x7ff00008, 0x7ff00008, 0x7ff00008, 0x7ff00008, 0x7ff00008, 0x7ff00008
.long 0x7ff00008, 0x7ff00008, 0x7ff00008, 0x7ff00008, 0x7ff00008, 0x7ff00008, 0x7ff00008, 0x7ff00008
.long 0x7ff00008, 0x7ff00008, 0x7ff00008, 0x7ff00008, 0x7ff00008, 0x7ff00008, 0x7ff00008, 0x7ff00008
.long 0x6b800, 0x6b810, 0x6b820, 0x6b830, 0x6b840, 0x6b850, 0x6b860, 0x6b870
.long 0x6b880, 0x6b890, 0x6bd00, 0x6bd10, 0x6bd20, 0x6bd30, 0x6bd40, 0x6bd50
.long 0x6bd60, 0x6bd70, 0x6bd80, 0x6bd90, 0x6c200, 0x6c210, 0x6c220, 0x6c230
.long 0x6c240, 0x6c250, 0x6c260, 0x6c270, 0x6c280, 0x6c290, 0x6c700, 0x6c710
.long 0x6c720, 0x6c730, 0x6c740, 0x6c750, 0x6c760, 0x6c770, 0x6c780, 0x6c790
.long 0x6ea00, 0x6ea10, 0x6ea20, 0x6ea30, 0x6ea40, 0x6ea50, 0x6ea60, 0x6ea70
.long 0x6ea80, 0x6ea90, 0x6ef00, 0x6ef10, 0x6ef20, 0x6ef30, 0x6ef40, 0x6ef50
.long 0x6ef60, 0x6ef70, 0x6ef80, 0x6ef90, 0x6f400, 0x6f410, 0x6f420, 0x6f430
.long 0x6f440, 0x6f450, 0x6f460, 0x6f470, 0x6f480, 0x6f490, 0x6f900, 0x6f910
.long 0x6f920, 0x6f930, 0x6f940, 0x6f950, 0x6f960, 0x6f970, 0x6f980, 0x6f990
.long 0x6d600, 0x6d610, 0x6d620, 0x6d630, 0x6d640, 0x6d650, 0x6d660, 0x6d670
.long 0x6d680, 0x6d690, 0x6db00, 0x6db10, 0x6db20, 0x6db30, 0x6db40, 0x6db50
.long 0x6db60, 0x6db70, 0x6db80, 0x6db90, 0x6e000, 0x6e010, 0x6e020, 0x6e030
.long 0x6e040, 0x6e050, 0x6e060, 0x6e070, 0x6e080, 0x6e090, 0x6e500, 0x6e510
.long 0x6e520, 0x6e530, 0x6e540, 0x6e550, 0x6e560, 0x6e570, 0x6e580, 0x6e590
.long 0x64001, 0x64011, 0x64021, 0x64031, 0x64041, 0x64051, 0x64061, 0x64071
.long 0x64081, 0x64091, 0x64501, 0x64511, 0x64521, 0x64531, 0x64541, 0x64551
.long 0x64561, 0x64571, 0x64581, 0x64591, 0x64a01, 0x64a11, 0x64a21, 0x64a31
.long 0x64a41, 0x64a51, 0x64a61, 0x64a71, 0x64a81, 0x64a91, 0x64f01, 0x64f11
.long 0x64f21, 0x64f31, 0x64f41, 0x64f51, 0x64f61, 0x64f71, 0x64f81, 0x64f91
.long 0x65401, 0x65411, 0x65421, 0x65431, 0x65441, 0x65451, 0x65461, 0x65471
.long 0x65481, 0x65491, 0x65901, 0x65911, 0x65921, 0x65931, 0x65941, 0x65951
.long 0x65961, 0x65971, 0x65981, 0x65991, 0x65e01, 0x65e11, 0x65e21, 0x65e31
.long 0x65e41, 0x65e51, 0x65e61, 0x65e71, 0x65e81, 0x65e91, 0x66301, 0x66311
.long 0x66321, 0x66331, 0x66341, 0x66351, 0x66361, 0x66371, 0x66381, 0x66391
.long 0x7ff00008, 0x7ff00008, 0x7ff00008, 0x7ff00008, 0x7ff00008, 0x7ff00008, 0x7ff00008, 0x7ff00008
.long 0x7ff00008, 0x7ff00008, 0x7ff00008, 0x7ff00008, 0x7ff00008, 0x7ff00008, 0x7ff00008, 0x7ff00008
.long 0x7ff00008, 0x7ff00008, 0x7ff00008, 0x7ff00008, 0x7ff00008, 0x7ff00008, 0x7ff00008, 0x7ff00008
.long 0x7ff00008, 0x7ff00008, 0x7ff00008, 0x7ff00008, 0x7ff00008, 0x7ff00008, 0x7ff00008, 0x7ff00008
.long 0x7ff00008, 0x7ff00008, 0x7ff00008, 0x7ff00008, 0x7ff00008, 0x7ff00008, 0x7ff00008, 0x7ff00008
.long 0x7ff00008, 0x7ff00008, 0x7ff00008, 0x7ff00008, 0x7ff00008, 0x7ff00008, 0x7ff00008, 0x7ff00008
.long 0x7ff00008, 0x7ff00008, 0x7ff00008, 0x7ff00008, 0x7ff00008, 0x7ff00008, 0x7ff00008, 0x7ff00008
.long 0x68601, 0x68611, 0x68621, 0x68631, 0x68641, 0x68651, 0x68661, 0x68671
.long 0x68681, 0x68691, 0x68b01, 0x68b11, 0x68b21, 0x68b31, 0x68b41, 0x68b51
.long 0x68b61, 0x68b71, 0x68b81, 0x68b91, 0x69001, 0x69011, 0x69021, 0x69031
.long 0x69041, 0x69051, 0x69061, 0x69071, 0x69081, 0x69091, 0x69501, 0x69511
.long 0x69521, 0x69531, 0x69541, 0x69551, 0x69561, 0x69571, 0x69581, 0x69591
.long 0x67201, 0x67211, 0x67221, 0x67231, 0x67241, 0x67251, 0x67261, 0x67271
.long 0x67281, 0x67291, 0x67701, 0x67711, 0x67721, 0x67731, 0x67741, 0x67751
.long 0x67761, 0x67771, 0x67781, 0x67791, 0x67c01, 0x67c11, 0x67c21, 0x67c31
.long 0x67c41, 0x67c51, 0x67c61, 0x67c71, 0x67c81, 0x67c91, 0x68101, 0x68111
.long 0x68121, 0x68131, 0x68141, 0x68151, 0x68161, 0x68171, 0x68181, 0x68191
.long 0x6a401, 0x6a411, 0x6a421, 0x6a431, 0x6a441, 0x6a451, 0x6a461, 0x6a471
.long 0x6a481, 0x6a491, 0x6a901, 0x6a911, 0x6a921, 0x6a931, 0x6a941, 0x6a951
.long 0x6a961, 0x6a971, 0x6a981, 0x6a991, 0x6ae01, 0x6ae11, 0x6ae21, 0x6ae31
.long 0x6ae41, 0x6ae51, 0x6ae61, 0x6ae71, 0x6ae81, 0x6ae91, 0x6b301, 0x6b311
.long 0x6b321, 0x6b331, 0x6b341, 0x6b351, 0x6b361, 0x6b371, 0x6b381, 0x6b391
.long 0x6b801, 0x6b811, 0x6b821, 0x6b831, 0x6b841, 0x6b851, 0x6b861, 0x6b871
.long 0x6b881, 0x6b891, 0x6bd01, 0x6bd11, 0x6bd21, 0x6bd31, 0x6bd41, 0x6bd51
.long 0x6bd61, 0x6bd71, 0x6bd81, 0x6bd91, 0x6c201, 0x6c211, 0x6c221, 0x6c231
.long 0x6c241, 0x6c251, 0x6c261, 0x6c271, 0x6c281, 0x6c291, 0x6c701, 0x6c711
.long 0x6c721, 0x6c731, 0x6c741, 0x6c751, 0x6c761, 0x6c771, 0x6c781, 0x6c791
.long 0x6ea01, 0x6ea11, 0x6ea21, 0x6ea31, 0x6ea41, 0x6ea51, 0x6ea61, 0x6ea71
.long 0x6ea81, 0x6ea91, 0x6ef01, 0x6ef11, 0x6ef21, 0x6ef31, 0x6ef41, 0x6ef51
.long 0x6ef61, 0x6ef71, 0x6ef81, 0x6ef91, 0x6f401, 0x6f411, 0x6f421, 0x6f431
.long 0x6f441, 0x6f451, 0x6f461, 0x6f471, 0x6f481, 0x6f491, 0x6f901, 0x6f911
.long 0x6f921, 0x6f931, 0x6f941, 0x6f951, 0x6f961, 0x6f971, 0x6f981, 0x6f991
.long 0x7ff00008, 0x7ff00008, 0x7ff00008, 0x7ff00008, 0x7ff00008, 0x7ff00008, 0x7ff00008, 0x7ff00008
.long 0x7ff00008, 0x7ff00008, 0x7ff00008, 0x7ff00008, 0x7ff00008, 0x7ff00008, 0x7ff00008, 0x7ff00008
.long 0x7ff00008, 0x7ff00008, 0x7ff00008, 0x7ff00008, 0x7ff00008, 0x7ff00008, 0x7ff00008, 0x7ff00008
.long 0x7ff00008, 0x7ff00008, 0x7ff00008, 0x7ff00008, 0x7ff00008, 0x7ff00008, 0x7ff00008, 0x7ff00008
.long 0x7ff00008, 0x7ff00008, 0x7ff00008, 0x7ff00008, 0x7ff00008, 0x7ff00008, 0x7ff00008, 0x7ff00008
.long 0x7ff00008, 0x7ff00008, 0x7ff00008, 0x7ff00008, 0x7ff00008, 0x7ff00008, 0x7ff00008, 0x7ff00008
.long 0x7ff00008, 0x7ff00008, 0x7ff00008, 0x7ff00008, 0x7ff00008, 0x7ff00008, 0x7ff00008, 0x7ff00008
.long 0x6d601, 0x6d611, 0x6d621, 0x6d631, 0x6d641, 0x6d651, 0x6d661, 0x6d671
.long 0x6d681, 0x6d691, 0x6db01, 0x6db11, 0x6db21, 0x6db31, 0x6db41, 0x6db51
.long 0x6db61, 0x6db71, 0x6db81, 0x6db91, 0x6e001, 0x6e011, 0x6e021, 0x6e031
.long 0x6e041, 0x6e051, 0x6e061, 0x6e071, 0x6e081, 0x6e091, 0x6e501, 0x6e511
.long 0x6e521, 0x6e531, 0x6e541, 0x6e551, 0x6e561, 0x6e571, 0x6e581, 0x6e591
.long 0x64002, 0x64012, 0x64022, 0x64032, 0x64042, 0x64052, 0x64062, 0x64072
.long 0x64082, 0x64092, 0x64502, 0x64512, 0x64522, 0x64532, 0x64542, 0x64552
.long 0x64562, 0x64572, 0x64582, 0x64592, 0x64a02, 0x64a12, 0x64a22, 0x64a32
.long 0x64a42, 0x64a52, 0x64a62, 0x64a72, 0x64a82, 0x64a92, 0x64f02, 0x64f12
.long 0x64f22, 0x64f32, 0x64f42, 0x64f52, 0x64f62, 0x64f72, 0x64f82, 0x64f92
.long 0x65402, 0x65412, 0x65422, 0x65432, 0x65442, 0x65452, 0x65462, 0x65472
.long 0x65482, 0x65492, 0x65902, 0x65912, 0x65922, 0x65932, 0x65942, 0x65952
.long 0x65962, 0x65972, 0x65982, 0x65992, 0x65e02, 0x65e12, 0x65e22, 0x65e32
.long 0x65e42, 0x65e52, 0x65e62, 0x65e72, 0x65e82, 0x65e92, 0x66302, 0x66312
.long 0x66322, 0x66332, 0x66342, 0x66352, 0x66362, 0x66372, 0x66382, 0x66392
.long 0x68602, 0x68612, 0x68622, 0x68632, 0x68642, 0x68652, 0x68662, 0x68672
.long 0x68682, 0x68692, 0x68b02, 0x68b12, 0x68b22, 0x68b32, 0x68b42, 0x68b52
.long 0x68b62, 0x68b72, 0x68b82, 0x68b92, 0x69002, 0x69012, 0x69022, 0x69032
.long 0x69042, 0x69052, 0x69062, 0x69072, 0x69082, 0x69092, 0x69502, 0x69512
.long 0x69522, 0x69532, 0x69542, 0x69552, 0x69562, 0x69572, 0x69582, 0x69592
.long 0x67202, 0x67212, 0x67222, 0x67232, 0x67242, 0x67252, 0x67262, 0x67272
.long 0x67282, 0x67292, 0x67702, 0x67712, 0x67722, 0x67732, 0x67742, 0x67752
.long 0x67762, 0x67772, 0x67782, 0x67792, 0x67c02, 0x67c12, 0x67c22, 0x67c32
.long 0x67c42, 0x67c52, 0x67c62, 0x67c72, 0x67c82, 0x67c92, 0x68102, 0x68112
.long 0x68122, 0x68132, 0x68142, 0x68152, 0x68162, 0x68172, 0x68182, 0x68192
.long 0x7ff00008, 0x7ff00008, 0x7ff00008, 0x7ff00008, 0x7ff00008, 0x7ff00008, 0x7ff00008, 0x7ff00008
.long 0x7ff00008, 0x7ff00008, 0x7ff00008, 0x7ff00008, 0x7ff00008, 0x7ff00008, 0x7ff00008, 0x7ff00008
.long 0x7ff00008, 0x7ff00008, 0x7ff00008, 0x7ff00008, 0x7ff00008, 0x7ff00008, 0x7ff00008, 0x7ff00008
.long 0x7ff00008, 0x7ff00008, 0x7ff00008, 0x7ff00008, 0x7ff00008, 0x7ff00008, 0x7ff00008, 0x7ff00008
.long 0x7ff00008, 0x7ff00008, 0x7ff00008, 0x7ff00008, 0x7ff00008, 0x7ff00008, 0x7ff00008, 0x7ff00008
.long 0x7ff00008, 0x7ff00008, 0x7ff00008, 0x7ff00008, 0x7ff00008, 0x7ff00008, 0x7ff00008, 0x7ff00008
.long 0x7ff00008, 0x7ff00008, 0x7ff00008, 0x7ff00008, 0x7ff00008, 0x7ff00008, 0x7ff00008, 0x7ff00008
.long 0x6a402, 0x6a412, 0x6a422, 0x6a432, 0x6a442, 0x6a452, 0x6a462, 0x6a472
.long 0x6a482, 0x6a492, 0x6a902, 0x6a912, 0x6a922, 0x6a932, 0x6a942, 0x6a952
.long 0x6a962, 0x6a972, 0x6a982, 0x6a992, 0x6ae02, 0x6ae12, 0x6ae22, 0x6ae32
.long 0x6ae42, 0x6ae52, 0x6ae62, 0x6ae72, 0x6ae82, 0x6ae92, 0x6b302, 0x6b312
.long 0x6b322, 0x6b332, 0x6b342, 0x6b352, 0x6b362, 0x6b372, 0x6b382, 0x6b392
.long 0x6b802, 0x6b812, 0x6b822, 0x6b832, 0x6b842, 0x6b852, 0x6b862, 0x6b872
.long 0x6b882, 0x6b892, 0x6bd02, 0x6bd12, 0x6bd22, 0x6bd32, 0x6bd42, 0x6bd52
.long 0x6bd62, 0x6bd72, 0x6bd82, 0x6bd92, 0x6c202, 0x6c212, 0x6c222, 0x6c232
.long 0x6c242, 0x6c252, 0x6c262, 0x6c272, 0x6c282, 0x6c292, 0x6c702, 0x6c712
.long 0x6c722, 0x6c732, 0x6c742, 0x6c752, 0x6c762, 0x6c772, 0x6c782, 0x6c792
.long 0x6ea02, 0x6ea12, 0x6ea22, 0x6ea32, 0x6ea42, 0x6ea52, 0x6ea62, 0x6ea72
.long 0x6ea82, 0x6ea92, 0x6ef02, 0x6ef12, 0x6ef22, 0x6ef32, 0x6ef42, 0x6ef52
.long 0x6ef62, 0x6ef72, 0x6ef82, 0x6ef92, 0x6f402, 0x6f412, 0x6f422, 0x6f432
.long 0x6f442, 0x6f452, 0x6f462, 0x6f472, 0x6f482, 0x6f492, 0x6f902, 0x6f912
.long 0x6f922, 0x6f932, 0x6f942, 0x6f952, 0x6f962, 0x6f972, 0x6f982, 0x6f992
.long 0x6d602, 0x6d612, 0x6d622, 0x6d632, 0x6d642, 0x6d652, 0x6d662, 0x6d672
.long 0x6d682, 0x6d692, 0x6db02, 0x6db12, 0x6db22, 0x6db32, 0x6db42, 0x6db52
.long 0x6db62, 0x6db72, 0x6db82, 0x6db92, 0x6e002, 0x6e012, 0x6e022, 0x6e032
.long 0x6e042, 0x6e052, 0x6e062, 0x6e072, 0x6e082, 0x6e092, 0x6e502, 0x6e512
.long 0x6e522, 0x6e532, 0x6e542, 0x6e552, 0x6e562, 0x6e572, 0x6e582, 0x6e592
.long 0x64003, 0x64013, 0x64023, 0x64033, 0x64043, 0x64053, 0x64063, 0x64073
.long 0x64083, 0x64093, 0x64503, 0x64513, 0x64523, 0x64533, 0x64543, 0x64553
.long 0x64563, 0x64573, 0x64583, 0x64593, 0x64a03, 0x64a13, 0x64a23, 0x64a33
.long 0x64a43, 0x64a53, 0x64a63, 0x64a73, 0x64a83, 0x64a93, 0x64f03, 0x64f13
.long 0x64f23, 0x64f33, 0x64f43, 0x64f53, 0x64f63, 0x64f73, 0x64f83, 0x64f93
.long 0x7ff00008, 0x7ff00008, 0x7ff00008, 0x7ff00008, 0x7ff00008, 0x7ff00008, 0x7ff00008, 0x7ff00008
.long 0x7ff00008, 0x7ff00008, 0x7ff00008, 0x7ff00008, 0x7ff00008, 0x7ff00008, 0x7ff00008, 0x7ff00008
.long 0x7ff00008, 0x7ff00008, 0x7ff00008, 0x7ff00008, 0x7ff00008, 0x7ff00008, 0x7ff00008, 0x7ff00008
.long 0x7ff00008, 0x7ff00008, 0x7ff00008, 0x7ff00008, 0x7ff00008, 0x7ff00008, 0x7ff00008, 0x7ff00008
.long 0x7ff00008, 0x7ff00008, 0x7ff00008, 0x7ff00008, 0x7ff00008, 0x7ff00008, 0x7ff00008, 0x7ff00008
.long 0x7ff00008, 0x7ff00008, 0x7ff00008, 0x7ff00008, 0x7ff00008, 0x7ff00008, 0x7ff00008, 0x7ff00008
.long 0x7ff00008, 0x7ff00008, 0x7ff00008, 0x7ff00008, 0x7ff00008, 0x7ff00008, 0x7ff00008, 0x7ff00008
.long 0x65403, 0x65413, 0x65423, 0x65433, 0x65443, 0x65453, 0x65463, 0x65473
.long 0x65483, 0x65493, 0x65903, 0x65913, 0x65923, 0x65933, 0x65943, 0x65953
.long 0x65963, 0x65973, 0x65983, 0x65993, 0x65e03, 0x65e13, 0x65e23, 0x65e33
.long 0x65e43, 0x65e53, 0x65e63, 0x65e73, 0x65e83, 0x65e93, 0x66303, 0x66313
.long 0x66323, 0x66333, 0x66343, 0x66353, 0x66363, 0x66373, 0x66383, 0x66393
.long 0x68603, 0x68613, 0x68623, 0x68633, 0x68643, 0x68653, 0x68663, 0x68673
.long 0x68683, 0x68693, 0x68b03, 0x68b13, 0x68b23, 0x68b33, 0x68b43, 0x68b53
.long 0x68b63, 0x68b73, 0x68b83, 0x68b93, 0x69003, 0x69013, 0x69023, 0x69033
.long 0x69043, 0x69053, 0x69063, 0x69073, 0x69083, 0x69093, 0x69503, 0x69513
.long 0x69523, 0x69533, 0x69543, 0x69553, 0x69563, 0x69573, 0x69583, 0x69593
.long 0x67203, 0x67213, 0x67223, 0x67233, 0x67243, 0x67253, 0x67263, 0x67273
.long 0x67283, 0x67293, 0x67703, 0x67713, 0x67723, 0x67733, 0x67743, 0x67753
.long 0x67763, 0x67773, 0x67783, 0x67793, 0x67c03, 0x67c13, 0x67c23, 0x67c33
.long 0x67c43, 0x67c53, 0x67c63, 0x67c73, 0x67c83, 0x67c93, 0x68103, 0x68113
.long 0x68123, 0x68133, 0x68143, 0x68153, 0x68163, 0x68173, 0x68183, 0x68193
.long 0x6a403, 0x6a413, 0x6a423, 0x6a433, 0x6a443, 0x6a453, 0x6a463, 0x6a473
.long 0x6a483, 0x6a493, 0x6a903, 0x6a913, 0x6a923, 0x6a933, 0x6a943, 0x6a953
.long 0x6a963, 0x6a973, 0x6a983, 0x6a993, 0x6ae03, 0x6ae13, 0x6ae23, 0x6ae33
.long 0x6ae43, 0x6ae53, 0x6ae63, 0x6ae73, 0x6ae83, 0x6ae93, 0x6b303, 0x6b313
.long 0x6b323, 0x6b333, 0x6b343, 0x6b353, 0x6b363, 0x6b373, 0x6b383, 0x6b393
.long 0x6b803, 0x6b813, 0x6b823, 0x6b833, 0x6b843, 0x6b853, 0x6b863, 0x6b873
.long 0x6b883, 0x6b893, 0x6bd03, 0x6bd13, 0x6bd23, 0x6bd33, 0x6bd43, 0x6bd53
.long 0x6bd63, 0x6bd73, 0x6bd83, 0x6bd93, 0x6c203, 0x6c213, 0x6c223, 0x6c233
.long 0x6c243, 0x6c253, 0x6c263, 0x6c273, 0x6c283, 0x6c293, 0x6c703, 0x6c713
.long 0x6c723, 0x6c733, 0x6c743, 0x6c753, 0x6c763, 0x6c773, 0x6c783, 0x6c793
.long 0x7ff00008, 0x7ff00008, 0x7ff00008, 0x7ff00008, 0x7ff00008, 0x7ff00008, 0x7ff00008, 0x7ff00008
.long 0x7ff00008, 0x7ff00008, 0x7ff00008, 0x7ff00008, 0x7ff00008, 0x7ff00008, 0x7ff00008, 0x7ff00008
.long 0x7ff00008, 0x7ff00008, 0x7ff00008, 0x7ff00008, 0x7ff00008, 0x7ff00008, 0x7ff00008, 0x7ff00008
.long 0x7ff00008, 0x7ff00008, 0x7ff00008, 0x7ff00008, 0x7ff00008, 0x7ff00008, 0x7ff00008, 0x7ff00008
.long 0x7ff00008, 0x7ff00008, 0x7ff00008, 0x7ff00008, 0x7ff00008, 0x7ff00008, 0x7ff00008, 0x7ff00008
.long 0x7ff00008, 0x7ff00008, 0x7ff00008, 0x7ff00008, 0x7ff00008, 0x7ff00008, 0x7ff00008, 0x7ff00008
.long 0x7ff00008, 0x7ff00008, 0x7ff00008, 0x7ff00008, 0x7ff00008, 0x7ff00008, 0x7ff00008, 0x7ff00008
.long 0x6ea03, 0x6ea13, 0x6ea23, 0x6ea33, 0x6ea43, 0x6ea53, 0x6ea63, 0x6ea73
.long 0x6ea83, 0x6ea93, 0x6ef03, 0x6ef13, 0x6ef23, 0x6ef33, 0x6ef43, 0x6ef53
.long 0x6ef63, 0x6ef73, 0x6ef83, 0x6ef93, 0x6f403, 0x6f413, 0x6f423, 0x6f433
.long 0x6f443, 0x6f453, 0x6f463, 0x6f473, 0x6f483, 0x6f493, 0x6f903, 0x6f913
.long 0x6f923, 0x6f933, 0x6f943, 0x6f953, 0x6f963, 0x6f973, 0x6f983, 0x6f993
.long 0x6d603, 0x6d613, 0x6d623, 0x6d633, 0x6d643, 0x6d653, 0x6d663, 0x6d673
.long 0x6d683, 0x6d693, 0x6db03, 0x6db13, 0x6db23, 0x6db33, 0x6db43, 0x6db53
.long 0x6db63, 0x6db73, 0x6db83, 0x6db93, 0x6e003, 0x6e013, 0x6e023, 0x6e033
.long 0x6e043, 0x6e053, 0x6e063, 0x6e073, 0x6e083, 0x6e093, 0x6e503, 0x6e513
.long 0x6e523, 0x6e533, 0x6e543, 0x6e553, 0x6e563, 0x6e573, 0x6e583, 0x6e593
.long 0x7, 0x17, 0x27, 0x37, 0x47, 0x57, 0x67, 0x77
.long 0x87, 0x97, 0x507, 0x517, 0x527, 0x537, 0x547, 0x557
.long 0x567, 0x577, 0x587, 0x597, 0xa07, 0xa17, 0xa27, 0xa37
.long 0xa47, 0xa57, 0xa67, 0xa77, 0xa87, 0xa97, 0xf07, 0xf17
.long 0xf27, 0xf37, 0xf47, 0xf57, 0xf67, 0xf77, 0xf87, 0xf97
.long 0x1407, 0x1417, 0x1427, 0x1437, 0x1447, 0x1457, 0x1467, 0x1477
.long 0x1487, 0x1497, 0x1907, 0x1917, 0x1927, 0x1937, 0x1947, 0x1957
.long 0x1967, 0x1977, 0x1987, 0x1997, 0x1e07, 0x1e17, 0x1e27, 0x1e37
.long 0x1e47, 0x1e57, 0x1e67, 0x1e77, 0x1e87, 0x1e97, 0x2307, 0x2317
.long 0x2327, 0x2337, 0x2347, 0x2357, 0x2367, 0x2377, 0x2387, 0x2397
.long 0x4607, 0x4617, 0x4627, 0x4637, 0x4647, 0x4657, 0x4667, 0x4677
.long 0x4687, 0x4697, 0x4b07, 0x4b17, 0x4b27, 0x4b37, 0x4b47, 0x4b57
.long 0x4b67, 0x4b77, 0x4b87, 0x4b97, 0x5007, 0x5017, 0x5027, 0x5037
.long 0x5047, 0x5057, 0x5067, 0x5077, 0x5087, 0x5097, 0x5507, 0x5517
.long 0x5527, 0x5537, 0x5547, 0x5557, 0x5567, 0x5577, 0x5587, 0x5597
.long 0x7ff00008, 0x7ff00008, 0x7ff00008, 0x7ff00008, 0x7ff00008, 0x7ff00008, 0x7ff00008, 0x7ff00008
.long 0x7ff00008, 0x7ff00008, 0x7ff00008, 0x7ff00008, 0x7ff00008, 0x7ff00008, 0x7ff00008, 0x7ff00008
.long 0x7ff00008, 0x7ff00008, 0x7ff00008, 0x7ff00008, 0x7ff00008, 0x7ff00008, 0x7ff00008, 0x7ff00008
.long 0x7ff00008, 0x7ff00008, 0x7ff00008, 0x7ff00008, 0x7ff00008, 0x7ff00008, 0x7ff00008, 0x7ff00008
.long 0x7ff00008, 0x7ff00008, 0x7ff00008, 0x7ff00008, 0x7ff00008, 0x7ff00008, 0x7ff00008, 0x7ff00008
.long 0x7ff00008, 0x7ff00008, 0x7ff00008, 0x7ff00008, 0x7ff00008, 0x7ff00008, 0x7ff00008, 0x7ff00008
.long 0x7ff00008, 0x7ff00008, 0x7ff00008, 0x7ff00008, 0x7ff00008, 0x7ff00008, 0x7ff00008, 0x7ff00008
.long 0x3207, 0x3217, 0x3227, 0x3237, 0x3247, 0x3257, 0x3267, 0x3277
.long 0x3287, 0x3297, 0x3707, 0x3717, 0x3727, 0x3737, 0x3747, 0x3757
.long 0x3767, 0x3777, 0x3787, 0x3797, 0x3c07, 0x3c17, 0x3c27, 0x3c37
.long 0x3c47, 0x3c57, 0x3c67, 0x3c77, 0x3c87, 0x3c97, 0x4107, 0x4117
.long 0x4127, 0x4137, 0x4147, 0x4157, 0x4167, 0x4177, 0x4187, 0x4197
.long 0x6407, 0x6417, 0x6427, 0x6437, 0x6447, 0x6457, 0x6467, 0x6477
.long 0x6487, 0x6497, 0x6907, 0x6917, 0x6927, 0x6937, 0x6947, 0x6957
.long 0x6967, 0x6977, 0x6987, 0x6997, 0x6e07, 0x6e17, 0x6e27, 0x6e37
.long 0x6e47, 0x6e57, 0x6e67, 0x6e77, 0x6e87, 0x6e97, 0x7307, 0x7317
.long 0x7327, 0x7337, 0x7347, 0x7357, 0x7367, 0x7377, 0x7387, 0x7397
.long 0x7807, 0x7817, 0x7827, 0x7837, 0x7847, 0x7857, 0x7867, 0x7877
.long 0x7887, 0x7897, 0x7d07, 0x7d17, 0x7d27, 0x7d37, 0x7d47, 0x7d57
.long 0x7d67, 0x7d77, 0x7d87, 0x7d97, 0x8207, 0x8217, 0x8227, 0x8237
.long 0x8247, 0x8257, 0x8267, 0x8277, 0x8287, 0x8297, 0x8707, 0x8717
.long 0x8727, 0x8737, 0x8747, 0x8757, 0x8767, 0x8777, 0x8787, 0x8797
.long 0xaa07, 0xaa17, 0xaa27, 0xaa37, 0xaa47, 0xaa57, 0xaa67, 0xaa77
.long 0xaa87, 0xaa97, 0xaf07, 0xaf17, 0xaf27, 0xaf37, 0xaf47, 0xaf57
.long 0xaf67, 0xaf77, 0xaf87, 0xaf97, 0xb407, 0xb417, 0xb427, 0xb437
.long 0xb447, 0xb457, 0xb467, 0xb477, 0xb487, 0xb497, 0xb907, 0xb917
.long 0xb927, 0xb937, 0xb947, 0xb957, 0xb967, 0xb977, 0xb987, 0xb997
.long 0x9607, 0x9617, 0x9627, 0x9637, 0x9647, 0x9657, 0x9667, 0x9677
.long 0x9687, 0x9697, 0x9b07, 0x9b17, 0x9b27, 0x9b37, 0x9b47, 0x9b57
.long 0x9b67, 0x9b77, 0x9b87, 0x9b97, 0xa007, 0xa017, 0xa027, 0xa037
.long 0xa047, 0xa057, 0xa067, 0xa077, 0xa087, 0xa097, 0xa507, 0xa517
.long 0xa527, 0xa537, 0xa547, 0xa557, 0xa567, 0xa577, 0xa587, 0xa597
.long 0x7ff00008, 0x7ff00008, 0x7ff00008, 0x7ff00008, 0x7ff00008, 0x7ff00008, 0x7ff00008, 0x7ff00008
.long 0x7ff00008, 0x7ff00008, 0x7ff00008, 0x7ff00008, 0x7ff00008, 0x7ff00008, 0x7ff00008, 0x7ff00008
.long 0x7ff00008, 0x7ff00008, 0x7ff00008, 0x7ff00008, 0x7ff00008, 0x7ff00008, 0x7ff00008, 0x7ff00008
.long 0x7ff00008, 0x7ff00008, 0x7ff00008, 0x7ff00008, 0x7ff00008, 0x7ff00008, 0x7ff00008, 0x7ff00008
.long 0x7ff00008, 0x7ff00008, 0x7ff00008, 0x7ff00008, 0x7ff00008, 0x7ff00008, 0x7ff00008, 0x7ff00008
.long 0x7ff00008, 0x7ff00008, 0x7ff00008, 0x7ff00008, 0x7ff00008, 0x7ff00008, 0x7ff00008, 0x7ff00008
.long 0x7ff00008, 0x7ff00008, 0x7ff00008, 0x7ff00008, 0x7ff00008, 0x7ff00008, 0x7ff00008, 0x7ff00008
.long 0x2808, 0x2818, 0x2828, 0x2838, 0x2848, 0x2858, 0x2868, 0x2878
.long 0x2888, 0x2898, 0x2d08, 0x2d18, 0x2d28, 0x2d38, 0x2d48, 0x2d58
.long 0x2d68, 0x2d78, 0x2d88, 0x2d98, 0x5a08, 0x5a18, 0x5a28, 0x5a38
.long 0x5a48, 0x5a58, 0x5a68, 0x5a78, 0x5a88, 0x5a98, 0x5f08, 0x5f18
.long 0x5f28, 0x5f38, 0x5f48, 0x5f58, 0x5f68, 0x5f78, 0x5f88, 0x5f98
.long 0x8c08, 0x8c18, 0x8c28, 0x8c38, 0x8c48, 0x8c58, 0x8c68, 0x8c78
.long 0x8c88, 0x8c98, 0x9108, 0x9118, 0x9128, 0x9138, 0x9148, 0x9158
.long 0x9168, 0x9178, 0x9188, 0x9198, 0xbe08, 0xbe18, 0xbe28, 0xbe38
.long 0xbe48, 0xbe58, 0xbe68, 0xbe78, 0xbe88, 0xbe98, 0xc308, 0xc318
.long 0xc328, 0xc338, 0xc348, 0xc358, 0xc368, 0xc378, 0xc388, 0xc398
.long 0x15408, 0x15418, 0x15428, 0x15438, 0x15448, 0x15458, 0x15468, 0x15478
.long 0x15488, 0x15498, 0x15908, 0x15918, 0x15928, 0x15938, 0x15948, 0x15958
.long 0x15968, 0x15978, 0x15988, 0x15998, 0x18608, 0x18618, 0x18628, 0x18638
.long 0x18648, 0x18658, 0x18668, 0x18678, 0x18688, 0x18698, 0x18b08, 0x18b18
.long 0x18b28, 0x18b38, 0x18b48, 0x18b58, 0x18b68, 0x18b78, 0x18b88, 0x18b98
.long 0xf008, 0xf018, 0xf028, 0xf038, 0xf048, 0xf058, 0xf068, 0xf078
.long 0xf088, 0xf098, 0xf508, 0xf518, 0xf528, 0xf538, 0xf548, 0xf558
.long 0xf568, 0xf578, 0xf588, 0xf598, 0x12208, 0x12218, 0x12228, 0x12238
.long 0x12248, 0x12258, 0x12268, 0x12278, 0x12288, 0x12298, 0x12708, 0x12718
.long 0x12728, 0x12738, 0x12748, 0x12758, 0x12768, 0x12778, 0x12788, 0x12798
.long 0x1b808, 0x1b818, 0x1b828, 0x1b838, 0x1b848, 0x1b858, 0x1b868, 0x1b878
.long 0x1b888, 0x1b898, 0x1bd08, 0x1bd18, 0x1bd28, 0x1bd38, 0x1bd48, 0x1bd58
.long 0x1bd68, 0x1bd78, 0x1bd88, 0x1bd98, 0x1ea08, 0x1ea18, 0x1ea28, 0x1ea38
.long 0x1ea48, 0x1ea58, 0x1ea68, 0x1ea78, 0x1ea88, 0x1ea98, 0x1ef08, 0x1ef18
.long 0x1ef28, 0x1ef38, 0x1ef48, 0x1ef58, 0x1ef68, 0x1ef78, 0x1ef88, 0x1ef98
.long 0x7ff00008, 0x7ff00008, 0x7ff00008, 0x7ff00008, 0x7ff00008, 0x7ff00008, 0x7ff00008, 0x7ff00008
.long 0x7ff00008, 0x7ff00008, 0x7ff00008, 0x7ff00008, 0x7ff00008, 0x7ff00008, 0x7ff00008, 0x7ff00008
.long 0x7ff00008, 0x7ff00008, 0x7ff00008, 0x7ff00008, 0x7ff00008, 0x7ff00008, 0x7ff00008, 0x7ff00008
.long 0x7ff00008, 0x7ff00008, 0x7ff00008, 0x7ff00008, 0x7ff00008, 0x7ff00008, 0x7ff00008, 0x7ff00008
.long 0x7ff00008, 0x7ff00008, 0x7ff00008, 0x7ff00008, 0x7ff00008, 0x7ff00008, 0x7ff00008, 0x7ff00008
.long 0x7ff00008, 0x7ff00008, 0x7ff00008, 0x7ff00008, 0x7ff00008, 0x7ff00008, 0x7ff00008, 0x7ff00008
.long 0x7ff00008, 0x7ff00008, 0x7ff00008, 0x7ff00008, 0x7ff00008, 0x7ff00008, 0x7ff00008, 0x7ff00008
.long 0x21c08, 0x21c18, 0x21c28, 0x21c38, 0x21c48, 0x21c58, 0x21c68, 0x21c78
.long 0x21c88, 0x21c98, 0x22108, 0x22118, 0x22128, 0x22138, 0x22148, 0x22158
.long 0x22168, 0x22178, 0x22188, 0x22198, 0x24e08, 0x24e18, 0x24e28, 0x24e38
.long 0x24e48, 0x24e58, 0x24e68, 0x24e78, 0x24e88, 0x24e98, 0x25308, 0x25318
.long 0x25328, 0x25338, 0x25348, 0x25358, 0x25368, 0x25378, 0x25388, 0x25398
.long 0x2e408, 0x2e418, 0x2e428, 0x2e438, 0x2e448, 0x2e458, 0x2e468, 0x2e478
.long 0x2e488, 0x2e498, 0x2e908, 0x2e918, 0x2e928, 0x2e938, 0x2e948, 0x2e958
.long 0x2e968, 0x2e978, 0x2e988, 0x2e998, 0x31608, 0x31618, 0x31628, 0x31638
.long 0x31648, 0x31658, 0x31668, 0x31678, 0x31688, 0x31698, 0x31b08, 0x31b18
.long 0x31b28, 0x31b38, 0x31b48, 0x31b58, 0x31b68, 0x31b78, 0x31b88, 0x31b98
.long 0x28008, 0x28018, 0x28028, 0x28038, 0x28048, 0x28058, 0x28068, 0x28078
.long 0x28088, 0x28098, 0x28508, 0x28518, 0x28528, 0x28538, 0x28548, 0x28558
.long 0x28568, 0x28578, 0x28588, 0x28598, 0x2b208, 0x2b218, 0x2b228, 0x2b238
.long 0x2b248, 0x2b258, 0x2b268, 0x2b278, 0x2b288, 0x2b298, 0x2b708, 0x2b718
.long 0x2b728, 0x2b738, 0x2b748, 0x2b758, 0x2b768, 0x2b778, 0x2b788, 0x2b798
.long 0x34808, 0x34818, 0x34828, 0x34838, 0x34848, 0x34858, 0x34868, 0x34878
.long 0x34888, 0x34898, 0x34d08, 0x34d18, 0x34d28, 0x34d38, 0x34d48, 0x34d58
.long 0x34d68, 0x34d78, 0x34d88, 0x34d98, 0x37a08, 0x37a18, 0x37a28, 0x37a38
.long 0x37a48, 0x37a58, 0x37a68, 0x37a78, 0x37a88, 0x37a98, 0x37f08, 0x37f18
.long 0x37f28, 0x37f38, 0x37f48, 0x37f58, 0x37f68, 0x37f78, 0x37f88, 0x37f98
.long 0x3ac08, 0x3ac18, 0x3ac28, 0x3ac38, 0x3ac48, 0x3ac58, 0x3ac68, 0x3ac78
.long 0x3ac88, 0x3ac98, 0x3b108, 0x3b118, 0x3b128, 0x3b138, 0x3b148, 0x3b158
.long 0x3b168, 0x3b178, 0x3b188, 0x3b198, 0x3de08, 0x3de18, 0x3de28, 0x3de38
.long 0x3de48, 0x3de58, 0x3de68, 0x3de78, 0x3de88, 0x3de98, 0x3e308, 0x3e318
.long 0x3e328, 0x3e338, 0x3e348, 0x3e358, 0x3e368, 0x3e378, 0x3e388, 0x3e398
.long 0x7ff00008, 0x7ff00008, 0x7ff00008, 0x7ff00008, 0x7ff00008, 0x7ff00008, 0x7ff00008, 0x7ff00008
.long 0x7ff00008, 0x7ff00008, 0x7ff00008, 0x7ff00008, 0x7ff00008, 0x7ff00008, 0x7ff00008, 0x7ff00008
.long 0x7ff00008, 0x7ff00008, 0x7ff00008, 0x7ff00008, 0x7ff00008, 0x7ff00008, 0x7ff00008, 0x7ff00008
.long 0x7ff00008, 0x7ff00008, 0x7ff00008, 0x7ff00008, 0x7ff00008, 0x7ff00008, 0x7ff00008, 0x7ff00008
.long 0x7ff00008, 0x7ff00008, 0x7ff00008, 0x7ff00008, 0x7ff00008, 0x7ff00008, 0x7ff00008, 0x7ff00008
.long 0x7ff00008, 0x7ff00008, 0x7ff00008, 0x7ff00008, 0x7ff00008, 0x7ff00008, 0x7ff00008, 0x7ff00008
.long 0x7ff00008, 0x7ff00008, 0x7ff00008, 0x7ff00008, 0x7ff00008, 0x7ff00008, 0x7ff00008, 0x7ff00008
.long 0x47408, 0x47418, 0x47428, 0x47438, 0x47448, 0x47458, 0x47468, 0x47478
.long 0x47488, 0x47498, 0x47908, 0x47918, 0x47928, 0x47938, 0x47948, 0x47958
.long 0x47968, 0x47978, 0x47988, 0x47998, 0x4a608, 0x4a618, 0x4a628, 0x4a638
.long 0x4a648, 0x4a658, 0x4a668, 0x4a678, 0x4a688, 0x4a698, 0x4ab08, 0x4ab18
.long 0x4ab28, 0x4ab38, 0x4ab48, 0x4ab58, 0x4ab68, 0x4ab78, 0x4ab88, 0x4ab98
.long 0x41008, 0x41018, 0x41028, 0x41038, 0x41048, 0x41058, 0x41068, 0x41078
.long 0x41088, 0x41098, 0x41508, 0x41518, 0x41528, 0x41538, 0x41548, 0x41558
.long 0x41568, 0x41578, 0x41588, 0x41598, 0x44208, 0x44218, 0x44228, 0x44238
.long 0x44248, 0x44258, 0x44268, 0x44278, 0x44288, 0x44298, 0x44708, 0x44718
.long 0x44728, 0x44738, 0x44748, 0x44758, 0x44768, 0x44778, 0x44788, 0x44798
.long 0x4d808, 0x4d818, 0x4d828, 0x4d838, 0x4d848, 0x4d858, 0x4d868, 0x4d878
.long 0x4d888, 0x4d898, 0x4dd08, 0x4dd18, 0x4dd28, 0x4dd38, 0x4dd48, 0x4dd58
.long 0x4dd68, 0x4dd78, 0x4dd88, 0x4dd98, 0x50a08, 0x50a18, 0x50a28, 0x50a38
.long 0x50a48, 0x50a58, 0x50a68, 0x50a78, 0x50a88, 0x50a98, 0x50f08, 0x50f18
.long 0x50f28, 0x50f38, 0x50f48, 0x50f58, 0x50f68, 0x50f78, 0x50f88, 0x50f98
.long 0x53c08, 0x53c18, 0x53c28, 0x53c38, 0x53c48, 0x53c58, 0x53c68, 0x53c78
.long 0x53c88, 0x53c98, 0x54108, 0x54118, 0x54128, 0x54138, 0x54148, 0x54158
.long 0x54168, 0x54178, 0x54188, 0x54198, 0x56e08, 0x56e18, 0x56e28, 0x56e38
.long 0x56e48, 0x56e58, 0x56e68, 0x56e78, 0x56e88, 0x56e98, 0x57308, 0x57318
.long 0x57328, 0x57338, 0x57348, 0x57358, 0x57368, 0x57378, 0x57388, 0x57398
.long 0x60408, 0x60418, 0x60428, 0x60438, 0x60448, 0x60458, 0x60468, 0x60478
.long 0x60488, 0x60498, 0x60908, 0x60918, 0x60928, 0x60938, 0x60948, 0x60958
.long 0x60968, 0x60978, 0x60988, 0x60998, 0x63608, 0x63618, 0x63628, 0x63638
.long 0x63648, 0x63658, 0x63668, 0x63678, 0x63688, 0x63698, 0x63b08, 0x63b18
.long 0x63b28, 0x63b38, 0x63b48, 0x63b58, 0x63b68, 0x63b78, 0x63b88, 0x63b98
.long 0x7ff00008, 0x7ff00008, 0x7ff00008, 0x7ff00008, 0x7ff00008, 0x7ff00008, 0x7ff00008, 0x7ff00008
.long 0x7ff00008, 0x7ff00008, 0x7ff00008, 0x7ff00008, 0x7ff00008, 0x7ff00008, 0x7ff00008, 0x7ff00008
.long 0x7ff00008, 0x7ff00008, 0x7ff00008, 0x7ff00008, 0x7ff00008, 0x7ff00008, 0x7ff00008, 0x7ff00008
.long 0x7ff00008, 0x7ff00008, 0x7ff00008, 0x7ff00008, 0x7ff00008, 0x7ff00008, 0x7ff00008, 0x7ff00008
.long 0x7ff00008, 0x7ff00008, 0x7ff00008, 0x7ff00008, 0x7ff00008, 0x7ff00008, 0x7ff00008, 0x7ff00008
.long 0x7ff00008, 0x7ff00008, 0x7ff00008, 0x7ff00008, 0x7ff00008, 0x7ff00008, 0x7ff00008, 0x7ff00008
.long 0x7ff00008, 0x7ff00008, 0x7ff00008, 0x7ff00008, 0x7ff00008, 0x7ff00008, 0x7ff00008, 0x7ff00008
.long 0x5a008, 0x5a018, 0x5a028, 0x5a038, 0x5a048, 0x5a058, 0x5a068, 0x5a078
.long 0x5a088, 0x5a098, 0x5a508, 0x5a518, 0x5a528, 0x5a538, 0x5a548, 0x5a558
.long 0x5a568, 0x5a578, 0x5a588, 0x5a598, 0x5d208, 0x5d218, 0x5d228, 0x5d238
.long 0x5d248, 0x5d258, 0x5d268, 0x5d278, 0x5d288, 0x5d298, 0x5d708, 0x5d718
.long 0x5d728, 0x5d738, 0x5d748, 0x5d758, 0x5d768, 0x5d778, 0x5d788, 0x5d798
.long 0x64007, 0x64017, 0x64027, 0x64037, 0x64047, 0x64057, 0x64067, 0x64077
.long 0x64087, 0x64097, 0x64507, 0x64517, 0x64527, 0x64537, 0x64547, 0x64557
.long 0x64567, 0x64577, 0x64587, 0x64597, 0x64a07, 0x64a17, 0x64a27, 0x64a37
.long 0x64a47, 0x64a57, 0x64a67, 0x64a77, 0x64a87, 0x64a97, 0x64f07, 0x64f17
.long 0x64f27, 0x64f37, 0x64f47, 0x64f57, 0x64f67, 0x64f77, 0x64f87, 0x64f97
.long 0x65407, 0x65417, 0x65427, 0x65437, 0x65447, 0x65457, 0x65467, 0x65477
.long 0x65487, 0x65497, 0x65907, 0x65917, 0x65927, 0x65937, 0x65947, 0x65957
.long 0x65967, 0x65977, 0x65987, 0x65997, 0x65e07, 0x65e17, 0x65e27, 0x65e37
.long 0x65e47, 0x65e57, 0x65e67, 0x65e77, 0x65e87, 0x65e97, 0x66307, 0x66317
.long 0x66327, 0x66337, 0x66347, 0x66357, 0x66367, 0x66377, 0x66387, 0x66397
.long 0x68607, 0x68617, 0x68627, 0x68637, 0x68647, 0x68657, 0x68667, 0x68677
.long 0x68687, 0x68697, 0x68b07, 0x68b17, 0x68b27, 0x68b37, 0x68b47, 0x68b57
.long 0x68b67, 0x68b77, 0x68b87, 0x68b97, 0x69007, 0x69017, 0x69027, 0x69037
.long 0x69047, 0x69057, 0x69067, 0x69077, 0x69087, 0x69097, 0x69507, 0x69517
.long 0x69527, 0x69537, 0x69547, 0x69557, 0x69567, 0x69577, 0x69587, 0x69597
.long 0x67207, 0x67217, 0x67227, 0x67237, 0x67247, 0x67257, 0x67267, 0x67277
.long 0x67287, 0x67297, 0x67707, 0x67717, 0x67727, 0x67737, 0x67747, 0x67757
.long 0x67767, 0x67777, 0x67787, 0x67797, 0x67c07, 0x67c17, 0x67c27, 0x67c37
.long 0x67c47, 0x67c57, 0x67c67, 0x67c77, 0x67c87, 0x67c97, 0x68107, 0x68117
.long 0x68127, 0x68137, 0x68147, 0x68157, 0x68167, 0x68177, 0x68187, 0x68197
.long 0x7ff00008, 0x7ff00008, 0x7ff00008, 0x7ff00008, 0x7ff00008, 0x7ff00008, 0x7ff00008, 0x7ff00008
.long 0x7ff00008, 0x7ff00008, 0x7ff00008, 0x7ff00008, 0x7ff00008, 0x7ff00008, 0x7ff00008, 0x7ff00008
.long 0x7ff00008, 0x7ff00008, 0x7ff00008, 0x7ff00008, 0x7ff00008, 0x7ff00008, 0x7ff00008, 0x7ff00008
.long 0x7ff00008, 0x7ff00008, 0x7ff00008, 0x7ff00008, 0x7ff00008, 0x7ff00008, 0x7ff00008, 0x7ff00008
.long 0x7ff00008, 0x7ff00008, 0x7ff00008, 0x7ff00008, 0x7ff00008, 0x7ff00008, 0x7ff00008, 0x7ff00008
.long 0x7ff00008, 0x7ff00008, 0x7ff00008, 0x7ff00008, 0x7ff00008, 0x7ff00008, 0x7ff00008, 0x7ff00008
.long 0x7ff00008, 0x7ff00008, 0x7ff00008, 0x7ff00008, 0x7ff00008, 0x7ff00008, 0x7ff00008, 0x7ff00008
.long 0x6a407, 0x6a417, 0x6a427, 0x6a437, 0x6a447, 0x6a457, 0x6a467, 0x6a477
.long 0x6a487, 0x6a497, 0x6a907, 0x6a917, 0x6a927, 0x6a937, 0x6a947, 0x6a957
.long 0x6a967, 0x6a977, 0x6a987, 0x6a997, 0x6ae07, 0x6ae17, 0x6ae27, 0x6ae37
.long 0x6ae47, 0x6ae57, 0x6ae67, 0x6ae77, 0x6ae87, 0x6ae97, 0x6b307, 0x6b317
.long 0x6b327, 0x6b337, 0x6b347, 0x6b357, 0x6b367, 0x6b377, 0x6b387, 0x6b397
.long 0x6b807, 0x6b817, 0x6b827, 0x6b837, 0x6b847, 0x6b857, 0x6b867, 0x6b877
.long 0x6b887, 0x6b897, 0x6bd07, 0x6bd17, 0x6bd27, 0x6bd37, 0x6bd47, 0x6bd57
.long 0x6bd67, 0x6bd77, 0x6bd87, 0x6bd97, 0x6c207, 0x6c217, 0x6c227, 0x6c237
.long 0x6c247, 0x6c257, 0x6c267, 0x6c277, 0x6c287, 0x6c297, 0x6c707, 0x6c717
.long 0x6c727, 0x6c737, 0x6c747, 0x6c757, 0x6c767, 0x6c777, 0x6c787, 0x6c797
.long 0x6ea07, 0x6ea17, 0x6ea27, 0x6ea37, 0x6ea47, 0x6ea57, 0x6ea67, 0x6ea77
.long 0x6ea87, 0x6ea97, 0x6ef07, 0x6ef17, 0x6ef27, 0x6ef37, 0x6ef47, 0x6ef57
.long 0x6ef67, 0x6ef77, 0x6ef87, 0x6ef97, 0x6f407, 0x6f417, 0x6f427, 0x6f437
.long 0x6f447, 0x6f457, 0x6f467, 0x6f477, 0x6f487, 0x6f497, 0x6f907, 0x6f917
.long 0x6f927, 0x6f937, 0x6f947, 0x6f957, 0x6f967, 0x6f977, 0x6f987, 0x6f997
.long 0x6d607, 0x6d617, 0x6d627, 0x6d637, 0x6d647, 0x6d657, 0x6d667, 0x6d677
.long 0x6d687, 0x6d697, 0x6db07, 0x6db17, 0x6db27, 0x6db37, 0x6db47, 0x6db57
.long 0x6db67, 0x6db77, 0x6db87, 0x6db97, 0x6e007, 0x6e017, 0x6e027, 0x6e037
.long 0x6e047, 0x6e057, 0x6e067, 0x6e077, 0x6e087, 0x6e097, 0x6e507, 0x6e517
.long 0x6e527, 0x6e537, 0x6e547, 0x6e557, 0x6e567, 0x6e577, 0x6e587, 0x6e597
.long 0x66808, 0x66818, 0x66828, 0x66838, 0x66848, 0x66858, 0x66868, 0x66878
.long 0x66888, 0x66898, 0x66d08, 0x66d18, 0x66d28, 0x66d38, 0x66d48, 0x66d58
.long 0x66d68, 0x66d78, 0x66d88, 0x66d98, 0x69a08, 0x69a18, 0x69a28, 0x69a38
.long 0x69a48, 0x69a58, 0x69a68, 0x69a78, 0x69a88, 0x69a98, 0x69f08, 0x69f18
.long 0x69f28, 0x69f38, 0x69f48, 0x69f58, 0x69f68, 0x69f78, 0x69f88, 0x69f98
.long 0x7ff00008, 0x7ff00008, 0x7ff00008, 0x7ff00008, 0x7ff00008, 0x7ff00008, 0x7ff00008, 0x7ff00008
.long 0x7ff00008, 0x7ff00008, 0x7ff00008, 0x7ff00008, 0x7ff00008, 0x7ff00008, 0x7ff00008, 0x7ff00008
.long 0x7ff00008, 0x7ff00008, 0x7ff00008, 0x7ff00008, 0x7ff00008, 0x7ff00008, 0x7ff00008, 0x7ff00008
.long 0x7ff00008, 0x7ff00008, 0x7ff00008, 0x7ff00008, 0x7ff00008, 0x7ff00008, 0x7ff00008, 0x7ff00008
.long 0x7ff00008, 0x7ff00008, 0x7ff00008, 0x7ff00008, 0x7ff00008, 0x7ff00008, 0x7ff00008, 0x7ff00008
.long 0x7ff00008, 0x7ff00008, 0x7ff00008, 0x7ff00008, 0x7ff00008, 0x7ff00008, 0x7ff00008, 0x7ff00008
.long 0x7ff00008, 0x7ff00008, 0x7ff00008, 0x7ff00008, 0x7ff00008, 0x7ff00008, 0x7ff00008, 0x7ff00008
.long 0x6cc08, 0x6cc18, 0x6cc28, 0x6cc38, 0x6cc48, 0x6cc58, 0x6cc68, 0x6cc78
.long 0x6cc88, 0x6cc98, 0x6d108, 0x6d118, 0x6d128, 0x6d138, 0x6d148, 0x6d158
.long 0x6d168, 0x6d178, 0x6d188, 0x6d198, 0x6fe08, 0x6fe18, 0x6fe28, 0x6fe38
.long 0x6fe48, 0x6fe58, 0x6fe68, 0x6fe78, 0x6fe88, 0x6fe98, 0x70308, 0x70318
.long 0x70328, 0x70338, 0x70348, 0x70358, 0x70368, 0x70378, 0x70388, 0x70398
.long 0x79408, 0x79418, 0x79428, 0x79438, 0x79448, 0x79458, 0x79468, 0x79478
.long 0x79488, 0x79498, 0x79908, 0x79918, 0x79928, 0x79938, 0x79948, 0x79958
.long 0x79968, 0x79978, 0x79988, 0x79998, 0x7c608, 0x7c618, 0x7c628, 0x7c638
.long 0x7c648, 0x7c658, 0x7c668, 0x7c678, 0x7c688, 0x7c698, 0x7cb08, 0x7cb18
.long 0x7cb28, 0x7cb38, 0x7cb48, 0x7cb58, 0x7cb68, 0x7cb78, 0x7cb88, 0x7cb98
.long 0x73008, 0x73018, 0x73028, 0x73038, 0x73048, 0x73058, 0x73068, 0x73078
.long 0x73088, 0x73098, 0x73508, 0x73518, 0x73528, 0x73538, 0x73548, 0x73558
.long 0x73568, 0x73578, 0x73588, 0x73598, 0x76208, 0x76218, 0x76228, 0x76238
.long 0x76248, 0x76258, 0x76268, 0x76278, 0x76288, 0x76298, 0x76708, 0x76718
.long 0x76728, 0x76738, 0x76748, 0x76758, 0x76768, 0x76778, 0x76788, 0x76798
.long 0x7f808, 0x7f818, 0x7f828, 0x7f838, 0x7f848, 0x7f858, 0x7f868, 0x7f878
.long 0x7f888, 0x7f898, 0x7fd08, 0x7fd18, 0x7fd28, 0x7fd38, 0x7fd48, 0x7fd58
.long 0x7fd68, 0x7fd78, 0x7fd88, 0x7fd98, 0x82a08, 0x82a18, 0x82a28, 0x82a38
.long 0x82a48, 0x82a58, 0x82a68, 0x82a78, 0x82a88, 0x82a98, 0x82f08, 0x82f18
.long 0x82f28, 0x82f38, 0x82f48, 0x82f58, 0x82f68, 0x82f78, 0x82f88, 0x82f98
.long 0x85c08, 0x85c18, 0x85c28, 0x85c38, 0x85c48, 0x85c58, 0x85c68, 0x85c78
.long 0x85c88, 0x85c98, 0x86108, 0x86118, 0x86128, 0x86138, 0x86148, 0x86158
.long 0x86168, 0x86178, 0x86188, 0x86198, 0x88e08, 0x88e18, 0x88e28, 0x88e38
.long 0x88e48, 0x88e58, 0x88e68, 0x88e78, 0x88e88, 0x88e98, 0x89308, 0x89318
.long 0x89328, 0x89338, 0x89348, 0x89358, 0x89368, 0x89378, 0x89388, 0x89398
.long 0x7ff00008, 0x7ff00008, 0x7ff00008, 0x7ff00008, 0x7ff00008, 0x7ff00008, 0x7ff00008, 0x7ff00008
.long 0x7ff00008, 0x7ff00008, 0x7ff00008, 0x7ff00008, 0x7ff00008, 0x7ff00008, 0x7ff00008, 0x7ff00008
.long 0x7ff00008, 0x7ff00008, 0x7ff00008, 0x7ff00008, 0x7ff00008, 0x7ff00008, 0x7ff00008, 0x7ff00008
.long 0x7ff00008, 0x7ff00008, 0x7ff00008, 0x7ff00008, 0x7ff00008, 0x7ff00008, 0x7ff00008, 0x7ff00008
.long 0x7ff00008, 0x7ff00008, 0x7ff00008, 0x7ff00008, 0x7ff00008, 0x7ff00008, 0x7ff00008, 0x7ff00008
.long 0x7ff00008, 0x7ff00008, 0x7ff00008, 0x7ff00008, 0x7ff00008, 0x7ff00008, 0x7ff00008, 0x7ff00008
.long 0x7ff00008, 0x7ff00008, 0x7ff00008, 0x7ff00008, 0x7ff00008, 0x7ff00008, 0x7ff00008, 0x7ff00008
.long 0x92408, 0x92418, 0x92428, 0x92438, 0x92448, 0x92458, 0x92468, 0x92478
.long 0x92488, 0x92498, 0x92908, 0x92918, 0x92928, 0x92938, 0x92948, 0x92958
.long 0x92968, 0x92978, 0x92988, 0x92998, 0x95608, 0x95618, 0x95628, 0x95638
.long 0x95648, 0x95658, 0x95668, 0x95678, 0x95688, 0x95698, 0x95b08, 0x95b18
.long 0x95b28, 0x95b38, 0x95b48, 0x95b58, 0x95b68, 0x95b78, 0x95b88, 0x95b98
.long 0x8c008, 0x8c018, 0x8c028, 0x8c038, 0x8c048, 0x8c058, 0x8c068, 0x8c078
.long 0x8c088, 0x8c098, 0x8c508, 0x8c518, 0x8c528, 0x8c538, 0x8c548, 0x8c558
.long 0x8c568, 0x8c578, 0x8c588, 0x8c598, 0x8f208, 0x8f218, 0x8f228, 0x8f238
.long 0x8f248, 0x8f258, 0x8f268, 0x8f278, 0x8f288, 0x8f298, 0x8f708, 0x8f718
.long 0x8f728, 0x8f738, 0x8f748, 0x8f758, 0x8f768, 0x8f778, 0x8f788, 0x8f798
.long 0x98808, 0x98818, 0x98828, 0x98838, 0x98848, 0x98858, 0x98868, 0x98878
.long 0x98888, 0x98898, 0x98d08, 0x98d18, 0x98d28, 0x98d38, 0x98d48, 0x98d58
.long 0x98d68, 0x98d78, 0x98d88, 0x98d98, 0x9ba08, 0x9ba18, 0x9ba28, 0x9ba38
.long 0x9ba48, 0x9ba58, 0x9ba68, 0x9ba78, 0x9ba88, 0x9ba98, 0x9bf08, 0x9bf18
.long 0x9bf28, 0x9bf38, 0x9bf48, 0x9bf58, 0x9bf68, 0x9bf78, 0x9bf88, 0x9bf98
.long 0x9ec08, 0x9ec18, 0x9ec28, 0x9ec38, 0x9ec48, 0x9ec58, 0x9ec68, 0x9ec78
.long 0x9ec88, 0x9ec98, 0x9f108, 0x9f118, 0x9f128, 0x9f138, 0x9f148, 0x9f158
.long 0x9f168, 0x9f178, 0x9f188, 0x9f198, 0xa1e08, 0xa1e18, 0xa1e28, 0xa1e38
.long 0xa1e48, 0xa1e58, 0xa1e68, 0xa1e78, 0xa1e88, 0xa1e98, 0xa2308, 0xa2318
.long 0xa2328, 0xa2338, 0xa2348, 0xa2358, 0xa2368, 0xa2378, 0xa2388, 0xa2398
.long 0xab408, 0xab418, 0xab428, 0xab438, 0xab448, 0xab458, 0xab468, 0xab478
.long 0xab488, 0xab498, 0xab908, 0xab918, 0xab928, 0xab938, 0xab948, 0xab958
.long 0xab968, 0xab978, 0xab988, 0xab998, 0xae608, 0xae618, 0xae628, 0xae638
.long 0xae648, 0xae658, 0xae668, 0xae678, 0xae688, 0xae698, 0xaeb08, 0xaeb18
.long 0xaeb28, 0xaeb38, 0xaeb48, 0xaeb58, 0xaeb68, 0xaeb78, 0xaeb88, 0xaeb98
.long 0x7ff00008, 0x7ff00008, 0x7ff00008, 0x7ff00008, 0x7ff00008, 0x7ff00008, 0x7ff00008, 0x7ff00008
.long 0x7ff00008, 0x7ff00008, 0x7ff00008, 0x7ff00008, 0x7ff00008, 0x7ff00008, 0x7ff00008, 0x7ff00008
.long 0x7ff00008, 0x7ff00008, 0x7ff00008, 0x7ff00008, 0x7ff00008, 0x7ff00008, 0x7ff00008, 0x7ff00008
.long 0x7ff00008, 0x7ff00008, 0x7ff00008, 0x7ff00008, 0x7ff00008, 0x7ff00008, 0x7ff00008, 0x7ff00008
.long 0x7ff00008, 0x7ff00008, 0x7ff00008, 0x7ff00008, 0x7ff00008, 0x7ff00008, 0x7ff00008, 0x7ff00008
.long 0x7ff00008, 0x7ff00008, 0x7ff00008, 0x7ff00008, 0x7ff00008, 0x7ff00008, 0x7ff00008, 0x7ff00008
.long 0x7ff00008, 0x7ff00008, 0x7ff00008, 0x7ff00008, 0x7ff00008, 0x7ff00008, 0x7ff00008, 0x7ff00008
.long 0xa5008, 0xa5018, 0xa5028, 0xa5038, 0xa5048, 0xa5058, 0xa5068, 0xa5078
.long 0xa5088, 0xa5098, 0xa5508, 0xa5518, 0xa5528, 0xa5538, 0xa5548, 0xa5558
.long 0xa5568, 0xa5578, 0xa5588, 0xa5598, 0xa8208, 0xa8218, 0xa8228, 0xa8238
.long 0xa8248, 0xa8258, 0xa8268, 0xa8278, 0xa8288, 0xa8298, 0xa8708, 0xa8718
.long 0xa8728, 0xa8738, 0xa8748, 0xa8758, 0xa8768, 0xa8778, 0xa8788, 0xa8798
.long 0xb1808, 0xb1818, 0xb1828, 0xb1838, 0xb1848, 0xb1858, 0xb1868, 0xb1878
.long 0xb1888, 0xb1898, 0xb1d08, 0xb1d18, 0xb1d28, 0xb1d38, 0xb1d48, 0xb1d58
.long 0xb1d68, 0xb1d78, 0xb1d88, 0xb1d98, 0xb4a08, 0xb4a18, 0xb4a28, 0xb4a38
.long 0xb4a48, 0xb4a58, 0xb4a68, 0xb4a78, 0xb4a88, 0xb4a98, 0xb4f08, 0xb4f18
.long 0xb4f28, 0xb4f38, 0xb4f48, 0xb4f58, 0xb4f68, 0xb4f78, 0xb4f88, 0xb4f98
.long 0xb7c08, 0xb7c18, 0xb7c28, 0xb7c38, 0xb7c48, 0xb7c58, 0xb7c68, 0xb7c78
.long 0xb7c88, 0xb7c98, 0xb8108, 0xb8118, 0xb8128, 0xb8138, 0xb8148, 0xb8158
.long 0xb8168, 0xb8178, 0xb8188, 0xb8198, 0xbae08, 0xbae18, 0xbae28, 0xbae38
.long 0xbae48, 0xbae58, 0xbae68, 0xbae78, 0xbae88, 0xbae98, 0xbb308, 0xbb318
.long 0xbb328, 0xbb338, 0xbb348, 0xbb358, 0xbb368, 0xbb378, 0xbb388, 0xbb398
.long 0xc4408, 0xc4418, 0xc4428, 0xc4438, 0xc4448, 0xc4458, 0xc4468, 0xc4478
.long 0xc4488, 0xc4498, 0xc4908, 0xc4918, 0xc4928, 0xc4938, 0xc4948, 0xc4958
.long 0xc4968, 0xc4978, 0xc4988, 0xc4998, 0xc7608, 0xc7618, 0xc7628, 0xc7638
.long 0xc7648, 0xc7658, 0xc7668, 0xc7678, 0xc7688, 0xc7698, 0xc7b08, 0xc7b18
.long 0xc7b28, 0xc7b38, 0xc7b48, 0xc7b58, 0xc7b68, 0xc7b78, 0xc7b88, 0xc7b98
.long 0xbe008, 0xbe018, 0xbe028, 0xbe038, 0xbe048, 0xbe058, 0xbe068, 0xbe078
.long 0xbe088, 0xbe098, 0xbe508, 0xbe518, 0xbe528, 0xbe538, 0xbe548, 0xbe558
.long 0xbe568, 0xbe578, 0xbe588, 0xbe598, 0xc1208, 0xc1218, 0xc1228, 0xc1238
.long 0xc1248, 0xc1258, 0xc1268, 0xc1278, 0xc1288, 0xc1298, 0xc1708, 0xc1718
.long 0xc1728, 0xc1738, 0xc1748, 0xc1758, 0xc1768, 0xc1778, 0xc1788, 0xc1798
.long 0x7ff00008, 0x7ff00008, 0x7ff00008, 0x7ff00008, 0x7ff00008, 0x7ff00008, 0x7ff00008, 0x7ff00008
.long 0x7ff00008, 0x7ff00008, 0x7ff00008, 0x7ff00008, 0x7ff00008, 0x7ff00008, 0x7ff00008, 0x7ff00008
.long 0x7ff00008, 0x7ff00008, 0x7ff00008, 0x7ff00008, 0x7ff00008, 0x7ff00008, 0x7ff00008, 0x7ff00008
.long 0x7ff00008, 0x7ff00008, 0x7ff00008, 0x7ff00008, 0x7ff00008, 0x7ff00008, 0x7ff00008, 0x7ff00008
.long 0x7ff00008, 0x7ff00008, 0x7ff00008, 0x7ff00008, 0x7ff00008, 0x7ff00008, 0x7ff00008, 0x7ff00008
.long 0x7ff00008, 0x7ff00008, 0x7ff00008, 0x7ff00008, 0x7ff00008, 0x7ff00008, 0x7ff00008, 0x7ff00008
.long 0x7ff00008, 0x7ff00008, 0x7ff00008, 0x7ff00008, 0x7ff00008, 0x7ff00008, 0x7ff00008, 0x7ff00008
.size L_tab, 50176
.section .rodata,"a"
.p2align 6
.amdhsa_kernel gated_mix__linear_kernel_hedgehog__moe_arch_mod__prompt_kernel
  .amdhsa_next_free_vgpr 256
  .amdhsa_next_free_sgpr 102
  .amdhsa_accum_offset 256
  .amdhsa_group_segment_fixed_size 0
  .amdhsa_kernarg_size 104
  .amdhsa_user_sgpr_count 2
  .amdhsa_user_sgpr_kernarg_segment_ptr 1
  .amdhsa_system_sgpr_workgroup_id_x 1
  .amdhsa_float_denorm_mode_32 3
.end_amdhsa_kernel
```
